```python
import torch

def _softmax(x, axis=-1):
    return torch.softmax(x, dim=axis)
def _gelu(x):
    return torch.nn.functional.gelu(x, approximate="tanh")
def _silu(x):
    return torch.nn.functional.silu(x)
def _sigmoid(x):
    return torch.sigmoid(x)
def _layernorm(x, axis=-1, eps=1e-5):
    m = x.mean(dim=axis, keepdim=True)
    v = x.var(dim=axis, keepdim=True, unbiased=False)
    return (x - m) / torch.sqrt(v + eps)
def _scatter_add(tgt, idx, src, axis=0):
    return tgt.clone().index_add_(axis, idx, src)
def _segment_sum(src, seg, n):
    out = torch.zeros((n,) + src.shape[1:], dtype=src.dtype)
    return out.index_add_(0, seg, src)
def _pad(x, pw):
    flat = tuple(v for pair in reversed(pw) for v in pair)
    return torch.nn.functional.pad(x, flat)

kernel_name = 'standalone__gqa_softmax__near_ridge'

def setup_inputs():

    _w = (lambda a: (lambda t: t.to(torch.bfloat16) if t.is_floating_point() else t)(torch.as_tensor(a)))
    B, Hq, Hkv, Sq, Sk, D = 32, 32, 4, 192, 512, 128
    return {
        "q": _w((lambda *s: torch.randn(*s, dtype=torch.bfloat16) * 0.8)(B, Hq, Sq, D)),
        "k": _w((lambda *s: torch.randn(*s, dtype=torch.bfloat16) * 0.8)(B, Hkv, Sk, D)),
        "v": _w((lambda *s: torch.randn(*s, dtype=torch.bfloat16) * 0.05)(B, Hkv, Sk, D)),
    }

def reference(q, k, v):
    B, Hq, Sq, D = q.shape
    Hkv = k.shape[1]
    rep = Hq // Hkv
    k = (lambda x, n, axis: torch.repeat_interleave(x, n, dim=axis))(k, rep, axis=1)
    v = (lambda x, n, axis: torch.repeat_interleave(x, n, dim=axis))(v, rep, axis=1)
    scale = D ** -0.5
    scores = torch.einsum("bhqd,bhkd->bhqk", q, k) * scale
    p = _softmax(scores, axis=-1)
    return torch.einsum("bhqk,bhkd->bhqd", p, v)
```

```asm
; @launch grid=(256,1,1) block=(256,1,1) lds=163840
.amdgcn_target "amdgcn-amd-amdhsa--gfx950"
.text
.globl standalone__gqa_softmax__near_ridge_kernel
.p2align 8
.type standalone__gqa_softmax__near_ridge_kernel,@function
standalone__gqa_softmax__near_ridge_kernel:
s_cmp_ge_u32 s2, 256
s_cbranch_scc1 L_end
s_load_dwordx4 s[4:7], s[0:1], 0
s_load_dwordx4 s[28:31], s[0:1], 16
s_getpc_b64 s[52:53]
L_pc:
s_lshr_b32 s54, s2, 3
s_and_b32 s54, s54, 3
s_lshl_b32 s54, s54, 15
v_lshl_add_u32 v232, v0, 7, s54
v_min_u32 v232, L_fb-L_pc, v232
v_mov_b32 v233, s53
v_add_co_u32 v232, vcc, s52, v232
s_nop 1
v_addc_co_u32 v233, vcc, 0, v233, vcc
global_load_dword v234, v[232:233], off
v_lshrrev_b32 v252, 6, v0
v_and_b32 v0, 63, v0
v_readfirstlane_b32 s25, v252
s_and_b32 s26, s2, 7
s_lshr_b32 s27, s2, 4
s_lshl_b32 s27, s27, 3
s_or_b32 s26, s26, s27
s_bfe_u32 s27, s2, 0x10003
s_lshl_b32 s48, s26, 1
s_add_u32 s48, s48, s27
s_lshl_b32 s48, s48, 2
s_add_u32 s48, s48, s25
s_mul_i32 s51, s48, 0x9e3779b1
s_mul_hi_u32 s51, s51, 12
s_lshl_b32 s32, s51, 12
s_mul_i32 s48, s48, 49152
s_lshl_b32 s49, s26, 17
s_lshl_b32 s44, s25, 12
s_add_u32 s33, s32, 0x1000
s_cmp_lt_u32 s33, 0xc000
s_cselect_b32 s33, s33, 0
s_mul_i32 s51, s26, 0x9e3779b1
s_lshr_b32 s51, s51, 28
s_lshl_b32 s68, s51, 13
s_add_u32 s69, s68, 0x2000
s_and_b32 s69, s69, 0x1e000
s_add_u32 s70, s69, 0x2000
s_and_b32 s70, s70, 0x1e000
v_and_b32 v252, 15, v0
v_lshrrev_b32 v253, 4, v0
s_lshl_b32 s50, s25, 10
v_lshl_add_u32 v248, v0, 4, s50
v_add_u32 v249, 0x1000, v248
s_lshr_b32 s50, s25, 1
s_lshl_b32 s50, s50, 12
s_and_b32 s51, s25, 1
s_lshl_b32 s24, s51, 10
s_add_u32 s24, s24, s50
s_lshl_b32 s51, s51, 7
s_add_u32 s46, s50, s51
v_and_b32 v254, 7, v0
v_lshlrev_b32 v255, 1, v253
v_xor_b32 v254, v254, v255
v_lshl_add_u32 v254, v254, 4, s46
v_lshrrev_b32 v255, 3, v0
v_lshl_add_u32 v2, v255, 8, v254
v_xor_b32 v254, v253, v252
v_lshlrev_b32 v255, 8, v253
v_xor_b32 v244, 0, v254
v_lshl_add_u32 v244, v244, 4, v255
v_xor_b32 v245, 4, v254
v_lshl_add_u32 v245, v245, 4, v255
v_xor_b32 v246, 8, v254
v_lshl_add_u32 v246, v246, 4, v255
v_xor_b32 v247, 12, v254
v_lshl_add_u32 v247, v247, 4, v255
s_mov_b32 s14, 131072
s_mov_b32 s15, 0x20000
s_mov_b32 s18, 131072
s_mov_b32 s19, 0x20000
s_mov_b32 s10, 49152
s_mov_b32 s11, 0x20000
s_mov_b32 s22, 49152
s_mov_b32 s23, 0x20000
s_waitcnt lgkmcnt(0)
s_add_u32 s12, s6, s49
s_addc_u32 s13, s7, 0
s_add_u32 s16, s28, s49
s_addc_u32 s17, s29, 0
s_add_u32 s8, s4, s48
s_addc_u32 s9, s5, 0
s_add_u32 s20, s30, s48
s_addc_u32 s21, s31, 0
buffer_load_dwordx4 v[192:195], v248, s[12:15], s68 offen nt
buffer_load_dwordx4 v[196:199], v249, s[12:15], s68 offen nt
buffer_load_dwordx4 v[200:203], v248, s[12:15], s69 offen nt
buffer_load_dwordx4 v[204:207], v249, s[12:15], s69 offen nt
s_add_u32 m0, s44, 0x18000
s_nop 0
buffer_load_dwordx4 v244, s[8:11], s32 offen offset:0 nt lds
buffer_load_dwordx4 v245, s[8:11], s32 offen offset:1024 nt lds
buffer_load_dwordx4 v246, s[8:11], s32 offen offset:2048 nt lds
buffer_load_dwordx4 v247, s[8:11], s32 offen offset:3072 nt lds
s_add_u32 m0, s24, 0x0
s_nop 0
buffer_load_dwordx4 v2, s[16:19], s68 offen offset:0 lds
buffer_load_dwordx4 v2, s[16:19], s68 offen offset:2048 lds
s_add_u32 s34, s33, 0x1000
s_cmp_lt_u32 s34, 0xc000
s_cselect_b32 s34, s34, 0
s_add_u32 s35, s34, 0x1000
s_cmp_lt_u32 s35, 0xc000
s_cselect_b32 s35, s35, 0
s_add_u32 s36, s35, 0x1000
s_cmp_lt_u32 s36, 0xc000
s_cselect_b32 s36, s36, 0
s_add_u32 s37, s36, 0x1000
s_cmp_lt_u32 s37, 0xc000
s_cselect_b32 s37, s37, 0
s_add_u32 s38, s37, 0x1000
s_cmp_lt_u32 s38, 0xc000
s_cselect_b32 s38, s38, 0
s_add_u32 s39, s38, 0x1000
s_cmp_lt_u32 s39, 0xc000
s_cselect_b32 s39, s39, 0
s_add_u32 s40, s39, 0x1000
s_cmp_lt_u32 s40, 0xc000
s_cselect_b32 s40, s40, 0
s_add_u32 s41, s40, 0x1000
s_cmp_lt_u32 s41, 0xc000
s_cselect_b32 s41, s41, 0
s_add_u32 s42, s41, 0x1000
s_cmp_lt_u32 s42, 0xc000
s_cselect_b32 s42, s42, 0
s_add_u32 s43, s42, 0x1000
s_cmp_lt_u32 s43, 0xc000
s_cselect_b32 s43, s43, 0
s_add_u32 s71, s70, 0x2000
s_and_b32 s71, s71, 0x1e000
s_add_u32 s72, s71, 0x2000
s_and_b32 s72, s72, 0x1e000
s_add_u32 s73, s72, 0x2000
s_and_b32 s73, s73, 0x1e000
s_add_u32 s74, s73, 0x2000
s_and_b32 s74, s74, 0x1e000
s_add_u32 s75, s74, 0x2000
s_and_b32 s75, s75, 0x1e000
s_add_u32 s76, s75, 0x2000
s_and_b32 s76, s76, 0x1e000
s_add_u32 s77, s76, 0x2000
s_and_b32 s77, s77, 0x1e000
s_add_u32 s78, s77, 0x2000
s_and_b32 s78, s78, 0x1e000
s_add_u32 s79, s78, 0x2000
s_and_b32 s79, s79, 0x1e000
s_add_u32 s80, s79, 0x2000
s_and_b32 s80, s80, 0x1e000
s_add_u32 s81, s80, 0x2000
s_and_b32 s81, s81, 0x1e000
s_add_u32 s82, s81, 0x2000
s_and_b32 s82, s82, 0x1e000
s_add_u32 s83, s82, 0x2000
s_and_b32 s83, s83, 0x1e000
s_lshl_b32 s50, s25, 2
v_add_u32 v254, s50, v253
v_xor_b32 v255, v254, v252
v_lshlrev_b32 v255, 4, v255
v_lshl_add_u32 v255, v254, 8, v255
v_add_u32 v251, 0x8000, v255
v_bfrev_b32 v16, v253
v_lshrrev_b32 v16, 30, v16
s_add_u32 s45, s44, 0x18000
s_add_u32 s47, s44, 0x8000
v_xor_b32 v255, v16, v252
v_xor_b32 v254, 0, v255
v_lshlrev_b32 v254, 4, v254
v_lshl_add_u32 v254, v252, 8, v254
v_add_u32 v4, 0x8000, v254
v_add_u32 v240, s45, v254
v_xor_b32 v254, 4, v255
v_lshlrev_b32 v254, 4, v254
v_lshl_add_u32 v254, v252, 8, v254
v_add_u32 v5, 0x8000, v254
v_add_u32 v241, s45, v254
v_xor_b32 v254, 8, v255
v_lshlrev_b32 v254, 4, v254
v_lshl_add_u32 v254, v252, 8, v254
v_add_u32 v6, 0x8000, v254
v_add_u32 v242, s45, v254
v_xor_b32 v254, 12, v255
v_lshlrev_b32 v254, 4, v254
v_lshl_add_u32 v254, v252, 8, v254
v_add_u32 v7, 0x8000, v254
v_add_u32 v243, s45, v254
v_bfe_u32 v17, v0, 2, 3
v_lshrrev_b32 v18, 1, v17
v_and_b32 v19, 3, v0
v_lshlrev_b32 v19, 3, v19
v_lshl_add_u32 v19, v17, 7, v19
v_lshrrev_b32 v20, 5, v0
v_lshl_add_u32 v19, v20, 11, v19
v_xor_b32 v20, 0, v18
v_lshl_add_u32 v8, v20, 5, v19
v_xor_b32 v20, 1, v18
v_lshl_add_u32 v9, v20, 5, v19
v_xor_b32 v20, 2, v18
v_lshl_add_u32 v10, v20, 5, v19
v_xor_b32 v20, 3, v18
v_lshl_add_u32 v11, v20, 5, v19
v_and_b32 v254, 2, v0
v_cmp_eq_u32 vcc, 0, v254
v_mov_b32 v255, 0x3f803f80
v_and_b32 v254, 1, v0
v_cndmask_b32 v12, 0, v255, vcc
v_cndmask_b32 v13, 0, v255, vcc
v_cndmask_b32 v14, 0, v255, vcc
v_cndmask_b32 v15, 0, v255, vcc
v_cmp_eq_u32 vcc, 0, v254
v_mov_b32 v255, 0x44444444
v_mov_b32 v1, 0xeeeeeeee
v_cndmask_b32 v1, v1, v255, vcc
v_mov_b32 v48, 0
v_mov_b32 v49, 0
v_mov_b32 v50, 0
v_mov_b32 v51, 0
v_mov_b32 v52, 0
v_mov_b32 v53, 0
v_mov_b32 v54, 0
v_mov_b32 v55, 0
v_mov_b32 v56, 0
v_mov_b32 v57, 0
v_mov_b32 v58, 0
v_mov_b32 v59, 0
v_mov_b32 v60, 0
v_mov_b32 v61, 0
v_mov_b32 v62, 0
v_mov_b32 v63, 0
v_mov_b32 v250, 0x3e0293ee
v_mov_b32 v3, 0
v_lshlrev_b32 v16, 4, v16
v_lshl_add_u32 v0, v252, 8, v16
s_mov_b64 vcc, -1
s_cmp_eq_u32 s25, 0
s_cbranch_scc1 L_pg0
s_cmp_eq_u32 s25, 1
s_cbranch_scc1 L_pg1
s_cmp_eq_u32 s25, 2
s_cbranch_scc1 L_pg2
s_branch L_pg3
L_ret:
s_mov_b64 vcc, 0
s_add_u32 m0, s44, 0x1c000
s_nop 0
buffer_load_dwordx4 v244, s[8:11], s33 offen offset:0 nt lds
buffer_load_dwordx4 v245, s[8:11], s33 offen offset:1024 nt lds
buffer_load_dwordx4 v246, s[8:11], s33 offen offset:2048 nt lds
buffer_load_dwordx4 v247, s[8:11], s33 offen offset:3072 nt lds
s_add_u32 m0, s24, 0x2000
s_nop 0
buffer_load_dwordx4 v2, s[16:19], s69 offen offset:0 lds
buffer_load_dwordx4 v2, s[16:19], s69 offen offset:2048 lds
buffer_load_dwordx4 v[208:211], v248, s[12:15], s70 offen nt
buffer_load_dwordx4 v[212:215], v249, s[12:15], s70 offen nt
s_waitcnt vmcnt(16)
v_lshlrev_b32 v232, 16, v192
v_and_b32 v233, 0xffff0000, v192
v_lshlrev_b32 v234, 16, v193
v_and_b32 v235, 0xffff0000, v193
v_lshlrev_b32 v236, 16, v194
v_and_b32 v237, 0xffff0000, v194
v_lshlrev_b32 v238, 16, v195
v_and_b32 v239, 0xffff0000, v195
v_pk_mul_f32 v[232:233], v[232:233], v[250:251] op_sel_hi:[1,0]
v_pk_mul_f32 v[234:235], v[234:235], v[250:251] op_sel_hi:[1,0]
v_pk_mul_f32 v[236:237], v[236:237], v[250:251] op_sel_hi:[1,0]
v_pk_mul_f32 v[238:239], v[238:239], v[250:251] op_sel_hi:[1,0]
v_cvt_pk_bf16_f32 v192, v232, v233
v_cvt_pk_bf16_f32 v193, v234, v235
v_cvt_pk_bf16_f32 v194, v236, v237
v_cvt_pk_bf16_f32 v195, v238, v239
ds_write_b128 v251, v[192:195] offset:0
v_lshlrev_b32 v232, 16, v196
v_and_b32 v233, 0xffff0000, v196
v_lshlrev_b32 v234, 16, v197
v_and_b32 v235, 0xffff0000, v197
v_lshlrev_b32 v236, 16, v198
v_and_b32 v237, 0xffff0000, v198
v_lshlrev_b32 v238, 16, v199
v_and_b32 v239, 0xffff0000, v199
v_pk_mul_f32 v[232:233], v[232:233], v[250:251] op_sel_hi:[1,0]
v_pk_mul_f32 v[234:235], v[234:235], v[250:251] op_sel_hi:[1,0]
v_pk_mul_f32 v[236:237], v[236:237], v[250:251] op_sel_hi:[1,0]
v_pk_mul_f32 v[238:239], v[238:239], v[250:251] op_sel_hi:[1,0]
v_cvt_pk_bf16_f32 v196, v232, v233
v_cvt_pk_bf16_f32 v197, v234, v235
v_cvt_pk_bf16_f32 v198, v236, v237
v_cvt_pk_bf16_f32 v199, v238, v239
ds_write_b128 v251, v[196:199] offset:4096
s_waitcnt vmcnt(14)
v_lshlrev_b32 v232, 16, v200
v_and_b32 v233, 0xffff0000, v200
v_lshlrev_b32 v234, 16, v201
v_and_b32 v235, 0xffff0000, v201
v_lshlrev_b32 v236, 16, v202
v_and_b32 v237, 0xffff0000, v202
v_lshlrev_b32 v238, 16, v203
v_and_b32 v239, 0xffff0000, v203
v_pk_mul_f32 v[232:233], v[232:233], v[250:251] op_sel_hi:[1,0]
v_pk_mul_f32 v[234:235], v[234:235], v[250:251] op_sel_hi:[1,0]
v_pk_mul_f32 v[236:237], v[236:237], v[250:251] op_sel_hi:[1,0]
v_pk_mul_f32 v[238:239], v[238:239], v[250:251] op_sel_hi:[1,0]
v_cvt_pk_bf16_f32 v200, v232, v233
v_cvt_pk_bf16_f32 v201, v234, v235
v_cvt_pk_bf16_f32 v202, v236, v237
v_cvt_pk_bf16_f32 v203, v238, v239
ds_write_b128 v251, v[200:203] offset:8192
v_lshlrev_b32 v232, 16, v204
v_and_b32 v233, 0xffff0000, v204
v_lshlrev_b32 v234, 16, v205
v_and_b32 v235, 0xffff0000, v205
v_lshlrev_b32 v236, 16, v206
v_and_b32 v237, 0xffff0000, v206
v_lshlrev_b32 v238, 16, v207
v_and_b32 v239, 0xffff0000, v207
v_pk_mul_f32 v[232:233], v[232:233], v[250:251] op_sel_hi:[1,0]
v_pk_mul_f32 v[234:235], v[234:235], v[250:251] op_sel_hi:[1,0]
v_pk_mul_f32 v[236:237], v[236:237], v[250:251] op_sel_hi:[1,0]
v_pk_mul_f32 v[238:239], v[238:239], v[250:251] op_sel_hi:[1,0]
v_cvt_pk_bf16_f32 v204, v232, v233
v_cvt_pk_bf16_f32 v205, v234, v235
v_cvt_pk_bf16_f32 v206, v236, v237
v_cvt_pk_bf16_f32 v207, v238, v239
ds_write_b128 v251, v[204:207] offset:12288
s_add_u32 m0, s44, 0x20000
s_nop 0
buffer_load_dwordx4 v244, s[8:11], s34 offen offset:0 nt lds
buffer_load_dwordx4 v245, s[8:11], s34 offen offset:1024 nt lds
buffer_load_dwordx4 v246, s[8:11], s34 offen offset:2048 nt lds
buffer_load_dwordx4 v247, s[8:11], s34 offen offset:3072 nt lds
s_waitcnt lgkmcnt(0)
s_barrier
ds_read_b128 a[128:131], v4 offset:0
ds_read_b128 a[132:135], v5 offset:0
ds_read_b128 a[136:139], v6 offset:0
ds_read_b128 a[140:143], v7 offset:0
ds_read_b128 a[144:147], v7 offset:4096
ds_read_b128 a[148:151], v6 offset:4096
ds_read_b128 a[152:155], v5 offset:4096
ds_read_b128 a[156:159], v4 offset:4096
ds_read_b128 a[160:163], v4 offset:8192
ds_read_b128 a[164:167], v5 offset:8192
ds_read_b128 a[168:171], v6 offset:8192
ds_read_b128 a[172:175], v7 offset:8192
ds_read_b128 a[176:179], v7 offset:12288
ds_read_b128 a[180:183], v6 offset:12288
ds_read_b128 a[184:187], v5 offset:12288
ds_read_b128 a[188:191], v4 offset:12288
s_waitcnt vmcnt(14)
ds_read_b128 a[0:3], v240 offset:0
ds_read_b128 a[4:7], v241 offset:0
ds_read_b128 a[8:11], v242 offset:0
ds_read_b128 a[12:15], v243 offset:0
buffer_load_dwordx4 v[216:219], v248, s[12:15], s71 offen nt
buffer_load_dwordx4 v[220:223], v249, s[12:15], s71 offen nt
s_add_u32 m0, s44, 0x24000
s_nop 0
buffer_load_dwordx4 v244, s[8:11], s35 offen offset:0 nt lds
buffer_load_dwordx4 v245, s[8:11], s35 offen offset:1024 nt lds
buffer_load_dwordx4 v246, s[8:11], s35 offen offset:2048 nt lds
buffer_load_dwordx4 v247, s[8:11], s35 offen offset:3072 nt lds
s_waitcnt vmcnt(10)
v_lshlrev_b32 v232, 16, v208
v_and_b32 v233, 0xffff0000, v208
v_lshlrev_b32 v234, 16, v209
v_and_b32 v235, 0xffff0000, v209
v_lshlrev_b32 v236, 16, v210
v_and_b32 v237, 0xffff0000, v210
v_lshlrev_b32 v238, 16, v211
v_and_b32 v239, 0xffff0000, v211
v_pk_mul_f32 v[232:233], v[232:233], v[250:251] op_sel_hi:[1,0]
v_pk_mul_f32 v[234:235], v[234:235], v[250:251] op_sel_hi:[1,0]
v_pk_mul_f32 v[236:237], v[236:237], v[250:251] op_sel_hi:[1,0]
v_pk_mul_f32 v[238:239], v[238:239], v[250:251] op_sel_hi:[1,0]
v_cvt_pk_bf16_f32 v208, v232, v233
v_cvt_pk_bf16_f32 v209, v234, v235
v_cvt_pk_bf16_f32 v210, v236, v237
v_cvt_pk_bf16_f32 v211, v238, v239
ds_write_b128 v251, v[208:211] offset:16384
v_lshlrev_b32 v232, 16, v212
v_and_b32 v233, 0xffff0000, v212
v_lshlrev_b32 v234, 16, v213
v_and_b32 v235, 0xffff0000, v213
v_lshlrev_b32 v236, 16, v214
v_and_b32 v237, 0xffff0000, v214
v_lshlrev_b32 v238, 16, v215
v_and_b32 v239, 0xffff0000, v215
v_pk_mul_f32 v[232:233], v[232:233], v[250:251] op_sel_hi:[1,0]
v_pk_mul_f32 v[234:235], v[234:235], v[250:251] op_sel_hi:[1,0]
v_pk_mul_f32 v[236:237], v[236:237], v[250:251] op_sel_hi:[1,0]
v_pk_mul_f32 v[238:239], v[238:239], v[250:251] op_sel_hi:[1,0]
v_cvt_pk_bf16_f32 v212, v232, v233
v_cvt_pk_bf16_f32 v213, v234, v235
v_cvt_pk_bf16_f32 v214, v236, v237
v_cvt_pk_bf16_f32 v215, v238, v239
ds_write_b128 v251, v[212:215] offset:20480
s_branch L_pg0
.p2align 12
L_pg0:
s_cbranch_vccnz L_pg4
s_waitcnt lgkmcnt(2)
v_mfma_f32_16x16x32_bf16 v[16:19], a[128:131], a[0:3], -4.0
s_add_u32 m0, s24, 0x4000
s_nop 0
buffer_load_dwordx4 v2, s[16:19], s70 offen offset:0 lds
v_mfma_f32_16x16x32_bf16 v[16:19], a[132:135], a[4:7], v[16:19]
v_mfma_f32_16x16x32_bf16 v[16:19], a[136:139], a[8:11], v[16:19]
v_mfma_f32_16x16x32_bf16 v[16:19], a[140:143], a[12:15], v[16:19]
v_mfma_f32_16x16x32_bf16 v[20:23], a[144:147], a[12:15], -4.0
v_mfma_f32_16x16x32_bf16 v[20:23], a[148:151], a[8:11], v[20:23]
v_mfma_f32_16x16x32_bf16 v[20:23], a[152:155], a[4:7], v[20:23]
buffer_load_dwordx4 v2, s[16:19], s70 offen offset:2048 lds
ds_read_b128 a[16:19], v240 offset:16384
v_mfma_f32_16x16x32_bf16 v[20:23], a[156:159], a[0:3], v[20:23]
s_add_u32 m0, s24, 0x6000
s_nop 0
v_exp_f32 v16, v16
v_mfma_f32_16x16x32_bf16 v[24:27], a[160:163], a[0:3], -4.0
ds_read_b128 a[20:23], v241 offset:16384
v_mfma_f32_16x16x32_bf16 v[24:27], a[164:167], a[4:7], v[24:27]
v_exp_f32 v17, v17
v_mfma_f32_16x16x32_bf16 v[24:27], a[168:171], a[8:11], v[24:27]
ds_read_b128 a[24:27], v242 offset:16384
v_cvt_pk_bf16_f32 v32, v16, v17
v_mfma_f32_16x16x32_bf16 v[24:27], a[172:175], a[12:15], v[24:27]
buffer_load_dwordx4 v2, s[16:19], s71 offen offset:0 lds
buffer_load_dwordx4 v2, s[16:19], s71 offen offset:2048 lds
v_exp_f32 v18, v18
v_mfma_f32_16x16x32_bf16 v[28:31], a[176:179], a[12:15], -4.0
s_barrier
ds_read_b128 a[28:31], v243 offset:16384
v_exp_f32 v20, v20
v_mfma_f32_16x16x32_bf16 v[28:31], a[180:183], a[8:11], v[28:31]
v_exp_f32 v19, v19
v_mfma_f32_16x16x32_bf16 v[28:31], a[184:187], a[4:7], v[28:31]
v_cvt_pk_bf16_f32 v33, v18, v19
v_exp_f32 v21, v21
v_mfma_f32_16x16x32_bf16 v[28:31], a[188:191], a[0:3], v[28:31]
s_waitcnt lgkmcnt(0)
v_exp_f32 v22, v22
v_mfma_f32_16x16x32_bf16 v[16:19], a[128:131], a[16:19], -4.0
v_exp_f32 v23, v23
v_cvt_pk_bf16_f32 v34, v20, v21
v_mfma_f32_16x16x32_bf16 v[16:19], a[132:135], a[20:23], v[16:19]
ds_read_b64_tr_b16 a[192:193], v8 offset:0
v_cvt_pk_bf16_f32 v35, v22, v23
v_mfma_f32_16x16x32_bf16 v[16:19], a[136:139], a[24:27], v[16:19]
v_exp_f32 v24, v24
v_mfma_f32_16x16x32_bf16 v[16:19], a[140:143], a[28:31], v[16:19]
v_exp_f32 v25, v25
v_mfma_f32_16x16x32_bf16 v[20:23], a[144:147], a[28:31], -4.0
v_exp_f32 v26, v26
v_mfma_f32_16x16x32_bf16 v[20:23], a[148:151], a[24:27], v[20:23]
v_exp_f32 v27, v27
v_mfma_f32_16x16x32_bf16 v[20:23], a[152:155], a[20:23], v[20:23]
v_cvt_pk_bf16_f32 v36, v24, v25
v_cvt_pk_bf16_f32 v37, v26, v27
v_exp_f32 v28, v28
v_mfma_f32_16x16x32_bf16 v[20:23], a[156:159], a[16:19], v[20:23]
v_exp_f32 v16, v16
v_exp_f32 v29, v29
v_mfma_f32_16x16x32_bf16 v[24:27], a[160:163], a[16:19], -4.0
v_exp_f32 v30, v30
v_exp_f32 v31, v31
v_mfma_f32_16x16x32_bf16 v[24:27], a[164:167], a[20:23], v[24:27]
ds_read_b64_tr_b16 a[194:195], v8 offset:4096
v_exp_f32 v17, v17
v_mfma_f32_16x16x32_bf16 v[24:27], a[168:171], a[24:27], v[24:27]
ds_read_b64_tr_b16 a[196:197], v8 offset:8192
ds_read_b64_tr_b16 a[198:199], v8 offset:12288
v_cvt_pk_bf16_f32 v40, v16, v17
v_cvt_pk_bf16_f32 v38, v28, v29
v_cvt_pk_bf16_f32 v39, v30, v31
v_mfma_f32_16x16x32_bf16 v[24:27], a[172:175], a[28:31], v[24:27]
ds_read_b64_tr_b16 a[200:201], v9 offset:8192
ds_read_b64_tr_b16 a[202:203], v9 offset:12288
v_exp_f32 v18, v18
v_mfma_f32_16x16x32_bf16 v[28:31], a[176:179], a[28:31], -4.0
ds_read_b64_tr_b16 a[204:205], v9 offset:0
ds_read_b64_tr_b16 a[206:207], v9 offset:4096
v_mfma_f32_16x16x32_bf16 v[28:31], a[180:183], a[24:27], v[28:31]
ds_read_b64_tr_b16 a[208:209], v10 offset:0
ds_read_b64_tr_b16 a[210:211], v10 offset:4096
v_exp_f32 v19, v19
v_mfma_f32_16x16x32_bf16 v[28:31], a[184:187], a[20:23], v[28:31]
ds_read_b64_tr_b16 a[212:213], v10 offset:8192
ds_read_b64_tr_b16 a[214:215], v10 offset:12288
v_cvt_pk_bf16_f32 v41, v18, v19
v_mfma_f32_16x16x32_bf16 v[28:31], a[188:191], a[16:19], v[28:31]
ds_read_b64_tr_b16 a[216:217], v11 offset:8192
ds_read_b64_tr_b16 a[218:219], v11 offset:12288
v_exp_f32 v20, v20
v_smfmac_f32_16x16x64_bf16 v[48:51], v[12:15], v[32:39], v1
s_waitcnt lgkmcnt(10)
ds_read_b64_tr_b16 a[220:221], v11 offset:0
ds_read_b64_tr_b16 a[222:223], v11 offset:4096
v_mfma_f32_16x16x32_bf16 v[64:67], a[192:195], v[32:35], 0
ds_read_b64_tr_b16 a[224:225], v8 offset:1024
ds_read_b64_tr_b16 a[226:227], v8 offset:5120
v_mfma_f32_16x16x32_bf16 v[64:67], a[196:199], v[36:39], v[64:67]
s_waitcnt lgkmcnt(10)
ds_read_b64_tr_b16 a[228:229], v8 offset:9216
ds_read_b64_tr_b16 a[230:231], v8 offset:13312
v_exp_f32 v21, v21
v_mfma_f32_16x16x32_bf16 v[68:71], a[200:203], v[36:39], 0
ds_read_b64_tr_b16 a[232:233], v9 offset:9216
ds_read_b64_tr_b16 a[234:235], v9 offset:13312
v_cvt_pk_bf16_f32 v42, v20, v21
v_mfma_f32_16x16x32_bf16 v[68:71], a[204:207], v[32:35], v[68:71]
s_waitcnt lgkmcnt(10)
ds_read_b64_tr_b16 a[236:237], v9 offset:1024
ds_read_b64_tr_b16 a[238:239], v9 offset:5120
v_exp_f32 v22, v22
v_mfma_f32_16x16x32_bf16 v[72:75], a[208:211], v[32:35], 0
ds_read_b64_tr_b16 a[240:241], v10 offset:1024
ds_read_b64_tr_b16 a[242:243], v10 offset:5120
v_mfma_f32_16x16x32_bf16 v[72:75], a[212:215], v[36:39], v[72:75]
s_waitcnt lgkmcnt(10)
ds_read_b64_tr_b16 a[244:245], v10 offset:9216
ds_read_b64_tr_b16 a[246:247], v10 offset:13312
v_exp_f32 v23, v23
v_mfma_f32_16x16x32_bf16 v[76:79], a[216:219], v[36:39], 0
ds_read_b64_tr_b16 a[248:249], v11 offset:9216
ds_read_b64_tr_b16 a[250:251], v11 offset:13312
v_cvt_pk_bf16_f32 v43, v22, v23
v_mfma_f32_16x16x32_bf16 v[76:79], a[220:223], v[32:35], v[76:79]
s_waitcnt lgkmcnt(10)
ds_read_b64_tr_b16 a[252:253], v11 offset:1024
ds_read_b64_tr_b16 a[254:255], v11 offset:5120
v_exp_f32 v24, v24
v_mfma_f32_16x16x32_bf16 v[80:83], a[224:227], v[32:35], 0
s_waitcnt vmcnt(10)
buffer_load_dwordx4 v[224:227], v248, s[12:15], s72 offen nt
ds_read_b128 a[32:35], v240 offset:32768
v_mfma_f32_16x16x32_bf16 v[80:83], a[228:231], v[36:39], v[80:83]
s_waitcnt lgkmcnt(9)
buffer_load_dwordx4 v[228:231], v249, s[12:15], s72 offen nt
buffer_load_dwordx4 v[192:195], v248, s[12:15], s73 offen nt
buffer_load_dwordx4 v[196:199], v249, s[12:15], s73 offen nt
v_exp_f32 v25, v25
v_mfma_f32_16x16x32_bf16 v[84:87], a[232:235], v[36:39], 0
ds_read_b128 a[36:39], v241 offset:32768
v_cvt_pk_bf16_f32 v44, v24, v25
v_mfma_f32_16x16x32_bf16 v[84:87], a[236:239], v[32:35], v[84:87]
s_waitcnt lgkmcnt(6)
v_exp_f32 v26, v26
v_mfma_f32_16x16x32_bf16 v[88:91], a[240:243], v[32:35], 0
ds_read_b128 a[40:43], v242 offset:32768
ds_read_b128 a[44:47], v243 offset:32768
v_mfma_f32_16x16x32_bf16 v[88:91], a[244:247], v[36:39], v[88:91]
s_waitcnt lgkmcnt(4)
v_exp_f32 v27, v27
v_mfma_f32_16x16x32_bf16 v[92:95], a[248:251], v[36:39], 0
s_waitcnt vmcnt(12)
v_cvt_pk_bf16_f32 v45, v26, v27
v_lshlrev_b32 v232, 16, v216
v_mfma_f32_16x16x32_bf16 v[92:95], a[252:255], v[32:35], v[92:95]
s_waitcnt lgkmcnt(0)
v_exp_f32 v28, v28
v_mfma_f32_16x16x32_bf16 v[16:19], a[128:131], a[32:35], -4.0
v_and_b32 v233, 0xffff0000, v216
v_lshlrev_b32 v234, 16, v217
v_and_b32 v235, 0xffff0000, v217
v_lshlrev_b32 v236, 16, v218
v_and_b32 v237, 0xffff0000, v218
v_lshlrev_b32 v238, 16, v219
v_and_b32 v239, 0xffff0000, v219
v_pk_mul_f32 v[232:233], v[232:233], v[250:251] op_sel_hi:[1,0]
v_pk_mul_f32 v[234:235], v[234:235], v[250:251] op_sel_hi:[1,0]
v_pk_mul_f32 v[236:237], v[236:237], v[250:251] op_sel_hi:[1,0]
v_pk_mul_f32 v[238:239], v[238:239], v[250:251] op_sel_hi:[1,0]
v_cvt_pk_bf16_f32 v216, v232, v233
v_cvt_pk_bf16_f32 v217, v234, v235
v_cvt_pk_bf16_f32 v218, v236, v237
v_cvt_pk_bf16_f32 v219, v238, v239
v_mfma_f32_16x16x32_bf16 v[16:19], a[132:135], a[36:39], v[16:19]
ds_write_b128 v251, v[216:219] offset:24576
v_exp_f32 v29, v29
v_mfma_f32_16x16x32_bf16 v[16:19], a[136:139], a[40:43], v[16:19]
buffer_load_dwordx4 v[200:203], v248, s[12:15], s74 offen nt
v_lshlrev_b32 v232, 16, v220
v_mfma_f32_16x16x32_bf16 v[16:19], a[140:143], a[44:47], v[16:19]
v_exp_f32 v30, v30
v_mfma_f32_16x16x32_bf16 v[20:23], a[144:147], a[44:47], -4.0
v_cvt_pk_bf16_f32 v46, v28, v29
v_and_b32 v233, 0xffff0000, v220
v_mfma_f32_16x16x32_bf16 v[20:23], a[148:151], a[40:43], v[20:23]
v_exp_f32 v31, v31
v_mfma_f32_16x16x32_bf16 v[20:23], a[152:155], a[36:39], v[20:23]
v_cvt_pk_bf16_f32 v47, v30, v31
v_lshlrev_b32 v234, 16, v221
v_mfma_f32_16x16x32_bf16 v[20:23], a[156:159], a[32:35], v[20:23]
v_exp_f32 v16, v16
v_mfma_f32_16x16x32_bf16 v[24:27], a[160:163], a[32:35], -4.0
buffer_load_dwordx4 v[204:207], v249, s[12:15], s74 offen nt
v_and_b32 v235, 0xffff0000, v221
v_lshlrev_b32 v236, 16, v222
v_and_b32 v237, 0xffff0000, v222
v_lshlrev_b32 v238, 16, v223
v_and_b32 v239, 0xffff0000, v223
v_pk_mul_f32 v[232:233], v[232:233], v[250:251] op_sel_hi:[1,0]
v_pk_mul_f32 v[234:235], v[234:235], v[250:251] op_sel_hi:[1,0]
v_pk_mul_f32 v[236:237], v[236:237], v[250:251] op_sel_hi:[1,0]
v_pk_mul_f32 v[238:239], v[238:239], v[250:251] op_sel_hi:[1,0]
v_mfma_f32_16x16x32_bf16 v[24:27], a[164:167], a[36:39], v[24:27]
v_exp_f32 v17, v17
v_mfma_f32_16x16x32_bf16 v[24:27], a[168:171], a[40:43], v[24:27]
v_cvt_pk_bf16_f32 v32, v16, v17
v_cvt_pk_bf16_f32 v220, v232, v233
v_mfma_f32_16x16x32_bf16 v[24:27], a[172:175], a[44:47], v[24:27]
v_exp_f32 v18, v18
v_mfma_f32_16x16x32_bf16 v[28:31], a[176:179], a[44:47], -4.0
v_cvt_pk_bf16_f32 v221, v234, v235
v_cvt_pk_bf16_f32 v222, v236, v237
v_cvt_pk_bf16_f32 v223, v238, v239
v_mfma_f32_16x16x32_bf16 v[28:31], a[180:183], a[40:43], v[28:31]
ds_write_b128 v251, v[220:223] offset:28672
v_exp_f32 v19, v19
v_mfma_f32_16x16x32_bf16 v[28:31], a[184:187], a[36:39], v[28:31]
buffer_load_dwordx4 v[208:211], v248, s[12:15], s75 offen nt
v_cvt_pk_bf16_f32 v33, v18, v19
v_mfma_f32_16x16x32_bf16 v[28:31], a[188:191], a[32:35], v[28:31]
v_exp_f32 v20, v20
v_smfmac_f32_16x16x64_bf16 v[52:55], v[12:15], v[40:47], v1
v_mfma_f32_16x16x32_bf16 v[96:99], a[192:195], v[40:43], 0
v_mfma_f32_16x16x32_bf16 v[96:99], a[196:199], v[44:47], v[96:99]
v_exp_f32 v21, v21
v_mfma_f32_16x16x32_bf16 v[100:103], a[200:203], v[44:47], 0
v_cvt_pk_bf16_f32 v34, v20, v21
v_mfma_f32_16x16x32_bf16 v[100:103], a[204:207], v[40:43], v[100:103]
v_exp_f32 v22, v22
v_mfma_f32_16x16x32_bf16 v[104:107], a[208:211], v[40:43], 0
buffer_load_dwordx4 v[212:215], v249, s[12:15], s75 offen nt
v_mfma_f32_16x16x32_bf16 v[104:107], a[212:215], v[44:47], v[104:107]
v_exp_f32 v23, v23
v_mfma_f32_16x16x32_bf16 v[108:111], a[216:219], v[44:47], 0
s_waitcnt vmcnt(12)
ds_read_b128 a[48:51], v240 offset:49152
v_cvt_pk_bf16_f32 v35, v22, v23
v_mfma_f32_16x16x32_bf16 v[108:111], a[220:223], v[40:43], v[108:111]
s_waitcnt lgkmcnt(1)
v_exp_f32 v24, v24
v_mfma_f32_16x16x32_bf16 v[112:115], a[224:227], v[40:43], 0
s_barrier
v_mfma_f32_16x16x32_bf16 v[112:115], a[228:231], v[44:47], v[112:115]
s_add_u32 m0, s24, 0x0
v_exp_f32 v25, v25
v_mfma_f32_16x16x32_bf16 v[116:119], a[232:235], v[44:47], 0
ds_read_b128 a[52:55], v241 offset:49152
v_cvt_pk_bf16_f32 v36, v24, v25
v_mfma_f32_16x16x32_bf16 v[116:119], a[236:239], v[40:43], v[116:119]
v_exp_f32 v26, v26
v_mfma_f32_16x16x32_bf16 v[120:123], a[240:243], v[40:43], 0
ds_read_b128 a[56:59], v242 offset:49152
ds_read_b128 a[60:63], v243 offset:49152
v_mfma_f32_16x16x32_bf16 v[120:123], a[244:247], v[44:47], v[120:123]
v_exp_f32 v27, v27
v_mfma_f32_16x16x32_bf16 v[124:127], a[248:251], v[44:47], 0
buffer_load_dwordx4 v2, s[16:19], s72 offen offset:0 lds
v_cvt_pk_bf16_f32 v37, v26, v27
v_mfma_f32_16x16x32_bf16 v[124:127], a[252:255], v[40:43], v[124:127]
s_waitcnt lgkmcnt(0)
v_exp_f32 v28, v28
v_mfma_f32_16x16x32_bf16 v[16:19], a[128:131], a[48:51], -4.0
s_waitcnt vmcnt(7)
ds_read_b128 a[128:131], v4 offset:16384
v_lshlrev_b32 v232, 16, v224
v_mfma_f32_16x16x32_bf16 v[16:19], a[132:135], a[52:55], v[16:19]
v_exp_f32 v29, v29
v_mfma_f32_16x16x32_bf16 v[16:19], a[136:139], a[56:59], v[16:19]
ds_read_b128 a[132:135], v5 offset:16384
v_and_b32 v233, 0xffff0000, v224
v_mfma_f32_16x16x32_bf16 v[16:19], a[140:143], a[60:63], v[16:19]
v_exp_f32 v30, v30
v_mfma_f32_16x16x32_bf16 v[20:23], a[144:147], a[60:63], -4.0
ds_read_b128 a[136:139], v6 offset:16384
v_cvt_pk_bf16_f32 v38, v28, v29
v_mfma_f32_16x16x32_bf16 v[20:23], a[148:151], a[56:59], v[20:23]
v_exp_f32 v31, v31
v_mfma_f32_16x16x32_bf16 v[20:23], a[152:155], a[52:55], v[20:23]
ds_read_b128 a[140:143], v7 offset:16384
v_cvt_pk_bf16_f32 v39, v30, v31
v_mfma_f32_16x16x32_bf16 v[20:23], a[156:159], a[48:51], v[20:23]
v_exp_f32 v16, v16
v_mfma_f32_16x16x32_bf16 v[24:27], a[160:163], a[48:51], -4.0
ds_read_b128 a[144:147], v7 offset:20480
buffer_load_dwordx4 v2, s[16:19], s72 offen offset:2048 lds
v_mfma_f32_16x16x32_bf16 v[24:27], a[164:167], a[52:55], v[24:27]
s_add_u32 m0, s24, 0x2000
v_exp_f32 v17, v17
v_mfma_f32_16x16x32_bf16 v[24:27], a[168:171], a[56:59], v[24:27]
ds_read_b128 a[148:151], v6 offset:20480
v_cvt_pk_bf16_f32 v40, v16, v17
v_mfma_f32_16x16x32_bf16 v[24:27], a[172:175], a[60:63], v[24:27]
v_exp_f32 v18, v18
v_mfma_f32_16x16x32_bf16 v[28:31], a[176:179], a[60:63], -4.0
ds_read_b128 a[152:155], v5 offset:20480
v_lshlrev_b32 v234, 16, v225
v_mfma_f32_16x16x32_bf16 v[28:31], a[180:183], a[56:59], v[28:31]
v_exp_f32 v19, v19
v_mfma_f32_16x16x32_bf16 v[28:31], a[184:187], a[52:55], v[28:31]
ds_read_b128 a[156:159], v4 offset:20480
v_cvt_pk_bf16_f32 v41, v18, v19
v_mfma_f32_16x16x32_bf16 v[28:31], a[188:191], a[48:51], v[28:31]
v_exp_f32 v20, v20
v_smfmac_f32_16x16x64_bf16 v[56:59], v[12:15], v[32:39], v1
buffer_load_dwordx4 v2, s[16:19], s73 offen offset:0 lds
v_mfma_f32_16x16x32_bf16 v[128:131], a[192:195], v[32:35], 0
ds_read_b128 a[160:163], v4 offset:24576
v_and_b32 v235, 0xffff0000, v225
v_lshlrev_b32 v236, 16, v226
v_and_b32 v237, 0xffff0000, v226
v_lshlrev_b32 v238, 16, v227
v_and_b32 v239, 0xffff0000, v227
v_pk_mul_f32 v[232:233], v[232:233], v[250:251] op_sel_hi:[1,0]
v_pk_mul_f32 v[234:235], v[234:235], v[250:251] op_sel_hi:[1,0]
v_pk_mul_f32 v[236:237], v[236:237], v[250:251] op_sel_hi:[1,0]
v_pk_mul_f32 v[238:239], v[238:239], v[250:251] op_sel_hi:[1,0]
v_mfma_f32_16x16x32_bf16 v[128:131], a[196:199], v[36:39], v[128:131]
v_exp_f32 v21, v21
v_mfma_f32_16x16x32_bf16 v[132:135], a[200:203], v[36:39], 0
ds_read_b128 a[164:167], v5 offset:24576
v_cvt_pk_bf16_f32 v42, v20, v21
v_mfma_f32_16x16x32_bf16 v[132:135], a[204:207], v[32:35], v[132:135]
v_exp_f32 v22, v22
v_mfma_f32_16x16x32_bf16 v[136:139], a[208:211], v[32:35], 0
ds_read_b128 a[168:171], v6 offset:24576
v_cvt_pk_bf16_f32 v224, v232, v233
v_mfma_f32_16x16x32_bf16 v[136:139], a[212:215], v[36:39], v[136:139]
v_exp_f32 v23, v23
v_mfma_f32_16x16x32_bf16 v[140:143], a[216:219], v[36:39], 0
buffer_load_dwordx4 v2, s[16:19], s73 offen offset:2048 lds
v_cvt_pk_bf16_f32 v43, v22, v23
v_mfma_f32_16x16x32_bf16 v[140:143], a[220:223], v[32:35], v[140:143]
v_exp_f32 v24, v24
v_cvt_pk_bf16_f32 v225, v234, v235
v_cvt_pk_bf16_f32 v226, v236, v237
v_cvt_pk_bf16_f32 v227, v238, v239
v_mfma_f32_16x16x32_bf16 v[144:147], a[224:227], v[32:35], 0
ds_write_b128 v251, v[224:227] offset:32768
v_mfma_f32_16x16x32_bf16 v[144:147], a[228:231], v[36:39], v[144:147]
v_exp_f32 v25, v25
v_mfma_f32_16x16x32_bf16 v[148:151], a[232:235], v[36:39], 0
ds_read_b128 a[172:175], v7 offset:24576
v_cvt_pk_bf16_f32 v44, v24, v25
v_mfma_f32_16x16x32_bf16 v[148:151], a[236:239], v[32:35], v[148:151]
v_exp_f32 v26, v26
v_mfma_f32_16x16x32_bf16 v[152:155], a[240:243], v[32:35], 0
ds_read_b128 a[176:179], v7 offset:28672
buffer_load_dwordx4 v[216:219], v248, s[12:15], s76 offen nt
v_mfma_f32_16x16x32_bf16 v[152:155], a[244:247], v[36:39], v[152:155]
v_exp_f32 v27, v27
v_mfma_f32_16x16x32_bf16 v[156:159], a[248:251], v[36:39], 0
ds_read_b128 a[180:183], v6 offset:28672
v_cvt_pk_bf16_f32 v45, v26, v27
v_mfma_f32_16x16x32_bf16 v[156:159], a[252:255], v[32:35], v[156:159]
s_waitcnt lgkmcnt(11)
v_exp_f32 v28, v28
v_mfma_f32_16x16x32_bf16 v[16:19], a[128:131], a[0:3], -4.0
ds_read_b128 a[184:187], v5 offset:28672
v_lshlrev_b32 v232, 16, v228
v_mfma_f32_16x16x32_bf16 v[16:19], a[132:135], a[4:7], v[16:19]
v_exp_f32 v29, v29
v_mfma_f32_16x16x32_bf16 v[16:19], a[136:139], a[8:11], v[16:19]
ds_read_b128 a[188:191], v4 offset:28672
buffer_load_dwordx4 v[220:223], v249, s[12:15], s76 offen nt
v_mfma_f32_16x16x32_bf16 v[16:19], a[140:143], a[12:15], v[16:19]
s_waitcnt lgkmcnt(9)
v_exp_f32 v30, v30
v_and_b32 v233, 0xffff0000, v228
v_lshlrev_b32 v234, 16, v229
v_and_b32 v235, 0xffff0000, v229
v_lshlrev_b32 v236, 16, v230
v_and_b32 v237, 0xffff0000, v230
v_lshlrev_b32 v238, 16, v231
v_and_b32 v239, 0xffff0000, v231
v_pk_mul_f32 v[232:233], v[232:233], v[250:251] op_sel_hi:[1,0]
v_pk_mul_f32 v[234:235], v[234:235], v[250:251] op_sel_hi:[1,0]
v_pk_mul_f32 v[236:237], v[236:237], v[250:251] op_sel_hi:[1,0]
v_pk_mul_f32 v[238:239], v[238:239], v[250:251] op_sel_hi:[1,0]
v_cvt_pk_bf16_f32 v228, v232, v233
v_cvt_pk_bf16_f32 v229, v234, v235
v_cvt_pk_bf16_f32 v230, v236, v237
v_cvt_pk_bf16_f32 v231, v238, v239
v_mfma_f32_16x16x32_bf16 v[20:23], a[144:147], a[12:15], -4.0
ds_write_b128 v251, v[228:231] offset:36864
v_cvt_pk_bf16_f32 v46, v28, v29
v_mfma_f32_16x16x32_bf16 v[20:23], a[148:151], a[8:11], v[20:23]
v_exp_f32 v31, v31
v_mfma_f32_16x16x32_bf16 v[20:23], a[152:155], a[4:7], v[20:23]
v_cvt_pk_bf16_f32 v47, v30, v31
v_mfma_f32_16x16x32_bf16 v[20:23], a[156:159], a[0:3], v[20:23]
s_waitcnt lgkmcnt(5)
v_exp_f32 v16, v16
v_mfma_f32_16x16x32_bf16 v[24:27], a[160:163], a[0:3], -4.0
v_mfma_f32_16x16x32_bf16 v[24:27], a[164:167], a[4:7], v[24:27]
v_exp_f32 v17, v17
v_mfma_f32_16x16x32_bf16 v[24:27], a[168:171], a[8:11], v[24:27]
v_cvt_pk_bf16_f32 v32, v16, v17
v_mfma_f32_16x16x32_bf16 v[24:27], a[172:175], a[12:15], v[24:27]
s_waitcnt lgkmcnt(1)
v_exp_f32 v18, v18
v_mfma_f32_16x16x32_bf16 v[28:31], a[176:179], a[12:15], -4.0
v_mfma_f32_16x16x32_bf16 v[28:31], a[180:183], a[8:11], v[28:31]
v_exp_f32 v19, v19
v_mfma_f32_16x16x32_bf16 v[28:31], a[184:187], a[4:7], v[28:31]
v_cvt_pk_bf16_f32 v33, v18, v19
v_mfma_f32_16x16x32_bf16 v[28:31], a[188:191], a[0:3], v[28:31]
v_exp_f32 v20, v20
v_smfmac_f32_16x16x64_bf16 v[60:63], v[12:15], v[40:47], v1
s_barrier
v_mfma_f32_16x16x32_bf16 v[160:163], a[192:195], v[40:43], 0
ds_read_b64_tr_b16 a[192:193], v8 offset:16384
ds_read_b64_tr_b16 a[194:195], v8 offset:20480
v_mfma_f32_16x16x32_bf16 v[160:163], a[196:199], v[44:47], v[160:163]
v_exp_f32 v21, v21
v_mfma_f32_16x16x32_bf16 v[164:167], a[200:203], v[44:47], 0
ds_read_b64_tr_b16 a[196:197], v8 offset:24576
v_cvt_pk_bf16_f32 v34, v20, v21
v_mfma_f32_16x16x32_bf16 v[164:167], a[204:207], v[40:43], v[164:167]
v_exp_f32 v22, v22
v_mfma_f32_16x16x32_bf16 v[168:171], a[208:211], v[40:43], 0
ds_read_b64_tr_b16 a[198:199], v8 offset:28672
ds_read_b64_tr_b16 a[200:201], v9 offset:24576
v_mfma_f32_16x16x32_bf16 v[168:171], a[212:215], v[44:47], v[168:171]
v_exp_f32 v23, v23
v_mfma_f32_16x16x32_bf16 v[172:175], a[216:219], v[44:47], 0
ds_read_b64_tr_b16 a[202:203], v9 offset:28672
v_cvt_pk_bf16_f32 v35, v22, v23
v_mfma_f32_16x16x32_bf16 v[172:175], a[220:223], v[40:43], v[172:175]
v_exp_f32 v24, v24
v_mfma_f32_16x16x32_bf16 v[176:179], a[224:227], v[40:43], 0
ds_read_b64_tr_b16 a[204:205], v9 offset:16384
ds_read_b64_tr_b16 a[206:207], v9 offset:20480
v_mfma_f32_16x16x32_bf16 v[176:179], a[228:231], v[44:47], v[176:179]
v_exp_f32 v25, v25
v_mfma_f32_16x16x32_bf16 v[180:183], a[232:235], v[44:47], 0
ds_read_b64_tr_b16 a[208:209], v10 offset:16384
v_cvt_pk_bf16_f32 v36, v24, v25
v_mfma_f32_16x16x32_bf16 v[180:183], a[236:239], v[40:43], v[180:183]
v_exp_f32 v26, v26
v_mfma_f32_16x16x32_bf16 v[184:187], a[240:243], v[40:43], 0
ds_read_b64_tr_b16 a[210:211], v10 offset:20480
ds_read_b64_tr_b16 a[212:213], v10 offset:24576
v_mfma_f32_16x16x32_bf16 v[184:187], a[244:247], v[44:47], v[184:187]
v_exp_f32 v27, v27
v_mfma_f32_16x16x32_bf16 v[188:191], a[248:251], v[44:47], 0
ds_read_b64_tr_b16 a[214:215], v10 offset:28672
v_cvt_pk_bf16_f32 v37, v26, v27
v_mfma_f32_16x16x32_bf16 v[188:191], a[252:255], v[40:43], v[188:191]
v_exp_f32 v28, v28
v_mfma_f32_16x16x32_bf16 v[16:19], a[128:131], a[16:19], -4.0
ds_read_b64_tr_b16 a[216:217], v11 offset:24576
ds_read_b64_tr_b16 a[218:219], v11 offset:28672
v_mfma_f32_16x16x32_bf16 v[16:19], a[132:135], a[20:23], v[16:19]
v_exp_f32 v29, v29
v_mfma_f32_16x16x32_bf16 v[16:19], a[136:139], a[24:27], v[16:19]
ds_read_b64_tr_b16 a[220:221], v11 offset:16384
ds_read_b64_tr_b16 a[222:223], v11 offset:20480
v_mfma_f32_16x16x32_bf16 v[16:19], a[140:143], a[28:31], v[16:19]
v_exp_f32 v30, v30
v_mfma_f32_16x16x32_bf16 v[20:23], a[144:147], a[28:31], -4.0
ds_read_b64_tr_b16 a[224:225], v8 offset:17408
v_cvt_pk_bf16_f32 v38, v28, v29
v_mfma_f32_16x16x32_bf16 v[20:23], a[148:151], a[24:27], v[20:23]
v_exp_f32 v31, v31
v_mfma_f32_16x16x32_bf16 v[20:23], a[152:155], a[20:23], v[20:23]
ds_read_b64_tr_b16 a[226:227], v8 offset:21504
v_cvt_pk_bf16_f32 v39, v30, v31
v_mfma_f32_16x16x32_bf16 v[20:23], a[156:159], a[16:19], v[20:23]
v_exp_f32 v16, v16
v_mfma_f32_16x16x32_bf16 v[24:27], a[160:163], a[16:19], -4.0
s_waitcnt vmcnt(10)
v_lshlrev_b32 v232, 16, v192
v_and_b32 v233, 0xffff0000, v192
v_lshlrev_b32 v234, 16, v193
v_and_b32 v235, 0xffff0000, v193
v_lshlrev_b32 v236, 16, v194
v_and_b32 v237, 0xffff0000, v194
v_lshlrev_b32 v238, 16, v195
v_and_b32 v239, 0xffff0000, v195
v_pk_mul_f32 v[232:233], v[232:233], v[250:251] op_sel_hi:[1,0]
v_pk_mul_f32 v[234:235], v[234:235], v[250:251] op_sel_hi:[1,0]
v_pk_mul_f32 v[236:237], v[236:237], v[250:251] op_sel_hi:[1,0]
v_pk_mul_f32 v[238:239], v[238:239], v[250:251] op_sel_hi:[1,0]
v_cvt_pk_bf16_f32 v192, v232, v233
v_cvt_pk_bf16_f32 v193, v234, v235
v_cvt_pk_bf16_f32 v194, v236, v237
v_cvt_pk_bf16_f32 v195, v238, v239
v_mfma_f32_16x16x32_bf16 v[24:27], a[164:167], a[20:23], v[24:27]
ds_write_b128 v251, v[192:195] offset:40960
v_exp_f32 v17, v17
v_mfma_f32_16x16x32_bf16 v[24:27], a[168:171], a[24:27], v[24:27]
ds_read_b64_tr_b16 a[228:229], v8 offset:25600
v_cvt_pk_bf16_f32 v40, v16, v17
v_mfma_f32_16x16x32_bf16 v[24:27], a[172:175], a[28:31], v[24:27]
v_exp_f32 v18, v18
v_mfma_f32_16x16x32_bf16 v[28:31], a[176:179], a[28:31], -4.0
ds_read_b64_tr_b16 a[230:231], v8 offset:29696
ds_read_b64_tr_b16 a[232:233], v9 offset:25600
v_mfma_f32_16x16x32_bf16 v[28:31], a[180:183], a[24:27], v[28:31]
v_exp_f32 v19, v19
v_mfma_f32_16x16x32_bf16 v[28:31], a[184:187], a[20:23], v[28:31]
ds_read_b64_tr_b16 a[234:235], v9 offset:29696
v_cvt_pk_bf16_f32 v41, v18, v19
v_mfma_f32_16x16x32_bf16 v[28:31], a[188:191], a[16:19], v[28:31]
v_exp_f32 v20, v20
v_smfmac_f32_16x16x64_bf16 v[48:51], v[12:15], v[32:39], v1
s_waitcnt lgkmcnt(15)
ds_read_b64_tr_b16 a[236:237], v9 offset:17408
v_mfma_f32_16x16x32_bf16 v[64:67], a[192:195], v[32:35], v[64:67]
ds_read_b64_tr_b16 a[238:239], v9 offset:21504
ds_read_b64_tr_b16 a[240:241], v10 offset:17408
v_mfma_f32_16x16x32_bf16 v[64:67], a[196:199], v[36:39], v[64:67]
v_exp_f32 v21, v21
v_mfma_f32_16x16x32_bf16 v[68:71], a[200:203], v[36:39], v[68:71]
ds_read_b64_tr_b16 a[242:243], v10 offset:21504
v_cvt_pk_bf16_f32 v42, v20, v21
v_mfma_f32_16x16x32_bf16 v[68:71], a[204:207], v[32:35], v[68:71]
s_waitcnt lgkmcnt(15)
v_exp_f32 v22, v22
v_lshlrev_b32 v232, 16, v196
v_and_b32 v233, 0xffff0000, v196
v_lshlrev_b32 v234, 16, v197
v_and_b32 v235, 0xffff0000, v197
v_lshlrev_b32 v236, 16, v198
v_and_b32 v237, 0xffff0000, v198
v_lshlrev_b32 v238, 16, v199
v_and_b32 v239, 0xffff0000, v199
v_pk_mul_f32 v[232:233], v[232:233], v[250:251] op_sel_hi:[1,0]
v_pk_mul_f32 v[234:235], v[234:235], v[250:251] op_sel_hi:[1,0]
v_pk_mul_f32 v[236:237], v[236:237], v[250:251] op_sel_hi:[1,0]
v_pk_mul_f32 v[238:239], v[238:239], v[250:251] op_sel_hi:[1,0]
v_cvt_pk_bf16_f32 v196, v232, v233
v_cvt_pk_bf16_f32 v197, v234, v235
v_cvt_pk_bf16_f32 v198, v236, v237
v_cvt_pk_bf16_f32 v199, v238, v239
v_mfma_f32_16x16x32_bf16 v[72:75], a[208:211], v[32:35], v[72:75]
ds_write_b128 v251, v[196:199] offset:45056
v_mfma_f32_16x16x32_bf16 v[72:75], a[212:215], v[36:39], v[72:75]
s_waitcnt lgkmcnt(12)
ds_read_b64_tr_b16 a[244:245], v10 offset:25600
ds_read_b64_tr_b16 a[246:247], v10 offset:29696
v_exp_f32 v23, v23
v_mfma_f32_16x16x32_bf16 v[76:79], a[216:219], v[36:39], v[76:79]
ds_read_b64_tr_b16 a[248:249], v11 offset:25600
ds_read_b64_tr_b16 a[250:251], v11 offset:29696
v_cvt_pk_bf16_f32 v43, v22, v23
v_mfma_f32_16x16x32_bf16 v[76:79], a[220:223], v[32:35], v[76:79]
s_waitcnt lgkmcnt(11)
ds_read_b64_tr_b16 a[252:253], v11 offset:17408
ds_read_b64_tr_b16 a[254:255], v11 offset:21504
v_exp_f32 v24, v24
v_mfma_f32_16x16x32_bf16 v[80:83], a[224:227], v[32:35], v[80:83]
buffer_load_dwordx4 v[224:227], v248, s[12:15], s77 offen nt
v_mfma_f32_16x16x32_bf16 v[80:83], a[228:231], v[36:39], v[80:83]
s_waitcnt lgkmcnt(9)
v_exp_f32 v25, v25
v_mfma_f32_16x16x32_bf16 v[84:87], a[232:235], v[36:39], v[84:87]
v_cvt_pk_bf16_f32 v44, v24, v25
v_mfma_f32_16x16x32_bf16 v[84:87], a[236:239], v[32:35], v[84:87]
s_waitcnt lgkmcnt(4)
v_exp_f32 v26, v26
v_mfma_f32_16x16x32_bf16 v[88:91], a[240:243], v[32:35], v[88:91]
v_mfma_f32_16x16x32_bf16 v[88:91], a[244:247], v[36:39], v[88:91]
s_waitcnt lgkmcnt(0)
v_exp_f32 v27, v27
v_mfma_f32_16x16x32_bf16 v[92:95], a[248:251], v[36:39], v[92:95]
buffer_load_dwordx4 v[228:231], v249, s[12:15], s77 offen nt
v_cvt_pk_bf16_f32 v45, v26, v27
v_mfma_f32_16x16x32_bf16 v[92:95], a[252:255], v[32:35], v[92:95]
v_exp_f32 v28, v28
v_mfma_f32_16x16x32_bf16 v[16:19], a[128:131], a[32:35], -4.0
s_barrier
v_mfma_f32_16x16x32_bf16 v[16:19], a[132:135], a[36:39], v[16:19]
s_add_u32 m0, s24, 0x4000
v_exp_f32 v29, v29
v_mfma_f32_16x16x32_bf16 v[16:19], a[136:139], a[40:43], v[16:19]
s_waitcnt vmcnt(10)
v_lshlrev_b32 v232, 16, v200
v_and_b32 v233, 0xffff0000, v200
v_mfma_f32_16x16x32_bf16 v[16:19], a[140:143], a[44:47], v[16:19]
v_exp_f32 v30, v30
v_mfma_f32_16x16x32_bf16 v[20:23], a[144:147], a[44:47], -4.0
buffer_load_dwordx4 v2, s[16:19], s74 offen offset:0 lds
v_cvt_pk_bf16_f32 v46, v28, v29
v_mfma_f32_16x16x32_bf16 v[20:23], a[148:151], a[40:43], v[20:23]
v_exp_f32 v31, v31
v_mfma_f32_16x16x32_bf16 v[20:23], a[152:155], a[36:39], v[20:23]
v_cvt_pk_bf16_f32 v47, v30, v31
v_lshlrev_b32 v234, 16, v201
v_mfma_f32_16x16x32_bf16 v[20:23], a[156:159], a[32:35], v[20:23]
L_pg1:
s_cbranch_vccnz L_pg5
v_exp_f32 v16, v16
v_mfma_f32_16x16x32_bf16 v[24:27], a[160:163], a[32:35], -4.0
v_and_b32 v235, 0xffff0000, v201
v_lshlrev_b32 v236, 16, v202
v_and_b32 v237, 0xffff0000, v202
v_lshlrev_b32 v238, 16, v203
v_and_b32 v239, 0xffff0000, v203
v_pk_mul_f32 v[232:233], v[232:233], v[250:251] op_sel_hi:[1,0]
v_pk_mul_f32 v[234:235], v[234:235], v[250:251] op_sel_hi:[1,0]
v_pk_mul_f32 v[236:237], v[236:237], v[250:251] op_sel_hi:[1,0]
v_pk_mul_f32 v[238:239], v[238:239], v[250:251] op_sel_hi:[1,0]
v_mfma_f32_16x16x32_bf16 v[24:27], a[164:167], a[36:39], v[24:27]
v_exp_f32 v17, v17
v_mfma_f32_16x16x32_bf16 v[24:27], a[168:171], a[40:43], v[24:27]
buffer_load_dwordx4 v2, s[16:19], s74 offen offset:2048 lds
v_cvt_pk_bf16_f32 v32, v16, v17
v_mfma_f32_16x16x32_bf16 v[24:27], a[172:175], a[44:47], v[24:27]
s_add_u32 m0, s24, 0x6000
v_exp_f32 v18, v18
v_mfma_f32_16x16x32_bf16 v[28:31], a[176:179], a[44:47], -4.0
v_cvt_pk_bf16_f32 v200, v232, v233
v_cvt_pk_bf16_f32 v201, v234, v235
v_mfma_f32_16x16x32_bf16 v[28:31], a[180:183], a[40:43], v[28:31]
v_exp_f32 v19, v19
v_mfma_f32_16x16x32_bf16 v[28:31], a[184:187], a[36:39], v[28:31]
v_cvt_pk_bf16_f32 v33, v18, v19
v_cvt_pk_bf16_f32 v202, v236, v237
v_mfma_f32_16x16x32_bf16 v[28:31], a[188:191], a[32:35], v[28:31]
v_exp_f32 v20, v20
v_smfmac_f32_16x16x64_bf16 v[52:55], v[12:15], v[40:47], v1
buffer_load_dwordx4 v2, s[16:19], s75 offen offset:0 lds
v_mfma_f32_16x16x32_bf16 v[96:99], a[192:195], v[40:43], v[96:99]
v_cvt_pk_bf16_f32 v203, v238, v239
v_lshlrev_b32 v232, 16, v204
v_mfma_f32_16x16x32_bf16 v[96:99], a[196:199], v[44:47], v[96:99]
v_exp_f32 v21, v21
v_mfma_f32_16x16x32_bf16 v[100:103], a[200:203], v[44:47], v[100:103]
ds_write_b128 v251, v[200:203] offset:49152
v_cvt_pk_bf16_f32 v34, v20, v21
v_mfma_f32_16x16x32_bf16 v[100:103], a[204:207], v[40:43], v[100:103]
v_exp_f32 v22, v22
v_mfma_f32_16x16x32_bf16 v[104:107], a[208:211], v[40:43], v[104:107]
v_and_b32 v233, 0xffff0000, v204
v_lshlrev_b32 v234, 16, v205
v_mfma_f32_16x16x32_bf16 v[104:107], a[212:215], v[44:47], v[104:107]
v_exp_f32 v23, v23
v_mfma_f32_16x16x32_bf16 v[108:111], a[216:219], v[44:47], v[108:111]
buffer_load_dwordx4 v2, s[16:19], s75 offen offset:2048 lds
v_cvt_pk_bf16_f32 v35, v22, v23
v_mfma_f32_16x16x32_bf16 v[108:111], a[220:223], v[40:43], v[108:111]
v_exp_f32 v24, v24
v_mfma_f32_16x16x32_bf16 v[112:115], a[224:227], v[40:43], v[112:115]
v_and_b32 v235, 0xffff0000, v205
v_lshlrev_b32 v236, 16, v206
v_and_b32 v237, 0xffff0000, v206
v_lshlrev_b32 v238, 16, v207
v_and_b32 v239, 0xffff0000, v207
v_pk_mul_f32 v[232:233], v[232:233], v[250:251] op_sel_hi:[1,0]
v_pk_mul_f32 v[234:235], v[234:235], v[250:251] op_sel_hi:[1,0]
v_pk_mul_f32 v[236:237], v[236:237], v[250:251] op_sel_hi:[1,0]
v_pk_mul_f32 v[238:239], v[238:239], v[250:251] op_sel_hi:[1,0]
v_mfma_f32_16x16x32_bf16 v[112:115], a[228:231], v[44:47], v[112:115]
v_exp_f32 v25, v25
v_mfma_f32_16x16x32_bf16 v[116:119], a[232:235], v[44:47], v[116:119]
v_cvt_pk_bf16_f32 v36, v24, v25
v_cvt_pk_bf16_f32 v204, v232, v233
v_mfma_f32_16x16x32_bf16 v[116:119], a[236:239], v[40:43], v[116:119]
v_exp_f32 v26, v26
v_mfma_f32_16x16x32_bf16 v[120:123], a[240:243], v[40:43], v[120:123]
buffer_load_dwordx4 v[192:195], v248, s[12:15], s78 offen nt
v_cvt_pk_bf16_f32 v205, v234, v235
v_mfma_f32_16x16x32_bf16 v[120:123], a[244:247], v[44:47], v[120:123]
v_exp_f32 v27, v27
v_mfma_f32_16x16x32_bf16 v[124:127], a[248:251], v[44:47], v[124:127]
v_cvt_pk_bf16_f32 v37, v26, v27
v_cvt_pk_bf16_f32 v206, v236, v237
v_mfma_f32_16x16x32_bf16 v[124:127], a[252:255], v[40:43], v[124:127]
v_exp_f32 v28, v28
v_mfma_f32_16x16x32_bf16 v[16:19], a[128:131], a[48:51], -4.0
ds_read_b128 a[128:131], v4 offset:32768
v_cvt_pk_bf16_f32 v207, v238, v239
v_mfma_f32_16x16x32_bf16 v[16:19], a[132:135], a[52:55], v[16:19]
v_exp_f32 v29, v29
v_mfma_f32_16x16x32_bf16 v[16:19], a[136:139], a[56:59], v[16:19]
ds_read_b128 a[132:135], v5 offset:32768
buffer_load_dwordx4 v[196:199], v249, s[12:15], s78 offen nt
v_mfma_f32_16x16x32_bf16 v[16:19], a[140:143], a[60:63], v[16:19]
v_exp_f32 v30, v30
v_mfma_f32_16x16x32_bf16 v[20:23], a[144:147], a[60:63], -4.0
ds_read_b128 a[136:139], v6 offset:32768
v_cvt_pk_bf16_f32 v38, v28, v29
v_mfma_f32_16x16x32_bf16 v[20:23], a[148:151], a[56:59], v[20:23]
v_exp_f32 v31, v31
v_mfma_f32_16x16x32_bf16 v[20:23], a[152:155], a[52:55], v[20:23]
ds_read_b128 a[140:143], v7 offset:32768
v_cvt_pk_bf16_f32 v39, v30, v31
v_mfma_f32_16x16x32_bf16 v[20:23], a[156:159], a[48:51], v[20:23]
v_exp_f32 v16, v16
v_mfma_f32_16x16x32_bf16 v[24:27], a[160:163], a[48:51], -4.0
s_waitcnt vmcnt(14)
ds_read_b128 a[144:147], v7 offset:36864
v_lshlrev_b32 v232, 16, v208
v_mfma_f32_16x16x32_bf16 v[24:27], a[164:167], a[52:55], v[24:27]
v_exp_f32 v17, v17
v_mfma_f32_16x16x32_bf16 v[24:27], a[168:171], a[56:59], v[24:27]
ds_read_b128 a[148:151], v6 offset:36864
v_cvt_pk_bf16_f32 v40, v16, v17
v_mfma_f32_16x16x32_bf16 v[24:27], a[172:175], a[60:63], v[24:27]
v_exp_f32 v18, v18
v_mfma_f32_16x16x32_bf16 v[28:31], a[176:179], a[60:63], -4.0
ds_read_b128 a[152:155], v5 offset:36864
v_and_b32 v233, 0xffff0000, v208
v_mfma_f32_16x16x32_bf16 v[28:31], a[180:183], a[56:59], v[28:31]
v_exp_f32 v19, v19
v_mfma_f32_16x16x32_bf16 v[28:31], a[184:187], a[52:55], v[28:31]
ds_read_b128 a[156:159], v4 offset:36864
v_cvt_pk_bf16_f32 v41, v18, v19
v_mfma_f32_16x16x32_bf16 v[28:31], a[188:191], a[48:51], v[28:31]
v_exp_f32 v20, v20
v_smfmac_f32_16x16x64_bf16 v[56:59], v[12:15], v[32:39], v1
ds_read_b128 a[160:163], v4 offset:40960
v_mfma_f32_16x16x32_bf16 v[128:131], a[192:195], v[32:35], v[128:131]
ds_read_b128 a[164:167], v5 offset:40960
v_lshlrev_b32 v234, 16, v209
v_mfma_f32_16x16x32_bf16 v[128:131], a[196:199], v[36:39], v[128:131]
v_exp_f32 v21, v21
v_mfma_f32_16x16x32_bf16 v[132:135], a[200:203], v[36:39], v[132:135]
ds_read_b128 a[168:171], v6 offset:40960
v_cvt_pk_bf16_f32 v42, v20, v21
v_mfma_f32_16x16x32_bf16 v[132:135], a[204:207], v[32:35], v[132:135]
v_exp_f32 v22, v22
v_mfma_f32_16x16x32_bf16 v[136:139], a[208:211], v[32:35], v[136:139]
ds_read_b128 a[172:175], v7 offset:40960
v_and_b32 v235, 0xffff0000, v209
v_lshlrev_b32 v236, 16, v210
v_and_b32 v237, 0xffff0000, v210
v_lshlrev_b32 v238, 16, v211
v_and_b32 v239, 0xffff0000, v211
v_pk_mul_f32 v[232:233], v[232:233], v[250:251] op_sel_hi:[1,0]
v_pk_mul_f32 v[234:235], v[234:235], v[250:251] op_sel_hi:[1,0]
v_pk_mul_f32 v[236:237], v[236:237], v[250:251] op_sel_hi:[1,0]
v_pk_mul_f32 v[238:239], v[238:239], v[250:251] op_sel_hi:[1,0]
v_mfma_f32_16x16x32_bf16 v[136:139], a[212:215], v[36:39], v[136:139]
v_exp_f32 v23, v23
v_mfma_f32_16x16x32_bf16 v[140:143], a[216:219], v[36:39], v[140:143]
ds_read_b128 a[176:179], v7 offset:45056
v_cvt_pk_bf16_f32 v43, v22, v23
v_mfma_f32_16x16x32_bf16 v[140:143], a[220:223], v[32:35], v[140:143]
v_exp_f32 v24, v24
v_mfma_f32_16x16x32_bf16 v[144:147], a[224:227], v[32:35], v[144:147]
ds_write_b128 v251, v[204:207] offset:53248
v_mfma_f32_16x16x32_bf16 v[144:147], a[228:231], v[36:39], v[144:147]
v_exp_f32 v25, v25
v_mfma_f32_16x16x32_bf16 v[148:151], a[232:235], v[36:39], v[148:151]
ds_read_b128 a[180:183], v6 offset:45056
v_cvt_pk_bf16_f32 v44, v24, v25
v_mfma_f32_16x16x32_bf16 v[148:151], a[236:239], v[32:35], v[148:151]
v_exp_f32 v26, v26
v_mfma_f32_16x16x32_bf16 v[152:155], a[240:243], v[32:35], v[152:155]
ds_read_b128 a[184:187], v5 offset:45056
v_cvt_pk_bf16_f32 v208, v232, v233
v_mfma_f32_16x16x32_bf16 v[152:155], a[244:247], v[36:39], v[152:155]
v_exp_f32 v27, v27
v_mfma_f32_16x16x32_bf16 v[156:159], a[248:251], v[36:39], v[156:159]
ds_read_b128 a[188:191], v4 offset:45056
v_cvt_pk_bf16_f32 v45, v26, v27
v_mfma_f32_16x16x32_bf16 v[156:159], a[252:255], v[32:35], v[156:159]
s_waitcnt lgkmcnt(13)
v_exp_f32 v28, v28
v_mfma_f32_16x16x32_bf16 v[16:19], a[128:131], a[0:3], -4.0
v_cvt_pk_bf16_f32 v209, v234, v235
v_cvt_pk_bf16_f32 v210, v236, v237
v_mfma_f32_16x16x32_bf16 v[16:19], a[132:135], a[4:7], v[16:19]
v_exp_f32 v29, v29
v_mfma_f32_16x16x32_bf16 v[16:19], a[136:139], a[8:11], v[16:19]
v_cvt_pk_bf16_f32 v211, v238, v239
v_lshlrev_b32 v232, 16, v212
v_mfma_f32_16x16x32_bf16 v[16:19], a[140:143], a[12:15], v[16:19]
s_waitcnt lgkmcnt(9)
v_exp_f32 v30, v30
v_mfma_f32_16x16x32_bf16 v[20:23], a[144:147], a[12:15], -4.0
ds_write_b128 v251, v[208:211] offset:57344
v_cvt_pk_bf16_f32 v46, v28, v29
v_mfma_f32_16x16x32_bf16 v[20:23], a[148:151], a[8:11], v[20:23]
v_exp_f32 v31, v31
v_mfma_f32_16x16x32_bf16 v[20:23], a[152:155], a[4:7], v[20:23]
v_cvt_pk_bf16_f32 v47, v30, v31
v_and_b32 v233, 0xffff0000, v212
v_mfma_f32_16x16x32_bf16 v[20:23], a[156:159], a[0:3], v[20:23]
s_waitcnt lgkmcnt(6)
v_exp_f32 v16, v16
v_mfma_f32_16x16x32_bf16 v[24:27], a[160:163], a[0:3], -4.0
v_lshlrev_b32 v234, 16, v213
v_and_b32 v235, 0xffff0000, v213
v_lshlrev_b32 v236, 16, v214
v_and_b32 v237, 0xffff0000, v214
v_lshlrev_b32 v238, 16, v215
v_and_b32 v239, 0xffff0000, v215
v_pk_mul_f32 v[232:233], v[232:233], v[250:251] op_sel_hi:[1,0]
v_pk_mul_f32 v[234:235], v[234:235], v[250:251] op_sel_hi:[1,0]
v_pk_mul_f32 v[236:237], v[236:237], v[250:251] op_sel_hi:[1,0]
v_pk_mul_f32 v[238:239], v[238:239], v[250:251] op_sel_hi:[1,0]
v_mfma_f32_16x16x32_bf16 v[24:27], a[164:167], a[4:7], v[24:27]
v_exp_f32 v17, v17
v_mfma_f32_16x16x32_bf16 v[24:27], a[168:171], a[8:11], v[24:27]
v_cvt_pk_bf16_f32 v32, v16, v17
v_cvt_pk_bf16_f32 v212, v232, v233
v_mfma_f32_16x16x32_bf16 v[24:27], a[172:175], a[12:15], v[24:27]
s_waitcnt lgkmcnt(1)
v_exp_f32 v18, v18
v_mfma_f32_16x16x32_bf16 v[28:31], a[176:179], a[12:15], -4.0
v_cvt_pk_bf16_f32 v213, v234, v235
v_cvt_pk_bf16_f32 v214, v236, v237
v_mfma_f32_16x16x32_bf16 v[28:31], a[180:183], a[8:11], v[28:31]
v_exp_f32 v19, v19
v_mfma_f32_16x16x32_bf16 v[28:31], a[184:187], a[4:7], v[28:31]
v_cvt_pk_bf16_f32 v33, v18, v19
v_cvt_pk_bf16_f32 v215, v238, v239
v_mfma_f32_16x16x32_bf16 v[28:31], a[188:191], a[0:3], v[28:31]
s_waitcnt vmcnt(10)
v_exp_f32 v20, v20
v_smfmac_f32_16x16x64_bf16 v[60:63], v[12:15], v[40:47], v1
s_barrier
v_mfma_f32_16x16x32_bf16 v[160:163], a[192:195], v[40:43], v[160:163]
ds_read_b64_tr_b16 a[192:193], v8 offset:0
ds_read_b64_tr_b16 a[194:195], v8 offset:4096
v_mfma_f32_16x16x32_bf16 v[160:163], a[196:199], v[44:47], v[160:163]
v_exp_f32 v21, v21
v_mfma_f32_16x16x32_bf16 v[164:167], a[200:203], v[44:47], v[164:167]
ds_read_b64_tr_b16 a[196:197], v8 offset:8192
v_cvt_pk_bf16_f32 v34, v20, v21
v_mfma_f32_16x16x32_bf16 v[164:167], a[204:207], v[40:43], v[164:167]
v_exp_f32 v22, v22
v_mfma_f32_16x16x32_bf16 v[168:171], a[208:211], v[40:43], v[168:171]
ds_read_b64_tr_b16 a[198:199], v8 offset:12288
ds_read_b64_tr_b16 a[200:201], v9 offset:8192
v_mfma_f32_16x16x32_bf16 v[168:171], a[212:215], v[44:47], v[168:171]
v_exp_f32 v23, v23
v_mfma_f32_16x16x32_bf16 v[172:175], a[216:219], v[44:47], v[172:175]
ds_read_b64_tr_b16 a[202:203], v9 offset:12288
v_cvt_pk_bf16_f32 v35, v22, v23
v_mfma_f32_16x16x32_bf16 v[172:175], a[220:223], v[40:43], v[172:175]
v_exp_f32 v24, v24
v_mfma_f32_16x16x32_bf16 v[176:179], a[224:227], v[40:43], v[176:179]
ds_read_b64_tr_b16 a[204:205], v9 offset:0
ds_read_b64_tr_b16 a[206:207], v9 offset:4096
v_mfma_f32_16x16x32_bf16 v[176:179], a[228:231], v[44:47], v[176:179]
v_exp_f32 v25, v25
v_mfma_f32_16x16x32_bf16 v[180:183], a[232:235], v[44:47], v[180:183]
ds_read_b64_tr_b16 a[208:209], v10 offset:0
v_cvt_pk_bf16_f32 v36, v24, v25
v_mfma_f32_16x16x32_bf16 v[180:183], a[236:239], v[40:43], v[180:183]
v_exp_f32 v26, v26
v_mfma_f32_16x16x32_bf16 v[184:187], a[240:243], v[40:43], v[184:187]
ds_read_b64_tr_b16 a[210:211], v10 offset:4096
ds_read_b64_tr_b16 a[212:213], v10 offset:8192
v_mfma_f32_16x16x32_bf16 v[184:187], a[244:247], v[44:47], v[184:187]
v_exp_f32 v27, v27
v_mfma_f32_16x16x32_bf16 v[188:191], a[248:251], v[44:47], v[188:191]
ds_read_b64_tr_b16 a[214:215], v10 offset:12288
v_cvt_pk_bf16_f32 v37, v26, v27
v_mfma_f32_16x16x32_bf16 v[188:191], a[252:255], v[40:43], v[188:191]
v_exp_f32 v28, v28
v_mfma_f32_16x16x32_bf16 v[16:19], a[128:131], a[16:19], -4.0
ds_read_b64_tr_b16 a[216:217], v11 offset:8192
ds_read_b64_tr_b16 a[218:219], v11 offset:12288
v_mfma_f32_16x16x32_bf16 v[16:19], a[132:135], a[20:23], v[16:19]
v_exp_f32 v29, v29
v_mfma_f32_16x16x32_bf16 v[16:19], a[136:139], a[24:27], v[16:19]
ds_read_b64_tr_b16 a[220:221], v11 offset:0
ds_read_b64_tr_b16 a[222:223], v11 offset:4096
v_mfma_f32_16x16x32_bf16 v[16:19], a[140:143], a[28:31], v[16:19]
v_exp_f32 v30, v30
v_mfma_f32_16x16x32_bf16 v[20:23], a[144:147], a[28:31], -4.0
ds_read_b64_tr_b16 a[224:225], v8 offset:1024
v_cvt_pk_bf16_f32 v38, v28, v29
v_mfma_f32_16x16x32_bf16 v[20:23], a[148:151], a[24:27], v[20:23]
v_exp_f32 v31, v31
v_mfma_f32_16x16x32_bf16 v[20:23], a[152:155], a[20:23], v[20:23]
ds_read_b64_tr_b16 a[226:227], v8 offset:5120
v_cvt_pk_bf16_f32 v39, v30, v31
v_mfma_f32_16x16x32_bf16 v[20:23], a[156:159], a[16:19], v[20:23]
v_exp_f32 v16, v16
v_mfma_f32_16x16x32_bf16 v[24:27], a[160:163], a[16:19], -4.0
ds_read_b64_tr_b16 a[228:229], v8 offset:9216
ds_read_b64_tr_b16 a[230:231], v8 offset:13312
v_mfma_f32_16x16x32_bf16 v[24:27], a[164:167], a[20:23], v[24:27]
v_exp_f32 v17, v17
v_mfma_f32_16x16x32_bf16 v[24:27], a[168:171], a[24:27], v[24:27]
ds_read_b64_tr_b16 a[232:233], v9 offset:9216
v_cvt_pk_bf16_f32 v40, v16, v17
v_mfma_f32_16x16x32_bf16 v[24:27], a[172:175], a[28:31], v[24:27]
v_exp_f32 v18, v18
v_mfma_f32_16x16x32_bf16 v[28:31], a[176:179], a[28:31], -4.0
ds_read_b64_tr_b16 a[234:235], v9 offset:13312
ds_read_b64_tr_b16 a[236:237], v9 offset:1024
v_mfma_f32_16x16x32_bf16 v[28:31], a[180:183], a[24:27], v[28:31]
v_exp_f32 v19, v19
v_mfma_f32_16x16x32_bf16 v[28:31], a[184:187], a[20:23], v[28:31]
ds_read_b64_tr_b16 a[238:239], v9 offset:5120
v_cvt_pk_bf16_f32 v41, v18, v19
v_mfma_f32_16x16x32_bf16 v[28:31], a[188:191], a[16:19], v[28:31]
v_exp_f32 v20, v20
v_smfmac_f32_16x16x64_bf16 v[48:51], v[12:15], v[32:39], v1
s_waitcnt lgkmcnt(15)
ds_read_b64_tr_b16 a[240:241], v10 offset:1024
v_mfma_f32_16x16x32_bf16 v[64:67], a[192:195], v[32:35], v[64:67]
ds_read_b64_tr_b16 a[242:243], v10 offset:5120
ds_read_b64_tr_b16 a[244:245], v10 offset:9216
v_mfma_f32_16x16x32_bf16 v[64:67], a[196:199], v[36:39], v[64:67]
v_exp_f32 v21, v21
v_mfma_f32_16x16x32_bf16 v[68:71], a[200:203], v[36:39], v[68:71]
ds_write_b128 v251, v[212:215] offset:61440
v_cvt_pk_bf16_f32 v42, v20, v21
v_mfma_f32_16x16x32_bf16 v[68:71], a[204:207], v[32:35], v[68:71]
s_waitcnt lgkmcnt(15)
v_exp_f32 v22, v22
v_mfma_f32_16x16x32_bf16 v[72:75], a[208:211], v[32:35], v[72:75]
ds_read_b64_tr_b16 a[246:247], v10 offset:13312
ds_read_b64_tr_b16 a[248:249], v11 offset:9216
v_mfma_f32_16x16x32_bf16 v[72:75], a[212:215], v[36:39], v[72:75]
s_waitcnt lgkmcnt(14)
v_exp_f32 v23, v23
v_mfma_f32_16x16x32_bf16 v[76:79], a[216:219], v[36:39], v[76:79]
ds_read_b64_tr_b16 a[250:251], v11 offset:13312
v_cvt_pk_bf16_f32 v43, v22, v23
v_mfma_f32_16x16x32_bf16 v[76:79], a[220:223], v[32:35], v[76:79]
s_waitcnt lgkmcnt(11)
ds_read_b64_tr_b16 a[252:253], v11 offset:1024
ds_read_b64_tr_b16 a[254:255], v11 offset:5120
v_exp_f32 v24, v24
v_mfma_f32_16x16x32_bf16 v[80:83], a[224:227], v[32:35], v[80:83]
buffer_load_dwordx4 v[200:203], v248, s[12:15], s79 offen nt
v_add_u32 v251, 0x10000, v251
v_mfma_f32_16x16x32_bf16 v[80:83], a[228:231], v[36:39], v[80:83]
s_waitcnt lgkmcnt(9)
v_exp_f32 v25, v25
v_mfma_f32_16x16x32_bf16 v[84:87], a[232:235], v[36:39], v[84:87]
s_waitcnt vmcnt(9)
v_cvt_pk_bf16_f32 v44, v24, v25
v_lshlrev_b32 v232, 16, v216
v_mfma_f32_16x16x32_bf16 v[84:87], a[236:239], v[32:35], v[84:87]
s_waitcnt lgkmcnt(4)
v_exp_f32 v26, v26
v_mfma_f32_16x16x32_bf16 v[88:91], a[240:243], v[32:35], v[88:91]
v_and_b32 v233, 0xffff0000, v216
v_lshlrev_b32 v234, 16, v217
v_mfma_f32_16x16x32_bf16 v[88:91], a[244:247], v[36:39], v[88:91]
s_waitcnt lgkmcnt(0)
v_exp_f32 v27, v27
v_mfma_f32_16x16x32_bf16 v[92:95], a[248:251], v[36:39], v[92:95]
buffer_load_dwordx4 v[204:207], v249, s[12:15], s79 offen nt
v_cvt_pk_bf16_f32 v45, v26, v27
v_mfma_f32_16x16x32_bf16 v[92:95], a[252:255], v[32:35], v[92:95]
v_exp_f32 v28, v28
v_mfma_f32_16x16x32_bf16 v[16:19], a[128:131], a[32:35], -4.0
s_barrier
v_mfma_f32_16x16x32_bf16 v[16:19], a[132:135], a[36:39], v[16:19]
s_add_u32 m0, s24, 0x0
v_exp_f32 v29, v29
v_mfma_f32_16x16x32_bf16 v[16:19], a[136:139], a[40:43], v[16:19]
v_and_b32 v235, 0xffff0000, v217
v_lshlrev_b32 v236, 16, v218
v_and_b32 v237, 0xffff0000, v218
v_lshlrev_b32 v238, 16, v219
v_and_b32 v239, 0xffff0000, v219
v_pk_mul_f32 v[232:233], v[232:233], v[250:251] op_sel_hi:[1,0]
v_pk_mul_f32 v[234:235], v[234:235], v[250:251] op_sel_hi:[1,0]
v_pk_mul_f32 v[236:237], v[236:237], v[250:251] op_sel_hi:[1,0]
v_pk_mul_f32 v[238:239], v[238:239], v[250:251] op_sel_hi:[1,0]
v_mfma_f32_16x16x32_bf16 v[16:19], a[140:143], a[44:47], v[16:19]
v_exp_f32 v30, v30
v_mfma_f32_16x16x32_bf16 v[20:23], a[144:147], a[44:47], -4.0
buffer_load_dwordx4 v2, s[16:19], s76 offen offset:0 lds
v_cvt_pk_bf16_f32 v46, v28, v29
v_mfma_f32_16x16x32_bf16 v[20:23], a[148:151], a[40:43], v[20:23]
v_exp_f32 v31, v31
v_mfma_f32_16x16x32_bf16 v[20:23], a[152:155], a[36:39], v[20:23]
v_cvt_pk_bf16_f32 v47, v30, v31
v_cvt_pk_bf16_f32 v216, v232, v233
v_mfma_f32_16x16x32_bf16 v[20:23], a[156:159], a[32:35], v[20:23]
v_exp_f32 v16, v16
v_mfma_f32_16x16x32_bf16 v[24:27], a[160:163], a[32:35], -4.0
v_cvt_pk_bf16_f32 v217, v234, v235
v_cvt_pk_bf16_f32 v218, v236, v237
v_mfma_f32_16x16x32_bf16 v[24:27], a[164:167], a[36:39], v[24:27]
v_exp_f32 v17, v17
v_mfma_f32_16x16x32_bf16 v[24:27], a[168:171], a[40:43], v[24:27]
buffer_load_dwordx4 v2, s[16:19], s76 offen offset:2048 lds
v_cvt_pk_bf16_f32 v32, v16, v17
v_mfma_f32_16x16x32_bf16 v[24:27], a[172:175], a[44:47], v[24:27]
s_add_u32 m0, s24, 0x2000
v_exp_f32 v18, v18
v_mfma_f32_16x16x32_bf16 v[28:31], a[176:179], a[44:47], -4.0
v_cvt_pk_bf16_f32 v219, v238, v239
v_lshlrev_b32 v232, 16, v220
v_mfma_f32_16x16x32_bf16 v[28:31], a[180:183], a[40:43], v[28:31]
v_exp_f32 v19, v19
v_mfma_f32_16x16x32_bf16 v[28:31], a[184:187], a[36:39], v[28:31]
ds_write_b128 v251, v[216:219] offset:0
v_cvt_pk_bf16_f32 v33, v18, v19
v_mfma_f32_16x16x32_bf16 v[28:31], a[188:191], a[32:35], v[28:31]
v_exp_f32 v20, v20
v_smfmac_f32_16x16x64_bf16 v[52:55], v[12:15], v[40:47], v1
buffer_load_dwordx4 v2, s[16:19], s77 offen offset:0 lds
v_mfma_f32_16x16x32_bf16 v[96:99], a[192:195], v[40:43], v[96:99]
v_and_b32 v233, 0xffff0000, v220
v_lshlrev_b32 v234, 16, v221
v_mfma_f32_16x16x32_bf16 v[96:99], a[196:199], v[44:47], v[96:99]
v_exp_f32 v21, v21
v_mfma_f32_16x16x32_bf16 v[100:103], a[200:203], v[44:47], v[100:103]
v_cvt_pk_bf16_f32 v34, v20, v21
v_and_b32 v235, 0xffff0000, v221
v_lshlrev_b32 v236, 16, v222
v_and_b32 v237, 0xffff0000, v222
v_lshlrev_b32 v238, 16, v223
v_and_b32 v239, 0xffff0000, v223
v_pk_mul_f32 v[232:233], v[232:233], v[250:251] op_sel_hi:[1,0]
v_pk_mul_f32 v[234:235], v[234:235], v[250:251] op_sel_hi:[1,0]
v_pk_mul_f32 v[236:237], v[236:237], v[250:251] op_sel_hi:[1,0]
v_pk_mul_f32 v[238:239], v[238:239], v[250:251] op_sel_hi:[1,0]
v_mfma_f32_16x16x32_bf16 v[100:103], a[204:207], v[40:43], v[100:103]
v_exp_f32 v22, v22
v_mfma_f32_16x16x32_bf16 v[104:107], a[208:211], v[40:43], v[104:107]
v_cvt_pk_bf16_f32 v220, v232, v233
v_cvt_pk_bf16_f32 v221, v234, v235
v_mfma_f32_16x16x32_bf16 v[104:107], a[212:215], v[44:47], v[104:107]
v_exp_f32 v23, v23
v_mfma_f32_16x16x32_bf16 v[108:111], a[216:219], v[44:47], v[108:111]
buffer_load_dwordx4 v2, s[16:19], s77 offen offset:2048 lds
v_cvt_pk_bf16_f32 v35, v22, v23
v_mfma_f32_16x16x32_bf16 v[108:111], a[220:223], v[40:43], v[108:111]
v_exp_f32 v24, v24
v_mfma_f32_16x16x32_bf16 v[112:115], a[224:227], v[40:43], v[112:115]
v_cvt_pk_bf16_f32 v222, v236, v237
v_cvt_pk_bf16_f32 v223, v238, v239
v_mfma_f32_16x16x32_bf16 v[112:115], a[228:231], v[44:47], v[112:115]
v_exp_f32 v25, v25
v_mfma_f32_16x16x32_bf16 v[116:119], a[232:235], v[44:47], v[116:119]
ds_write_b128 v251, v[220:223] offset:4096
v_cvt_pk_bf16_f32 v36, v24, v25
v_mfma_f32_16x16x32_bf16 v[116:119], a[236:239], v[40:43], v[116:119]
v_exp_f32 v26, v26
v_mfma_f32_16x16x32_bf16 v[120:123], a[240:243], v[40:43], v[120:123]
s_waitcnt vmcnt(12)
buffer_load_dwordx4 v[208:211], v248, s[12:15], s80 offen nt
v_lshlrev_b32 v232, 16, v224
v_mfma_f32_16x16x32_bf16 v[120:123], a[244:247], v[44:47], v[120:123]
v_exp_f32 v27, v27
v_mfma_f32_16x16x32_bf16 v[124:127], a[248:251], v[44:47], v[124:127]
v_cvt_pk_bf16_f32 v37, v26, v27
v_and_b32 v233, 0xffff0000, v224
v_mfma_f32_16x16x32_bf16 v[124:127], a[252:255], v[40:43], v[124:127]
v_exp_f32 v28, v28
v_mfma_f32_16x16x32_bf16 v[16:19], a[128:131], a[48:51], -4.0
ds_read_b128 a[128:131], v4 offset:49152
v_lshlrev_b32 v234, 16, v225
v_mfma_f32_16x16x32_bf16 v[16:19], a[132:135], a[52:55], v[16:19]
v_exp_f32 v29, v29
v_mfma_f32_16x16x32_bf16 v[16:19], a[136:139], a[56:59], v[16:19]
ds_read_b128 a[132:135], v5 offset:49152
buffer_load_dwordx4 v[212:215], v249, s[12:15], s80 offen nt
v_mfma_f32_16x16x32_bf16 v[16:19], a[140:143], a[60:63], v[16:19]
v_exp_f32 v30, v30
v_mfma_f32_16x16x32_bf16 v[20:23], a[144:147], a[60:63], -4.0
ds_read_b128 a[136:139], v6 offset:49152
v_cvt_pk_bf16_f32 v38, v28, v29
v_mfma_f32_16x16x32_bf16 v[20:23], a[148:151], a[56:59], v[20:23]
v_exp_f32 v31, v31
v_mfma_f32_16x16x32_bf16 v[20:23], a[152:155], a[52:55], v[20:23]
ds_read_b128 a[140:143], v7 offset:49152
v_cvt_pk_bf16_f32 v39, v30, v31
v_mfma_f32_16x16x32_bf16 v[20:23], a[156:159], a[48:51], v[20:23]
v_exp_f32 v16, v16
v_mfma_f32_16x16x32_bf16 v[24:27], a[160:163], a[48:51], -4.0
ds_read_b128 a[144:147], v7 offset:53248
buffer_load_dwordx4 a[64:67], v0, s[8:11], s36 offen offset:0 nt
v_mfma_f32_16x16x32_bf16 v[24:27], a[164:167], a[52:55], v[24:27]
v_exp_f32 v17, v17
v_mfma_f32_16x16x32_bf16 v[24:27], a[168:171], a[56:59], v[24:27]
ds_read_b128 a[148:151], v6 offset:53248
v_cvt_pk_bf16_f32 v40, v16, v17
v_mfma_f32_16x16x32_bf16 v[24:27], a[172:175], a[60:63], v[24:27]
v_exp_f32 v18, v18
v_mfma_f32_16x16x32_bf16 v[28:31], a[176:179], a[60:63], -4.0
ds_read_b128 a[152:155], v5 offset:53248
v_and_b32 v235, 0xffff0000, v225
v_lshlrev_b32 v236, 16, v226
v_and_b32 v237, 0xffff0000, v226
v_lshlrev_b32 v238, 16, v227
v_and_b32 v239, 0xffff0000, v227
v_pk_mul_f32 v[232:233], v[232:233], v[250:251] op_sel_hi:[1,0]
v_pk_mul_f32 v[234:235], v[234:235], v[250:251] op_sel_hi:[1,0]
v_pk_mul_f32 v[236:237], v[236:237], v[250:251] op_sel_hi:[1,0]
v_pk_mul_f32 v[238:239], v[238:239], v[250:251] op_sel_hi:[1,0]
v_mfma_f32_16x16x32_bf16 v[28:31], a[180:183], a[56:59], v[28:31]
v_exp_f32 v19, v19
v_mfma_f32_16x16x32_bf16 v[28:31], a[184:187], a[52:55], v[28:31]
ds_read_b128 a[156:159], v4 offset:53248
v_cvt_pk_bf16_f32 v41, v18, v19
v_mfma_f32_16x16x32_bf16 v[28:31], a[188:191], a[48:51], v[28:31]
v_exp_f32 v20, v20
v_smfmac_f32_16x16x64_bf16 v[56:59], v[12:15], v[32:39], v1
ds_read_b128 a[160:163], v4 offset:57344
v_mfma_f32_16x16x32_bf16 v[128:131], a[192:195], v[32:35], v[128:131]
ds_read_b128 a[164:167], v5 offset:57344
v_cvt_pk_bf16_f32 v224, v232, v233
v_mfma_f32_16x16x32_bf16 v[128:131], a[196:199], v[36:39], v[128:131]
v_exp_f32 v21, v21
v_mfma_f32_16x16x32_bf16 v[132:135], a[200:203], v[36:39], v[132:135]
ds_read_b128 a[168:171], v6 offset:57344
v_cvt_pk_bf16_f32 v42, v20, v21
v_mfma_f32_16x16x32_bf16 v[132:135], a[204:207], v[32:35], v[132:135]
v_exp_f32 v22, v22
v_mfma_f32_16x16x32_bf16 v[136:139], a[208:211], v[32:35], v[136:139]
ds_read_b128 a[172:175], v7 offset:57344
v_cvt_pk_bf16_f32 v225, v234, v235
v_mfma_f32_16x16x32_bf16 v[136:139], a[212:215], v[36:39], v[136:139]
v_exp_f32 v23, v23
v_mfma_f32_16x16x32_bf16 v[140:143], a[216:219], v[36:39], v[140:143]
ds_read_b128 a[176:179], v7 offset:61440
v_cvt_pk_bf16_f32 v43, v22, v23
v_mfma_f32_16x16x32_bf16 v[140:143], a[220:223], v[32:35], v[140:143]
v_exp_f32 v24, v24
v_mfma_f32_16x16x32_bf16 v[144:147], a[224:227], v[32:35], v[144:147]
ds_read_b128 a[180:183], v6 offset:61440
buffer_load_dwordx4 a[68:71], v0, s[8:11], s36 offen offset:64 nt
v_mfma_f32_16x16x32_bf16 v[144:147], a[228:231], v[36:39], v[144:147]
v_exp_f32 v25, v25
v_mfma_f32_16x16x32_bf16 v[148:151], a[232:235], v[36:39], v[148:151]
ds_read_b128 a[184:187], v5 offset:61440
v_cvt_pk_bf16_f32 v44, v24, v25
v_mfma_f32_16x16x32_bf16 v[148:151], a[236:239], v[32:35], v[148:151]
v_exp_f32 v26, v26
v_mfma_f32_16x16x32_bf16 v[152:155], a[240:243], v[32:35], v[152:155]
ds_read_b128 a[188:191], v4 offset:61440
v_cvt_pk_bf16_f32 v226, v236, v237
v_mfma_f32_16x16x32_bf16 v[152:155], a[244:247], v[36:39], v[152:155]
v_exp_f32 v27, v27
v_mfma_f32_16x16x32_bf16 v[156:159], a[248:251], v[36:39], v[156:159]
v_cvt_pk_bf16_f32 v45, v26, v27
v_cvt_pk_bf16_f32 v227, v238, v239
v_mfma_f32_16x16x32_bf16 v[156:159], a[252:255], v[32:35], v[156:159]
s_waitcnt lgkmcnt(12)
v_exp_f32 v28, v28
v_mfma_f32_16x16x32_bf16 v[16:19], a[128:131], a[0:3], -4.0
ds_write_b128 v251, v[224:227] offset:8192
v_mfma_f32_16x16x32_bf16 v[16:19], a[132:135], a[4:7], v[16:19]
v_exp_f32 v29, v29
v_mfma_f32_16x16x32_bf16 v[16:19], a[136:139], a[8:11], v[16:19]
v_lshlrev_b32 v232, 16, v228
v_and_b32 v233, 0xffff0000, v228
v_mfma_f32_16x16x32_bf16 v[16:19], a[140:143], a[12:15], v[16:19]
s_waitcnt lgkmcnt(9)
v_exp_f32 v30, v30
v_mfma_f32_16x16x32_bf16 v[20:23], a[144:147], a[12:15], -4.0
v_cvt_pk_bf16_f32 v46, v28, v29
v_lshlrev_b32 v234, 16, v229
v_mfma_f32_16x16x32_bf16 v[20:23], a[148:151], a[8:11], v[20:23]
v_exp_f32 v31, v31
v_mfma_f32_16x16x32_bf16 v[20:23], a[152:155], a[4:7], v[20:23]
v_cvt_pk_bf16_f32 v47, v30, v31
v_and_b32 v235, 0xffff0000, v229
v_lshlrev_b32 v236, 16, v230
v_and_b32 v237, 0xffff0000, v230
v_lshlrev_b32 v238, 16, v231
v_and_b32 v239, 0xffff0000, v231
v_pk_mul_f32 v[232:233], v[232:233], v[250:251] op_sel_hi:[1,0]
v_pk_mul_f32 v[234:235], v[234:235], v[250:251] op_sel_hi:[1,0]
v_pk_mul_f32 v[236:237], v[236:237], v[250:251] op_sel_hi:[1,0]
v_pk_mul_f32 v[238:239], v[238:239], v[250:251] op_sel_hi:[1,0]
v_mfma_f32_16x16x32_bf16 v[20:23], a[156:159], a[0:3], v[20:23]
s_waitcnt lgkmcnt(5)
v_exp_f32 v16, v16
v_mfma_f32_16x16x32_bf16 v[24:27], a[160:163], a[0:3], -4.0
v_cvt_pk_bf16_f32 v228, v232, v233
v_cvt_pk_bf16_f32 v229, v234, v235
v_mfma_f32_16x16x32_bf16 v[24:27], a[164:167], a[4:7], v[24:27]
v_exp_f32 v17, v17
v_mfma_f32_16x16x32_bf16 v[24:27], a[168:171], a[8:11], v[24:27]
buffer_load_dwordx4 a[72:75], v0, s[8:11], s36 offen offset:128 nt
v_cvt_pk_bf16_f32 v32, v16, v17
v_mfma_f32_16x16x32_bf16 v[24:27], a[172:175], a[12:15], v[24:27]
s_waitcnt lgkmcnt(1)
v_exp_f32 v18, v18
v_mfma_f32_16x16x32_bf16 v[28:31], a[176:179], a[12:15], -4.0
L_pg2:
s_cbranch_vccnz L_pg6
v_cvt_pk_bf16_f32 v230, v236, v237
v_cvt_pk_bf16_f32 v231, v238, v239
v_mfma_f32_16x16x32_bf16 v[28:31], a[180:183], a[8:11], v[28:31]
v_exp_f32 v19, v19
v_mfma_f32_16x16x32_bf16 v[28:31], a[184:187], a[4:7], v[28:31]
ds_write_b128 v251, v[228:231] offset:12288
v_cvt_pk_bf16_f32 v33, v18, v19
v_mfma_f32_16x16x32_bf16 v[28:31], a[188:191], a[0:3], v[28:31]
s_waitcnt vmcnt(13)
v_exp_f32 v20, v20
v_smfmac_f32_16x16x64_bf16 v[60:63], v[12:15], v[40:47], v1
s_barrier
v_mfma_f32_16x16x32_bf16 v[160:163], a[192:195], v[40:43], v[160:163]
ds_read_b64_tr_b16 a[192:193], v8 offset:16384
ds_read_b64_tr_b16 a[194:195], v8 offset:20480
v_mfma_f32_16x16x32_bf16 v[160:163], a[196:199], v[44:47], v[160:163]
v_exp_f32 v21, v21
v_mfma_f32_16x16x32_bf16 v[164:167], a[200:203], v[44:47], v[164:167]
ds_read_b64_tr_b16 a[196:197], v8 offset:24576
v_cvt_pk_bf16_f32 v34, v20, v21
v_mfma_f32_16x16x32_bf16 v[164:167], a[204:207], v[40:43], v[164:167]
v_exp_f32 v22, v22
v_mfma_f32_16x16x32_bf16 v[168:171], a[208:211], v[40:43], v[168:171]
ds_read_b64_tr_b16 a[198:199], v8 offset:28672
ds_read_b64_tr_b16 a[200:201], v9 offset:24576
v_mfma_f32_16x16x32_bf16 v[168:171], a[212:215], v[44:47], v[168:171]
v_exp_f32 v23, v23
v_mfma_f32_16x16x32_bf16 v[172:175], a[216:219], v[44:47], v[172:175]
ds_read_b64_tr_b16 a[202:203], v9 offset:28672
v_cvt_pk_bf16_f32 v35, v22, v23
v_mfma_f32_16x16x32_bf16 v[172:175], a[220:223], v[40:43], v[172:175]
v_exp_f32 v24, v24
v_mfma_f32_16x16x32_bf16 v[176:179], a[224:227], v[40:43], v[176:179]
ds_read_b64_tr_b16 a[204:205], v9 offset:16384
ds_read_b64_tr_b16 a[206:207], v9 offset:20480
v_mfma_f32_16x16x32_bf16 v[176:179], a[228:231], v[44:47], v[176:179]
v_exp_f32 v25, v25
v_mfma_f32_16x16x32_bf16 v[180:183], a[232:235], v[44:47], v[180:183]
ds_read_b64_tr_b16 a[208:209], v10 offset:16384
v_cvt_pk_bf16_f32 v36, v24, v25
v_mfma_f32_16x16x32_bf16 v[180:183], a[236:239], v[40:43], v[180:183]
v_exp_f32 v26, v26
v_mfma_f32_16x16x32_bf16 v[184:187], a[240:243], v[40:43], v[184:187]
ds_read_b64_tr_b16 a[210:211], v10 offset:20480
ds_read_b64_tr_b16 a[212:213], v10 offset:24576
v_mfma_f32_16x16x32_bf16 v[184:187], a[244:247], v[44:47], v[184:187]
v_exp_f32 v27, v27
v_mfma_f32_16x16x32_bf16 v[188:191], a[248:251], v[44:47], v[188:191]
ds_read_b64_tr_b16 a[214:215], v10 offset:28672
v_cvt_pk_bf16_f32 v37, v26, v27
v_mfma_f32_16x16x32_bf16 v[188:191], a[252:255], v[40:43], v[188:191]
v_exp_f32 v28, v28
v_mfma_f32_16x16x32_bf16 v[16:19], a[128:131], a[16:19], -4.0
ds_read_b64_tr_b16 a[216:217], v11 offset:24576
ds_read_b64_tr_b16 a[218:219], v11 offset:28672
v_mfma_f32_16x16x32_bf16 v[16:19], a[132:135], a[20:23], v[16:19]
v_exp_f32 v29, v29
v_mfma_f32_16x16x32_bf16 v[16:19], a[136:139], a[24:27], v[16:19]
ds_read_b64_tr_b16 a[220:221], v11 offset:16384
ds_read_b64_tr_b16 a[222:223], v11 offset:20480
v_mfma_f32_16x16x32_bf16 v[16:19], a[140:143], a[28:31], v[16:19]
v_exp_f32 v30, v30
v_mfma_f32_16x16x32_bf16 v[20:23], a[144:147], a[28:31], -4.0
ds_read_b64_tr_b16 a[224:225], v8 offset:17408
v_cvt_pk_bf16_f32 v38, v28, v29
v_mfma_f32_16x16x32_bf16 v[20:23], a[148:151], a[24:27], v[20:23]
v_exp_f32 v31, v31
v_mfma_f32_16x16x32_bf16 v[20:23], a[152:155], a[20:23], v[20:23]
ds_read_b64_tr_b16 a[226:227], v8 offset:21504
v_cvt_pk_bf16_f32 v39, v30, v31
v_mfma_f32_16x16x32_bf16 v[20:23], a[156:159], a[16:19], v[20:23]
v_exp_f32 v16, v16
v_mfma_f32_16x16x32_bf16 v[24:27], a[160:163], a[16:19], -4.0
ds_read_b64_tr_b16 a[228:229], v8 offset:25600
ds_read_b64_tr_b16 a[230:231], v8 offset:29696
v_mfma_f32_16x16x32_bf16 v[24:27], a[164:167], a[20:23], v[24:27]
v_exp_f32 v17, v17
v_mfma_f32_16x16x32_bf16 v[24:27], a[168:171], a[24:27], v[24:27]
ds_read_b64_tr_b16 a[232:233], v9 offset:25600
v_cvt_pk_bf16_f32 v40, v16, v17
v_mfma_f32_16x16x32_bf16 v[24:27], a[172:175], a[28:31], v[24:27]
v_exp_f32 v18, v18
v_mfma_f32_16x16x32_bf16 v[28:31], a[176:179], a[28:31], -4.0
ds_read_b64_tr_b16 a[234:235], v9 offset:29696
ds_read_b64_tr_b16 a[236:237], v9 offset:17408
v_mfma_f32_16x16x32_bf16 v[28:31], a[180:183], a[24:27], v[28:31]
v_exp_f32 v19, v19
v_mfma_f32_16x16x32_bf16 v[28:31], a[184:187], a[20:23], v[28:31]
ds_read_b64_tr_b16 a[238:239], v9 offset:21504
v_cvt_pk_bf16_f32 v41, v18, v19
v_mfma_f32_16x16x32_bf16 v[28:31], a[188:191], a[16:19], v[28:31]
v_exp_f32 v20, v20
v_smfmac_f32_16x16x64_bf16 v[48:51], v[12:15], v[32:39], v1
s_waitcnt lgkmcnt(15)
ds_read_b64_tr_b16 a[240:241], v10 offset:17408
v_mfma_f32_16x16x32_bf16 v[64:67], a[192:195], v[32:35], v[64:67]
ds_read_b64_tr_b16 a[242:243], v10 offset:21504
ds_read_b64_tr_b16 a[244:245], v10 offset:25600
v_mfma_f32_16x16x32_bf16 v[64:67], a[196:199], v[36:39], v[64:67]
v_exp_f32 v21, v21
v_mfma_f32_16x16x32_bf16 v[68:71], a[200:203], v[36:39], v[68:71]
ds_read_b64_tr_b16 a[246:247], v10 offset:29696
v_cvt_pk_bf16_f32 v42, v20, v21
v_mfma_f32_16x16x32_bf16 v[68:71], a[204:207], v[32:35], v[68:71]
s_waitcnt lgkmcnt(15)
v_exp_f32 v22, v22
v_mfma_f32_16x16x32_bf16 v[72:75], a[208:211], v[32:35], v[72:75]
ds_read_b64_tr_b16 a[248:249], v11 offset:25600
ds_read_b64_tr_b16 a[250:251], v11 offset:29696
v_mfma_f32_16x16x32_bf16 v[72:75], a[212:215], v[36:39], v[72:75]
s_waitcnt lgkmcnt(14)
v_exp_f32 v23, v23
v_mfma_f32_16x16x32_bf16 v[76:79], a[216:219], v[36:39], v[76:79]
ds_read_b64_tr_b16 a[252:253], v11 offset:17408
v_cvt_pk_bf16_f32 v43, v22, v23
v_mfma_f32_16x16x32_bf16 v[76:79], a[220:223], v[32:35], v[76:79]
s_waitcnt lgkmcnt(11)
ds_read_b64_tr_b16 a[254:255], v11 offset:21504
v_exp_f32 v24, v24
v_mfma_f32_16x16x32_bf16 v[80:83], a[224:227], v[32:35], v[80:83]
buffer_load_dwordx4 v[216:219], v248, s[12:15], s81 offen nt
v_add_u32 v4, 0x10000, v4
v_mfma_f32_16x16x32_bf16 v[80:83], a[228:231], v[36:39], v[80:83]
s_waitcnt lgkmcnt(8)
v_exp_f32 v25, v25
v_mfma_f32_16x16x32_bf16 v[84:87], a[232:235], v[36:39], v[84:87]
v_cvt_pk_bf16_f32 v44, v24, v25
v_add_u32 v5, 0x10000, v5
v_mfma_f32_16x16x32_bf16 v[84:87], a[236:239], v[32:35], v[84:87]
s_waitcnt lgkmcnt(4)
v_exp_f32 v26, v26
v_mfma_f32_16x16x32_bf16 v[88:91], a[240:243], v[32:35], v[88:91]
v_add_u32 v6, 0x10000, v6
v_add_u32 v7, 0x10000, v7
v_mfma_f32_16x16x32_bf16 v[88:91], a[244:247], v[36:39], v[88:91]
s_waitcnt lgkmcnt(0)
v_exp_f32 v27, v27
v_mfma_f32_16x16x32_bf16 v[92:95], a[248:251], v[36:39], v[92:95]
buffer_load_dwordx4 v[220:223], v249, s[12:15], s81 offen nt
v_cvt_pk_bf16_f32 v45, v26, v27
v_mfma_f32_16x16x32_bf16 v[92:95], a[252:255], v[32:35], v[92:95]
v_exp_f32 v28, v28
v_mfma_f32_16x16x32_bf16 v[16:19], a[128:131], a[32:35], -4.0
s_barrier
v_mfma_f32_16x16x32_bf16 v[16:19], a[132:135], a[36:39], v[16:19]
s_add_u32 m0, s24, 0x4000
v_exp_f32 v29, v29
v_mfma_f32_16x16x32_bf16 v[16:19], a[136:139], a[40:43], v[16:19]
s_waitcnt vmcnt(13)
v_lshlrev_b32 v232, 16, v192
v_and_b32 v233, 0xffff0000, v192
v_mfma_f32_16x16x32_bf16 v[16:19], a[140:143], a[44:47], v[16:19]
v_exp_f32 v30, v30
v_mfma_f32_16x16x32_bf16 v[20:23], a[144:147], a[44:47], -4.0
buffer_load_dwordx4 v2, s[16:19], s78 offen offset:0 lds
v_cvt_pk_bf16_f32 v46, v28, v29
v_mfma_f32_16x16x32_bf16 v[20:23], a[148:151], a[40:43], v[20:23]
v_exp_f32 v31, v31
v_mfma_f32_16x16x32_bf16 v[20:23], a[152:155], a[36:39], v[20:23]
v_cvt_pk_bf16_f32 v47, v30, v31
v_lshlrev_b32 v234, 16, v193
v_mfma_f32_16x16x32_bf16 v[20:23], a[156:159], a[32:35], v[20:23]
v_exp_f32 v16, v16
v_mfma_f32_16x16x32_bf16 v[24:27], a[160:163], a[32:35], -4.0
v_and_b32 v235, 0xffff0000, v193
v_lshlrev_b32 v236, 16, v194
v_and_b32 v237, 0xffff0000, v194
v_lshlrev_b32 v238, 16, v195
v_and_b32 v239, 0xffff0000, v195
v_pk_mul_f32 v[232:233], v[232:233], v[250:251] op_sel_hi:[1,0]
v_pk_mul_f32 v[234:235], v[234:235], v[250:251] op_sel_hi:[1,0]
v_pk_mul_f32 v[236:237], v[236:237], v[250:251] op_sel_hi:[1,0]
v_pk_mul_f32 v[238:239], v[238:239], v[250:251] op_sel_hi:[1,0]
v_mfma_f32_16x16x32_bf16 v[24:27], a[164:167], a[36:39], v[24:27]
v_exp_f32 v17, v17
v_mfma_f32_16x16x32_bf16 v[24:27], a[168:171], a[40:43], v[24:27]
buffer_load_dwordx4 v2, s[16:19], s78 offen offset:2048 lds
v_cvt_pk_bf16_f32 v32, v16, v17
v_mfma_f32_16x16x32_bf16 v[24:27], a[172:175], a[44:47], v[24:27]
s_add_u32 m0, s24, 0x6000
v_exp_f32 v18, v18
v_mfma_f32_16x16x32_bf16 v[28:31], a[176:179], a[44:47], -4.0
v_cvt_pk_bf16_f32 v192, v232, v233
v_cvt_pk_bf16_f32 v193, v234, v235
v_mfma_f32_16x16x32_bf16 v[28:31], a[180:183], a[40:43], v[28:31]
v_exp_f32 v19, v19
v_mfma_f32_16x16x32_bf16 v[28:31], a[184:187], a[36:39], v[28:31]
v_cvt_pk_bf16_f32 v33, v18, v19
v_cvt_pk_bf16_f32 v194, v236, v237
v_mfma_f32_16x16x32_bf16 v[28:31], a[188:191], a[32:35], v[28:31]
v_exp_f32 v20, v20
v_smfmac_f32_16x16x64_bf16 v[52:55], v[12:15], v[40:47], v1
buffer_load_dwordx4 v2, s[16:19], s79 offen offset:0 lds
v_mfma_f32_16x16x32_bf16 v[96:99], a[192:195], v[40:43], v[96:99]
v_cvt_pk_bf16_f32 v195, v238, v239
v_lshlrev_b32 v232, 16, v196
v_mfma_f32_16x16x32_bf16 v[96:99], a[196:199], v[44:47], v[96:99]
v_exp_f32 v21, v21
v_mfma_f32_16x16x32_bf16 v[100:103], a[200:203], v[44:47], v[100:103]
ds_write_b128 v251, v[192:195] offset:16384
v_cvt_pk_bf16_f32 v34, v20, v21
v_mfma_f32_16x16x32_bf16 v[100:103], a[204:207], v[40:43], v[100:103]
v_exp_f32 v22, v22
v_mfma_f32_16x16x32_bf16 v[104:107], a[208:211], v[40:43], v[104:107]
v_and_b32 v233, 0xffff0000, v196
v_lshlrev_b32 v234, 16, v197
v_mfma_f32_16x16x32_bf16 v[104:107], a[212:215], v[44:47], v[104:107]
v_exp_f32 v23, v23
v_mfma_f32_16x16x32_bf16 v[108:111], a[216:219], v[44:47], v[108:111]
buffer_load_dwordx4 v2, s[16:19], s79 offen offset:2048 lds
v_cvt_pk_bf16_f32 v35, v22, v23
v_mfma_f32_16x16x32_bf16 v[108:111], a[220:223], v[40:43], v[108:111]
v_exp_f32 v24, v24
v_mfma_f32_16x16x32_bf16 v[112:115], a[224:227], v[40:43], v[112:115]
v_and_b32 v235, 0xffff0000, v197
v_lshlrev_b32 v236, 16, v198
v_and_b32 v237, 0xffff0000, v198
v_lshlrev_b32 v238, 16, v199
v_and_b32 v239, 0xffff0000, v199
v_pk_mul_f32 v[232:233], v[232:233], v[250:251] op_sel_hi:[1,0]
v_pk_mul_f32 v[234:235], v[234:235], v[250:251] op_sel_hi:[1,0]
v_pk_mul_f32 v[236:237], v[236:237], v[250:251] op_sel_hi:[1,0]
v_pk_mul_f32 v[238:239], v[238:239], v[250:251] op_sel_hi:[1,0]
v_mfma_f32_16x16x32_bf16 v[112:115], a[228:231], v[44:47], v[112:115]
v_exp_f32 v25, v25
v_mfma_f32_16x16x32_bf16 v[116:119], a[232:235], v[44:47], v[116:119]
v_cvt_pk_bf16_f32 v36, v24, v25
v_cvt_pk_bf16_f32 v196, v232, v233
v_mfma_f32_16x16x32_bf16 v[116:119], a[236:239], v[40:43], v[116:119]
v_exp_f32 v26, v26
v_mfma_f32_16x16x32_bf16 v[120:123], a[240:243], v[40:43], v[120:123]
buffer_load_dwordx4 v[224:227], v248, s[12:15], s82 offen nt
v_cvt_pk_bf16_f32 v197, v234, v235
v_mfma_f32_16x16x32_bf16 v[120:123], a[244:247], v[44:47], v[120:123]
v_exp_f32 v27, v27
v_mfma_f32_16x16x32_bf16 v[124:127], a[248:251], v[44:47], v[124:127]
v_cvt_pk_bf16_f32 v37, v26, v27
v_cvt_pk_bf16_f32 v198, v236, v237
v_mfma_f32_16x16x32_bf16 v[124:127], a[252:255], v[40:43], v[124:127]
v_exp_f32 v28, v28
v_mfma_f32_16x16x32_bf16 v[16:19], a[128:131], a[48:51], -4.0
ds_read_b128 a[128:131], v4 offset:0
v_cvt_pk_bf16_f32 v199, v238, v239
v_mfma_f32_16x16x32_bf16 v[16:19], a[132:135], a[52:55], v[16:19]
v_exp_f32 v29, v29
v_mfma_f32_16x16x32_bf16 v[16:19], a[136:139], a[56:59], v[16:19]
ds_read_b128 a[132:135], v5 offset:0
buffer_load_dwordx4 v[228:231], v249, s[12:15], s82 offen nt
v_mfma_f32_16x16x32_bf16 v[16:19], a[140:143], a[60:63], v[16:19]
v_exp_f32 v30, v30
v_mfma_f32_16x16x32_bf16 v[20:23], a[144:147], a[60:63], -4.0
ds_read_b128 a[136:139], v6 offset:0
v_cvt_pk_bf16_f32 v38, v28, v29
v_mfma_f32_16x16x32_bf16 v[20:23], a[148:151], a[56:59], v[20:23]
v_exp_f32 v31, v31
v_mfma_f32_16x16x32_bf16 v[20:23], a[152:155], a[52:55], v[20:23]
ds_read_b128 a[140:143], v7 offset:0
v_cvt_pk_bf16_f32 v39, v30, v31
v_mfma_f32_16x16x32_bf16 v[20:23], a[156:159], a[48:51], v[20:23]
v_exp_f32 v16, v16
v_mfma_f32_16x16x32_bf16 v[24:27], a[160:163], a[48:51], -4.0
ds_read_b128 a[144:147], v7 offset:4096
buffer_load_dwordx4 a[76:79], v0, s[8:11], s36 offen offset:192 nt
v_mfma_f32_16x16x32_bf16 v[24:27], a[164:167], a[52:55], v[24:27]
v_exp_f32 v17, v17
v_mfma_f32_16x16x32_bf16 v[24:27], a[168:171], a[56:59], v[24:27]
ds_read_b128 a[148:151], v6 offset:4096
v_cvt_pk_bf16_f32 v40, v16, v17
v_mfma_f32_16x16x32_bf16 v[24:27], a[172:175], a[60:63], v[24:27]
v_exp_f32 v18, v18
v_mfma_f32_16x16x32_bf16 v[28:31], a[176:179], a[60:63], -4.0
s_waitcnt vmcnt(18)
ds_read_b128 a[152:155], v5 offset:4096
v_lshlrev_b32 v232, 16, v200
v_mfma_f32_16x16x32_bf16 v[28:31], a[180:183], a[56:59], v[28:31]
v_exp_f32 v19, v19
v_mfma_f32_16x16x32_bf16 v[28:31], a[184:187], a[52:55], v[28:31]
ds_read_b128 a[156:159], v4 offset:4096
v_cvt_pk_bf16_f32 v41, v18, v19
v_mfma_f32_16x16x32_bf16 v[28:31], a[188:191], a[48:51], v[28:31]
v_exp_f32 v20, v20
v_smfmac_f32_16x16x64_bf16 v[56:59], v[12:15], v[32:39], v1
ds_read_b128 a[160:163], v4 offset:8192
v_mfma_f32_16x16x32_bf16 v[128:131], a[192:195], v[32:35], v[128:131]
ds_read_b128 a[164:167], v5 offset:8192
v_and_b32 v233, 0xffff0000, v200
v_mfma_f32_16x16x32_bf16 v[128:131], a[196:199], v[36:39], v[128:131]
v_exp_f32 v21, v21
v_mfma_f32_16x16x32_bf16 v[132:135], a[200:203], v[36:39], v[132:135]
ds_read_b128 a[168:171], v6 offset:8192
v_cvt_pk_bf16_f32 v42, v20, v21
v_mfma_f32_16x16x32_bf16 v[132:135], a[204:207], v[32:35], v[132:135]
v_exp_f32 v22, v22
v_mfma_f32_16x16x32_bf16 v[136:139], a[208:211], v[32:35], v[136:139]
ds_read_b128 a[172:175], v7 offset:8192
v_lshlrev_b32 v234, 16, v201
v_mfma_f32_16x16x32_bf16 v[136:139], a[212:215], v[36:39], v[136:139]
v_exp_f32 v23, v23
v_mfma_f32_16x16x32_bf16 v[140:143], a[216:219], v[36:39], v[140:143]
ds_read_b128 a[176:179], v7 offset:12288
v_cvt_pk_bf16_f32 v43, v22, v23
v_mfma_f32_16x16x32_bf16 v[140:143], a[220:223], v[32:35], v[140:143]
v_exp_f32 v24, v24
v_mfma_f32_16x16x32_bf16 v[144:147], a[224:227], v[32:35], v[144:147]
ds_write_b128 v251, v[196:199] offset:20480
v_mfma_f32_16x16x32_bf16 v[144:147], a[228:231], v[36:39], v[144:147]
v_exp_f32 v25, v25
v_mfma_f32_16x16x32_bf16 v[148:151], a[232:235], v[36:39], v[148:151]
ds_read_b128 a[180:183], v6 offset:12288
v_cvt_pk_bf16_f32 v44, v24, v25
v_mfma_f32_16x16x32_bf16 v[148:151], a[236:239], v[32:35], v[148:151]
v_exp_f32 v26, v26
v_mfma_f32_16x16x32_bf16 v[152:155], a[240:243], v[32:35], v[152:155]
ds_read_b128 a[184:187], v5 offset:12288
buffer_load_dwordx4 a[80:83], v0, s[8:11], s37 offen offset:0 nt
v_mfma_f32_16x16x32_bf16 v[152:155], a[244:247], v[36:39], v[152:155]
v_exp_f32 v27, v27
v_mfma_f32_16x16x32_bf16 v[156:159], a[248:251], v[36:39], v[156:159]
ds_read_b128 a[188:191], v4 offset:12288
v_cvt_pk_bf16_f32 v45, v26, v27
v_mfma_f32_16x16x32_bf16 v[156:159], a[252:255], v[32:35], v[156:159]
s_waitcnt lgkmcnt(13)
v_exp_f32 v28, v28
v_mfma_f32_16x16x32_bf16 v[16:19], a[128:131], a[0:3], -4.0
v_and_b32 v235, 0xffff0000, v201
v_lshlrev_b32 v236, 16, v202
v_and_b32 v237, 0xffff0000, v202
v_lshlrev_b32 v238, 16, v203
v_and_b32 v239, 0xffff0000, v203
v_pk_mul_f32 v[232:233], v[232:233], v[250:251] op_sel_hi:[1,0]
v_pk_mul_f32 v[234:235], v[234:235], v[250:251] op_sel_hi:[1,0]
v_pk_mul_f32 v[236:237], v[236:237], v[250:251] op_sel_hi:[1,0]
v_pk_mul_f32 v[238:239], v[238:239], v[250:251] op_sel_hi:[1,0]
v_mfma_f32_16x16x32_bf16 v[16:19], a[132:135], a[4:7], v[16:19]
v_exp_f32 v29, v29
v_mfma_f32_16x16x32_bf16 v[16:19], a[136:139], a[8:11], v[16:19]
v_cvt_pk_bf16_f32 v200, v232, v233
v_cvt_pk_bf16_f32 v201, v234, v235
v_mfma_f32_16x16x32_bf16 v[16:19], a[140:143], a[12:15], v[16:19]
s_waitcnt lgkmcnt(9)
v_exp_f32 v30, v30
v_mfma_f32_16x16x32_bf16 v[20:23], a[144:147], a[12:15], -4.0
v_cvt_pk_bf16_f32 v46, v28, v29
v_cvt_pk_bf16_f32 v202, v236, v237
v_mfma_f32_16x16x32_bf16 v[20:23], a[148:151], a[8:11], v[20:23]
v_exp_f32 v31, v31
v_mfma_f32_16x16x32_bf16 v[20:23], a[152:155], a[4:7], v[20:23]
v_cvt_pk_bf16_f32 v47, v30, v31
v_cvt_pk_bf16_f32 v203, v238, v239
v_mfma_f32_16x16x32_bf16 v[20:23], a[156:159], a[0:3], v[20:23]
s_waitcnt lgkmcnt(5)
v_exp_f32 v16, v16
v_mfma_f32_16x16x32_bf16 v[24:27], a[160:163], a[0:3], -4.0
ds_write_b128 v251, v[200:203] offset:24576
v_mfma_f32_16x16x32_bf16 v[24:27], a[164:167], a[4:7], v[24:27]
v_exp_f32 v17, v17
v_mfma_f32_16x16x32_bf16 v[24:27], a[168:171], a[8:11], v[24:27]
v_cvt_pk_bf16_f32 v32, v16, v17
v_lshlrev_b32 v232, 16, v204
v_mfma_f32_16x16x32_bf16 v[24:27], a[172:175], a[12:15], v[24:27]
s_waitcnt lgkmcnt(1)
v_exp_f32 v18, v18
v_mfma_f32_16x16x32_bf16 v[28:31], a[176:179], a[12:15], -4.0
v_and_b32 v233, 0xffff0000, v204
v_lshlrev_b32 v234, 16, v205
v_mfma_f32_16x16x32_bf16 v[28:31], a[180:183], a[8:11], v[28:31]
v_exp_f32 v19, v19
v_mfma_f32_16x16x32_bf16 v[28:31], a[184:187], a[4:7], v[28:31]
buffer_load_dwordx4 a[84:87], v0, s[8:11], s37 offen offset:64 nt
v_cvt_pk_bf16_f32 v33, v18, v19
v_mfma_f32_16x16x32_bf16 v[28:31], a[188:191], a[0:3], v[28:31]
s_waitcnt vmcnt(16)
v_exp_f32 v20, v20
v_smfmac_f32_16x16x64_bf16 v[60:63], v[12:15], v[40:47], v1
s_barrier
v_mfma_f32_16x16x32_bf16 v[160:163], a[192:195], v[40:43], v[160:163]
ds_read_b64_tr_b16 a[192:193], v8 offset:0
ds_read_b64_tr_b16 a[194:195], v8 offset:4096
v_mfma_f32_16x16x32_bf16 v[160:163], a[196:199], v[44:47], v[160:163]
v_exp_f32 v21, v21
v_mfma_f32_16x16x32_bf16 v[164:167], a[200:203], v[44:47], v[164:167]
ds_read_b64_tr_b16 a[196:197], v8 offset:8192
v_cvt_pk_bf16_f32 v34, v20, v21
v_mfma_f32_16x16x32_bf16 v[164:167], a[204:207], v[40:43], v[164:167]
v_exp_f32 v22, v22
v_mfma_f32_16x16x32_bf16 v[168:171], a[208:211], v[40:43], v[168:171]
ds_read_b64_tr_b16 a[198:199], v8 offset:12288
ds_read_b64_tr_b16 a[200:201], v9 offset:8192
v_mfma_f32_16x16x32_bf16 v[168:171], a[212:215], v[44:47], v[168:171]
v_exp_f32 v23, v23
v_mfma_f32_16x16x32_bf16 v[172:175], a[216:219], v[44:47], v[172:175]
ds_read_b64_tr_b16 a[202:203], v9 offset:12288
v_cvt_pk_bf16_f32 v35, v22, v23
v_mfma_f32_16x16x32_bf16 v[172:175], a[220:223], v[40:43], v[172:175]
v_exp_f32 v24, v24
v_mfma_f32_16x16x32_bf16 v[176:179], a[224:227], v[40:43], v[176:179]
ds_read_b64_tr_b16 a[204:205], v9 offset:0
ds_read_b64_tr_b16 a[206:207], v9 offset:4096
v_mfma_f32_16x16x32_bf16 v[176:179], a[228:231], v[44:47], v[176:179]
v_exp_f32 v25, v25
v_mfma_f32_16x16x32_bf16 v[180:183], a[232:235], v[44:47], v[180:183]
ds_read_b64_tr_b16 a[208:209], v10 offset:0
v_cvt_pk_bf16_f32 v36, v24, v25
v_mfma_f32_16x16x32_bf16 v[180:183], a[236:239], v[40:43], v[180:183]
v_exp_f32 v26, v26
v_mfma_f32_16x16x32_bf16 v[184:187], a[240:243], v[40:43], v[184:187]
ds_read_b64_tr_b16 a[210:211], v10 offset:4096
ds_read_b64_tr_b16 a[212:213], v10 offset:8192
v_mfma_f32_16x16x32_bf16 v[184:187], a[244:247], v[44:47], v[184:187]
v_exp_f32 v27, v27
v_mfma_f32_16x16x32_bf16 v[188:191], a[248:251], v[44:47], v[188:191]
ds_read_b64_tr_b16 a[214:215], v10 offset:12288
v_cvt_pk_bf16_f32 v37, v26, v27
v_mfma_f32_16x16x32_bf16 v[188:191], a[252:255], v[40:43], v[188:191]
v_exp_f32 v28, v28
v_mfma_f32_16x16x32_bf16 v[16:19], a[128:131], a[16:19], -4.0
ds_read_b64_tr_b16 a[216:217], v11 offset:8192
ds_read_b64_tr_b16 a[218:219], v11 offset:12288
v_mfma_f32_16x16x32_bf16 v[16:19], a[132:135], a[20:23], v[16:19]
v_exp_f32 v29, v29
v_mfma_f32_16x16x32_bf16 v[16:19], a[136:139], a[24:27], v[16:19]
ds_read_b64_tr_b16 a[220:221], v11 offset:0
ds_read_b64_tr_b16 a[222:223], v11 offset:4096
v_mfma_f32_16x16x32_bf16 v[16:19], a[140:143], a[28:31], v[16:19]
v_exp_f32 v30, v30
v_mfma_f32_16x16x32_bf16 v[20:23], a[144:147], a[28:31], -4.0
ds_read_b64_tr_b16 a[224:225], v8 offset:1024
v_cvt_pk_bf16_f32 v38, v28, v29
v_mfma_f32_16x16x32_bf16 v[20:23], a[148:151], a[24:27], v[20:23]
v_exp_f32 v31, v31
v_mfma_f32_16x16x32_bf16 v[20:23], a[152:155], a[20:23], v[20:23]
ds_read_b64_tr_b16 a[226:227], v8 offset:5120
v_cvt_pk_bf16_f32 v39, v30, v31
v_mfma_f32_16x16x32_bf16 v[20:23], a[156:159], a[16:19], v[20:23]
v_exp_f32 v16, v16
v_mfma_f32_16x16x32_bf16 v[24:27], a[160:163], a[16:19], -4.0
ds_read_b64_tr_b16 a[228:229], v8 offset:9216
ds_read_b64_tr_b16 a[230:231], v8 offset:13312
v_mfma_f32_16x16x32_bf16 v[24:27], a[164:167], a[20:23], v[24:27]
v_exp_f32 v17, v17
v_mfma_f32_16x16x32_bf16 v[24:27], a[168:171], a[24:27], v[24:27]
ds_read_b64_tr_b16 a[232:233], v9 offset:9216
v_cvt_pk_bf16_f32 v40, v16, v17
v_mfma_f32_16x16x32_bf16 v[24:27], a[172:175], a[28:31], v[24:27]
v_exp_f32 v18, v18
v_mfma_f32_16x16x32_bf16 v[28:31], a[176:179], a[28:31], -4.0
ds_read_b64_tr_b16 a[234:235], v9 offset:13312
ds_read_b64_tr_b16 a[236:237], v9 offset:1024
v_mfma_f32_16x16x32_bf16 v[28:31], a[180:183], a[24:27], v[28:31]
v_exp_f32 v19, v19
v_mfma_f32_16x16x32_bf16 v[28:31], a[184:187], a[20:23], v[28:31]
ds_read_b64_tr_b16 a[238:239], v9 offset:5120
v_cvt_pk_bf16_f32 v41, v18, v19
v_mfma_f32_16x16x32_bf16 v[28:31], a[188:191], a[16:19], v[28:31]
v_exp_f32 v20, v20
v_smfmac_f32_16x16x64_bf16 v[48:51], v[12:15], v[32:39], v1
s_waitcnt lgkmcnt(15)
ds_read_b64_tr_b16 a[240:241], v10 offset:1024
v_mfma_f32_16x16x32_bf16 v[64:67], a[192:195], v[32:35], v[64:67]
ds_read_b64_tr_b16 a[242:243], v10 offset:5120
ds_read_b64_tr_b16 a[244:245], v10 offset:9216
v_mfma_f32_16x16x32_bf16 v[64:67], a[196:199], v[36:39], v[64:67]
v_exp_f32 v21, v21
v_mfma_f32_16x16x32_bf16 v[68:71], a[200:203], v[36:39], v[68:71]
ds_read_b64_tr_b16 a[246:247], v10 offset:13312
v_cvt_pk_bf16_f32 v42, v20, v21
v_mfma_f32_16x16x32_bf16 v[68:71], a[204:207], v[32:35], v[68:71]
s_waitcnt lgkmcnt(15)
v_exp_f32 v22, v22
v_and_b32 v235, 0xffff0000, v205
v_lshlrev_b32 v236, 16, v206
v_and_b32 v237, 0xffff0000, v206
v_lshlrev_b32 v238, 16, v207
v_and_b32 v239, 0xffff0000, v207
v_pk_mul_f32 v[232:233], v[232:233], v[250:251] op_sel_hi:[1,0]
v_pk_mul_f32 v[234:235], v[234:235], v[250:251] op_sel_hi:[1,0]
v_pk_mul_f32 v[236:237], v[236:237], v[250:251] op_sel_hi:[1,0]
v_pk_mul_f32 v[238:239], v[238:239], v[250:251] op_sel_hi:[1,0]
v_cvt_pk_bf16_f32 v204, v232, v233
v_cvt_pk_bf16_f32 v205, v234, v235
v_cvt_pk_bf16_f32 v206, v236, v237
v_cvt_pk_bf16_f32 v207, v238, v239
v_mfma_f32_16x16x32_bf16 v[72:75], a[208:211], v[32:35], v[72:75]
ds_write_b128 v251, v[204:207] offset:28672
v_mfma_f32_16x16x32_bf16 v[72:75], a[212:215], v[36:39], v[72:75]
s_waitcnt lgkmcnt(13)
v_exp_f32 v23, v23
v_mfma_f32_16x16x32_bf16 v[76:79], a[216:219], v[36:39], v[76:79]
ds_read_b64_tr_b16 a[248:249], v11 offset:9216
ds_read_b64_tr_b16 a[250:251], v11 offset:13312
v_cvt_pk_bf16_f32 v43, v22, v23
v_mfma_f32_16x16x32_bf16 v[76:79], a[220:223], v[32:35], v[76:79]
s_waitcnt lgkmcnt(11)
ds_read_b64_tr_b16 a[252:253], v11 offset:1024
ds_read_b64_tr_b16 a[254:255], v11 offset:5120
v_exp_f32 v24, v24
v_mfma_f32_16x16x32_bf16 v[80:83], a[224:227], v[32:35], v[80:83]
s_waitcnt vmcnt(14)
buffer_load_dwordx4 v[192:195], v248, s[12:15], s83 offen nt
v_lshlrev_b32 v232, 16, v208
v_mfma_f32_16x16x32_bf16 v[80:83], a[228:231], v[36:39], v[80:83]
s_waitcnt lgkmcnt(9)
v_exp_f32 v25, v25
v_mfma_f32_16x16x32_bf16 v[84:87], a[232:235], v[36:39], v[84:87]
v_cvt_pk_bf16_f32 v44, v24, v25
v_and_b32 v233, 0xffff0000, v208
v_mfma_f32_16x16x32_bf16 v[84:87], a[236:239], v[32:35], v[84:87]
s_waitcnt lgkmcnt(5)
v_exp_f32 v26, v26
v_mfma_f32_16x16x32_bf16 v[88:91], a[240:243], v[32:35], v[88:91]
v_lshlrev_b32 v234, 16, v209
v_and_b32 v235, 0xffff0000, v209
v_lshlrev_b32 v236, 16, v210
v_and_b32 v237, 0xffff0000, v210
v_lshlrev_b32 v238, 16, v211
v_and_b32 v239, 0xffff0000, v211
v_pk_mul_f32 v[232:233], v[232:233], v[250:251] op_sel_hi:[1,0]
v_pk_mul_f32 v[234:235], v[234:235], v[250:251] op_sel_hi:[1,0]
v_pk_mul_f32 v[236:237], v[236:237], v[250:251] op_sel_hi:[1,0]
v_pk_mul_f32 v[238:239], v[238:239], v[250:251] op_sel_hi:[1,0]
v_mfma_f32_16x16x32_bf16 v[88:91], a[244:247], v[36:39], v[88:91]
s_waitcnt lgkmcnt(0)
v_exp_f32 v27, v27
v_mfma_f32_16x16x32_bf16 v[92:95], a[248:251], v[36:39], v[92:95]
buffer_load_dwordx4 v[196:199], v249, s[12:15], s83 offen nt
v_cvt_pk_bf16_f32 v45, v26, v27
v_mfma_f32_16x16x32_bf16 v[92:95], a[252:255], v[32:35], v[92:95]
v_exp_f32 v28, v28
v_mfma_f32_16x16x32_bf16 v[16:19], a[128:131], a[32:35], -4.0
s_barrier
v_mfma_f32_16x16x32_bf16 v[16:19], a[132:135], a[36:39], v[16:19]
s_add_u32 m0, s24, 0x0
v_exp_f32 v29, v29
v_mfma_f32_16x16x32_bf16 v[16:19], a[136:139], a[40:43], v[16:19]
v_cvt_pk_bf16_f32 v208, v232, v233
v_cvt_pk_bf16_f32 v209, v234, v235
v_mfma_f32_16x16x32_bf16 v[16:19], a[140:143], a[44:47], v[16:19]
v_exp_f32 v30, v30
v_mfma_f32_16x16x32_bf16 v[20:23], a[144:147], a[44:47], -4.0
buffer_load_dwordx4 v2, s[16:19], s80 offen offset:0 lds
v_cvt_pk_bf16_f32 v46, v28, v29
v_mfma_f32_16x16x32_bf16 v[20:23], a[148:151], a[40:43], v[20:23]
v_exp_f32 v31, v31
v_mfma_f32_16x16x32_bf16 v[20:23], a[152:155], a[36:39], v[20:23]
v_cvt_pk_bf16_f32 v47, v30, v31
v_cvt_pk_bf16_f32 v210, v236, v237
v_mfma_f32_16x16x32_bf16 v[20:23], a[156:159], a[32:35], v[20:23]
v_exp_f32 v16, v16
v_mfma_f32_16x16x32_bf16 v[24:27], a[160:163], a[32:35], -4.0
v_cvt_pk_bf16_f32 v211, v238, v239
v_lshlrev_b32 v232, 16, v212
v_mfma_f32_16x16x32_bf16 v[24:27], a[164:167], a[36:39], v[24:27]
v_exp_f32 v17, v17
v_mfma_f32_16x16x32_bf16 v[24:27], a[168:171], a[40:43], v[24:27]
buffer_load_dwordx4 v2, s[16:19], s80 offen offset:2048 lds
v_cvt_pk_bf16_f32 v32, v16, v17
v_mfma_f32_16x16x32_bf16 v[24:27], a[172:175], a[44:47], v[24:27]
s_add_u32 m0, s24, 0x2000
v_exp_f32 v18, v18
v_mfma_f32_16x16x32_bf16 v[28:31], a[176:179], a[44:47], -4.0
ds_write_b128 v251, v[208:211] offset:32768
v_mfma_f32_16x16x32_bf16 v[28:31], a[180:183], a[40:43], v[28:31]
v_exp_f32 v19, v19
v_mfma_f32_16x16x32_bf16 v[28:31], a[184:187], a[36:39], v[28:31]
v_cvt_pk_bf16_f32 v33, v18, v19
v_and_b32 v233, 0xffff0000, v212
v_mfma_f32_16x16x32_bf16 v[28:31], a[188:191], a[32:35], v[28:31]
v_exp_f32 v20, v20
v_smfmac_f32_16x16x64_bf16 v[52:55], v[12:15], v[40:47], v1
buffer_load_dwordx4 v2, s[16:19], s81 offen offset:0 lds
v_mfma_f32_16x16x32_bf16 v[96:99], a[192:195], v[40:43], v[96:99]
v_lshlrev_b32 v234, 16, v213
v_and_b32 v235, 0xffff0000, v213
v_lshlrev_b32 v236, 16, v214
v_and_b32 v237, 0xffff0000, v214
v_lshlrev_b32 v238, 16, v215
v_and_b32 v239, 0xffff0000, v215
v_pk_mul_f32 v[232:233], v[232:233], v[250:251] op_sel_hi:[1,0]
v_pk_mul_f32 v[234:235], v[234:235], v[250:251] op_sel_hi:[1,0]
v_pk_mul_f32 v[236:237], v[236:237], v[250:251] op_sel_hi:[1,0]
v_pk_mul_f32 v[238:239], v[238:239], v[250:251] op_sel_hi:[1,0]
v_mfma_f32_16x16x32_bf16 v[96:99], a[196:199], v[44:47], v[96:99]
v_exp_f32 v21, v21
v_mfma_f32_16x16x32_bf16 v[100:103], a[200:203], v[44:47], v[100:103]
v_cvt_pk_bf16_f32 v34, v20, v21
v_cvt_pk_bf16_f32 v212, v232, v233
v_mfma_f32_16x16x32_bf16 v[100:103], a[204:207], v[40:43], v[100:103]
L_pg3:
s_cbranch_vccnz L_pg7
v_exp_f32 v22, v22
v_mfma_f32_16x16x32_bf16 v[104:107], a[208:211], v[40:43], v[104:107]
v_cvt_pk_bf16_f32 v213, v234, v235
v_cvt_pk_bf16_f32 v214, v236, v237
v_mfma_f32_16x16x32_bf16 v[104:107], a[212:215], v[44:47], v[104:107]
v_exp_f32 v23, v23
v_mfma_f32_16x16x32_bf16 v[108:111], a[216:219], v[44:47], v[108:111]
buffer_load_dwordx4 v2, s[16:19], s81 offen offset:2048 lds
v_cvt_pk_bf16_f32 v35, v22, v23
v_mfma_f32_16x16x32_bf16 v[108:111], a[220:223], v[40:43], v[108:111]
v_exp_f32 v24, v24
v_mfma_f32_16x16x32_bf16 v[112:115], a[224:227], v[40:43], v[112:115]
s_waitcnt vmcnt(15)
v_cvt_pk_bf16_f32 v215, v238, v239
v_lshlrev_b32 v232, 16, v216
v_mfma_f32_16x16x32_bf16 v[112:115], a[228:231], v[44:47], v[112:115]
v_exp_f32 v25, v25
v_mfma_f32_16x16x32_bf16 v[116:119], a[232:235], v[44:47], v[116:119]
ds_write_b128 v251, v[212:215] offset:36864
v_cvt_pk_bf16_f32 v36, v24, v25
v_mfma_f32_16x16x32_bf16 v[116:119], a[236:239], v[40:43], v[116:119]
v_exp_f32 v26, v26
v_mfma_f32_16x16x32_bf16 v[120:123], a[240:243], v[40:43], v[120:123]
buffer_load_dwordx4 a[88:91], v0, s[8:11], s37 offen offset:128 nt
v_and_b32 v233, 0xffff0000, v216
v_mfma_f32_16x16x32_bf16 v[120:123], a[244:247], v[44:47], v[120:123]
v_exp_f32 v27, v27
v_mfma_f32_16x16x32_bf16 v[124:127], a[248:251], v[44:47], v[124:127]
v_cvt_pk_bf16_f32 v37, v26, v27
v_lshlrev_b32 v234, 16, v217
v_mfma_f32_16x16x32_bf16 v[124:127], a[252:255], v[40:43], v[124:127]
v_exp_f32 v28, v28
v_mfma_f32_16x16x32_bf16 v[16:19], a[128:131], a[48:51], -4.0
ds_read_b128 a[128:131], v4 offset:16384
v_and_b32 v235, 0xffff0000, v217
v_lshlrev_b32 v236, 16, v218
v_and_b32 v237, 0xffff0000, v218
v_lshlrev_b32 v238, 16, v219
v_and_b32 v239, 0xffff0000, v219
v_pk_mul_f32 v[232:233], v[232:233], v[250:251] op_sel_hi:[1,0]
v_pk_mul_f32 v[234:235], v[234:235], v[250:251] op_sel_hi:[1,0]
v_pk_mul_f32 v[236:237], v[236:237], v[250:251] op_sel_hi:[1,0]
v_pk_mul_f32 v[238:239], v[238:239], v[250:251] op_sel_hi:[1,0]
v_mfma_f32_16x16x32_bf16 v[16:19], a[132:135], a[52:55], v[16:19]
v_exp_f32 v29, v29
v_mfma_f32_16x16x32_bf16 v[16:19], a[136:139], a[56:59], v[16:19]
ds_read_b128 a[132:135], v5 offset:16384
v_cvt_pk_bf16_f32 v216, v232, v233
v_mfma_f32_16x16x32_bf16 v[16:19], a[140:143], a[60:63], v[16:19]
v_exp_f32 v30, v30
v_mfma_f32_16x16x32_bf16 v[20:23], a[144:147], a[60:63], -4.0
ds_read_b128 a[136:139], v6 offset:16384
v_cvt_pk_bf16_f32 v38, v28, v29
v_mfma_f32_16x16x32_bf16 v[20:23], a[148:151], a[56:59], v[20:23]
v_exp_f32 v31, v31
v_mfma_f32_16x16x32_bf16 v[20:23], a[152:155], a[52:55], v[20:23]
ds_read_b128 a[140:143], v7 offset:16384
v_cvt_pk_bf16_f32 v39, v30, v31
v_mfma_f32_16x16x32_bf16 v[20:23], a[156:159], a[48:51], v[20:23]
v_exp_f32 v16, v16
v_mfma_f32_16x16x32_bf16 v[24:27], a[160:163], a[48:51], -4.0
ds_read_b128 a[144:147], v7 offset:20480
v_cvt_pk_bf16_f32 v217, v234, v235
v_mfma_f32_16x16x32_bf16 v[24:27], a[164:167], a[52:55], v[24:27]
v_exp_f32 v17, v17
v_mfma_f32_16x16x32_bf16 v[24:27], a[168:171], a[56:59], v[24:27]
ds_read_b128 a[148:151], v6 offset:20480
v_cvt_pk_bf16_f32 v40, v16, v17
v_mfma_f32_16x16x32_bf16 v[24:27], a[172:175], a[60:63], v[24:27]
v_exp_f32 v18, v18
v_mfma_f32_16x16x32_bf16 v[28:31], a[176:179], a[60:63], -4.0
ds_read_b128 a[152:155], v5 offset:20480
v_cvt_pk_bf16_f32 v218, v236, v237
v_mfma_f32_16x16x32_bf16 v[28:31], a[180:183], a[56:59], v[28:31]
v_exp_f32 v19, v19
v_mfma_f32_16x16x32_bf16 v[28:31], a[184:187], a[52:55], v[28:31]
ds_read_b128 a[156:159], v4 offset:20480
v_cvt_pk_bf16_f32 v41, v18, v19
v_mfma_f32_16x16x32_bf16 v[28:31], a[188:191], a[48:51], v[28:31]
v_exp_f32 v20, v20
v_smfmac_f32_16x16x64_bf16 v[56:59], v[12:15], v[32:39], v1
ds_read_b128 a[160:163], v4 offset:24576
v_mfma_f32_16x16x32_bf16 v[128:131], a[192:195], v[32:35], v[128:131]
ds_read_b128 a[164:167], v5 offset:24576
buffer_load_dwordx4 a[92:95], v0, s[8:11], s37 offen offset:192 nt
v_mfma_f32_16x16x32_bf16 v[128:131], a[196:199], v[36:39], v[128:131]
v_exp_f32 v21, v21
v_mfma_f32_16x16x32_bf16 v[132:135], a[200:203], v[36:39], v[132:135]
ds_read_b128 a[168:171], v6 offset:24576
v_cvt_pk_bf16_f32 v42, v20, v21
v_mfma_f32_16x16x32_bf16 v[132:135], a[204:207], v[32:35], v[132:135]
v_exp_f32 v22, v22
v_mfma_f32_16x16x32_bf16 v[136:139], a[208:211], v[32:35], v[136:139]
ds_read_b128 a[172:175], v7 offset:24576
v_cvt_pk_bf16_f32 v219, v238, v239
v_mfma_f32_16x16x32_bf16 v[136:139], a[212:215], v[36:39], v[136:139]
v_exp_f32 v23, v23
v_mfma_f32_16x16x32_bf16 v[140:143], a[216:219], v[36:39], v[140:143]
ds_read_b128 a[176:179], v7 offset:28672
v_cvt_pk_bf16_f32 v43, v22, v23
v_mfma_f32_16x16x32_bf16 v[140:143], a[220:223], v[32:35], v[140:143]
v_exp_f32 v24, v24
v_mfma_f32_16x16x32_bf16 v[144:147], a[224:227], v[32:35], v[144:147]
ds_read_b128 a[180:183], v6 offset:28672
v_lshlrev_b32 v232, 16, v220
v_mfma_f32_16x16x32_bf16 v[144:147], a[228:231], v[36:39], v[144:147]
v_exp_f32 v25, v25
v_mfma_f32_16x16x32_bf16 v[148:151], a[232:235], v[36:39], v[148:151]
ds_read_b128 a[184:187], v5 offset:28672
v_cvt_pk_bf16_f32 v44, v24, v25
v_mfma_f32_16x16x32_bf16 v[148:151], a[236:239], v[32:35], v[148:151]
v_exp_f32 v26, v26
v_mfma_f32_16x16x32_bf16 v[152:155], a[240:243], v[32:35], v[152:155]
ds_read_b128 a[188:191], v4 offset:28672
v_and_b32 v233, 0xffff0000, v220
v_mfma_f32_16x16x32_bf16 v[152:155], a[244:247], v[36:39], v[152:155]
v_exp_f32 v27, v27
v_mfma_f32_16x16x32_bf16 v[156:159], a[248:251], v[36:39], v[156:159]
ds_write_b128 v251, v[216:219] offset:40960
v_cvt_pk_bf16_f32 v45, v26, v27
v_mfma_f32_16x16x32_bf16 v[156:159], a[252:255], v[32:35], v[156:159]
s_waitcnt lgkmcnt(13)
v_exp_f32 v28, v28
v_mfma_f32_16x16x32_bf16 v[16:19], a[128:131], a[0:3], -4.0
v_lshlrev_b32 v234, 16, v221
v_and_b32 v235, 0xffff0000, v221
v_lshlrev_b32 v236, 16, v222
v_and_b32 v237, 0xffff0000, v222
v_lshlrev_b32 v238, 16, v223
v_and_b32 v239, 0xffff0000, v223
v_pk_mul_f32 v[232:233], v[232:233], v[250:251] op_sel_hi:[1,0]
v_pk_mul_f32 v[234:235], v[234:235], v[250:251] op_sel_hi:[1,0]
v_pk_mul_f32 v[236:237], v[236:237], v[250:251] op_sel_hi:[1,0]
v_pk_mul_f32 v[238:239], v[238:239], v[250:251] op_sel_hi:[1,0]
v_mfma_f32_16x16x32_bf16 v[16:19], a[132:135], a[4:7], v[16:19]
v_exp_f32 v29, v29
v_mfma_f32_16x16x32_bf16 v[16:19], a[136:139], a[8:11], v[16:19]
buffer_load_dwordx4 a[96:99], v0, s[8:11], s38 offen offset:0 nt
v_cvt_pk_bf16_f32 v220, v232, v233
v_mfma_f32_16x16x32_bf16 v[16:19], a[140:143], a[12:15], v[16:19]
s_waitcnt lgkmcnt(9)
v_exp_f32 v30, v30
v_mfma_f32_16x16x32_bf16 v[20:23], a[144:147], a[12:15], -4.0
v_cvt_pk_bf16_f32 v46, v28, v29
v_cvt_pk_bf16_f32 v221, v234, v235
v_mfma_f32_16x16x32_bf16 v[20:23], a[148:151], a[8:11], v[20:23]
v_exp_f32 v31, v31
v_mfma_f32_16x16x32_bf16 v[20:23], a[152:155], a[4:7], v[20:23]
v_cvt_pk_bf16_f32 v47, v30, v31
v_cvt_pk_bf16_f32 v222, v236, v237
v_mfma_f32_16x16x32_bf16 v[20:23], a[156:159], a[0:3], v[20:23]
s_waitcnt lgkmcnt(5)
v_exp_f32 v16, v16
v_mfma_f32_16x16x32_bf16 v[24:27], a[160:163], a[0:3], -4.0
v_cvt_pk_bf16_f32 v223, v238, v239
v_mfma_f32_16x16x32_bf16 v[24:27], a[164:167], a[4:7], v[24:27]
v_exp_f32 v17, v17
v_mfma_f32_16x16x32_bf16 v[24:27], a[168:171], a[8:11], v[24:27]
ds_write_b128 v251, v[220:223] offset:45056
v_cvt_pk_bf16_f32 v32, v16, v17
v_mfma_f32_16x16x32_bf16 v[24:27], a[172:175], a[12:15], v[24:27]
s_waitcnt lgkmcnt(2)
v_exp_f32 v18, v18
v_mfma_f32_16x16x32_bf16 v[28:31], a[176:179], a[12:15], -4.0
v_mfma_f32_16x16x32_bf16 v[28:31], a[180:183], a[8:11], v[28:31]
v_exp_f32 v19, v19
v_mfma_f32_16x16x32_bf16 v[28:31], a[184:187], a[4:7], v[28:31]
v_cvt_pk_bf16_f32 v33, v18, v19
v_mfma_f32_16x16x32_bf16 v[28:31], a[188:191], a[0:3], v[28:31]
s_waitcnt vmcnt(14)
v_exp_f32 v20, v20
v_smfmac_f32_16x16x64_bf16 v[60:63], v[12:15], v[40:47], v1
s_barrier
v_mfma_f32_16x16x32_bf16 v[160:163], a[192:195], v[40:43], v[160:163]
ds_read_b64_tr_b16 a[192:193], v8 offset:16384
ds_read_b64_tr_b16 a[194:195], v8 offset:20480
v_mfma_f32_16x16x32_bf16 v[160:163], a[196:199], v[44:47], v[160:163]
v_exp_f32 v21, v21
v_mfma_f32_16x16x32_bf16 v[164:167], a[200:203], v[44:47], v[164:167]
ds_read_b64_tr_b16 a[196:197], v8 offset:24576
v_cvt_pk_bf16_f32 v34, v20, v21
v_mfma_f32_16x16x32_bf16 v[164:167], a[204:207], v[40:43], v[164:167]
v_exp_f32 v22, v22
v_mfma_f32_16x16x32_bf16 v[168:171], a[208:211], v[40:43], v[168:171]
ds_read_b64_tr_b16 a[198:199], v8 offset:28672
ds_read_b64_tr_b16 a[200:201], v9 offset:24576
v_mfma_f32_16x16x32_bf16 v[168:171], a[212:215], v[44:47], v[168:171]
v_exp_f32 v23, v23
v_mfma_f32_16x16x32_bf16 v[172:175], a[216:219], v[44:47], v[172:175]
ds_read_b64_tr_b16 a[202:203], v9 offset:28672
v_cvt_pk_bf16_f32 v35, v22, v23
v_mfma_f32_16x16x32_bf16 v[172:175], a[220:223], v[40:43], v[172:175]
v_exp_f32 v24, v24
v_mfma_f32_16x16x32_bf16 v[176:179], a[224:227], v[40:43], v[176:179]
ds_read_b64_tr_b16 a[204:205], v9 offset:16384
ds_read_b64_tr_b16 a[206:207], v9 offset:20480
v_mfma_f32_16x16x32_bf16 v[176:179], a[228:231], v[44:47], v[176:179]
v_exp_f32 v25, v25
v_mfma_f32_16x16x32_bf16 v[180:183], a[232:235], v[44:47], v[180:183]
ds_read_b64_tr_b16 a[208:209], v10 offset:16384
v_cvt_pk_bf16_f32 v36, v24, v25
v_mfma_f32_16x16x32_bf16 v[180:183], a[236:239], v[40:43], v[180:183]
v_exp_f32 v26, v26
v_mfma_f32_16x16x32_bf16 v[184:187], a[240:243], v[40:43], v[184:187]
ds_read_b64_tr_b16 a[210:211], v10 offset:20480
ds_read_b64_tr_b16 a[212:213], v10 offset:24576
v_mfma_f32_16x16x32_bf16 v[184:187], a[244:247], v[44:47], v[184:187]
v_exp_f32 v27, v27
v_mfma_f32_16x16x32_bf16 v[188:191], a[248:251], v[44:47], v[188:191]
ds_read_b64_tr_b16 a[214:215], v10 offset:28672
v_cvt_pk_bf16_f32 v37, v26, v27
v_mfma_f32_16x16x32_bf16 v[188:191], a[252:255], v[40:43], v[188:191]
v_exp_f32 v28, v28
v_mfma_f32_16x16x32_bf16 v[16:19], a[128:131], a[16:19], -4.0
ds_read_b64_tr_b16 a[216:217], v11 offset:24576
ds_read_b64_tr_b16 a[218:219], v11 offset:28672
v_mfma_f32_16x16x32_bf16 v[16:19], a[132:135], a[20:23], v[16:19]
v_exp_f32 v29, v29
v_mfma_f32_16x16x32_bf16 v[16:19], a[136:139], a[24:27], v[16:19]
ds_read_b64_tr_b16 a[220:221], v11 offset:16384
ds_read_b64_tr_b16 a[222:223], v11 offset:20480
v_mfma_f32_16x16x32_bf16 v[16:19], a[140:143], a[28:31], v[16:19]
v_exp_f32 v30, v30
v_mfma_f32_16x16x32_bf16 v[20:23], a[144:147], a[28:31], -4.0
ds_read_b64_tr_b16 a[224:225], v8 offset:17408
v_cvt_pk_bf16_f32 v38, v28, v29
v_mfma_f32_16x16x32_bf16 v[20:23], a[148:151], a[24:27], v[20:23]
v_exp_f32 v31, v31
v_mfma_f32_16x16x32_bf16 v[20:23], a[152:155], a[20:23], v[20:23]
ds_read_b64_tr_b16 a[226:227], v8 offset:21504
v_cvt_pk_bf16_f32 v39, v30, v31
v_mfma_f32_16x16x32_bf16 v[20:23], a[156:159], a[16:19], v[20:23]
v_exp_f32 v16, v16
v_mfma_f32_16x16x32_bf16 v[24:27], a[160:163], a[16:19], -4.0
ds_read_b64_tr_b16 a[228:229], v8 offset:25600
ds_read_b64_tr_b16 a[230:231], v8 offset:29696
v_mfma_f32_16x16x32_bf16 v[24:27], a[164:167], a[20:23], v[24:27]
v_exp_f32 v17, v17
v_mfma_f32_16x16x32_bf16 v[24:27], a[168:171], a[24:27], v[24:27]
ds_read_b64_tr_b16 a[232:233], v9 offset:25600
v_cvt_pk_bf16_f32 v40, v16, v17
v_mfma_f32_16x16x32_bf16 v[24:27], a[172:175], a[28:31], v[24:27]
v_exp_f32 v18, v18
v_mfma_f32_16x16x32_bf16 v[28:31], a[176:179], a[28:31], -4.0
ds_read_b64_tr_b16 a[234:235], v9 offset:29696
ds_read_b64_tr_b16 a[236:237], v9 offset:17408
v_mfma_f32_16x16x32_bf16 v[28:31], a[180:183], a[24:27], v[28:31]
v_exp_f32 v19, v19
v_mfma_f32_16x16x32_bf16 v[28:31], a[184:187], a[20:23], v[28:31]
ds_read_b64_tr_b16 a[238:239], v9 offset:21504
v_cvt_pk_bf16_f32 v41, v18, v19
v_mfma_f32_16x16x32_bf16 v[28:31], a[188:191], a[16:19], v[28:31]
v_exp_f32 v20, v20
v_smfmac_f32_16x16x64_bf16 v[48:51], v[12:15], v[32:39], v1
s_waitcnt lgkmcnt(15)
ds_read_b64_tr_b16 a[240:241], v10 offset:17408
v_mfma_f32_16x16x32_bf16 v[64:67], a[192:195], v[32:35], v[64:67]
ds_read_b64_tr_b16 a[242:243], v10 offset:21504
ds_read_b64_tr_b16 a[244:245], v10 offset:25600
v_mfma_f32_16x16x32_bf16 v[64:67], a[196:199], v[36:39], v[64:67]
v_exp_f32 v21, v21
v_mfma_f32_16x16x32_bf16 v[68:71], a[200:203], v[36:39], v[68:71]
ds_read_b64_tr_b16 a[246:247], v10 offset:29696
v_cvt_pk_bf16_f32 v42, v20, v21
v_mfma_f32_16x16x32_bf16 v[68:71], a[204:207], v[32:35], v[68:71]
s_waitcnt lgkmcnt(15)
v_exp_f32 v22, v22
v_mfma_f32_16x16x32_bf16 v[72:75], a[208:211], v[32:35], v[72:75]
ds_read_b64_tr_b16 a[248:249], v11 offset:25600
ds_read_b64_tr_b16 a[250:251], v11 offset:29696
v_mfma_f32_16x16x32_bf16 v[72:75], a[212:215], v[36:39], v[72:75]
s_waitcnt lgkmcnt(14)
v_exp_f32 v23, v23
v_mfma_f32_16x16x32_bf16 v[76:79], a[216:219], v[36:39], v[76:79]
ds_read_b64_tr_b16 a[252:253], v11 offset:17408
v_cvt_pk_bf16_f32 v43, v22, v23
v_mfma_f32_16x16x32_bf16 v[76:79], a[220:223], v[32:35], v[76:79]
s_waitcnt lgkmcnt(11)
ds_read_b64_tr_b16 a[254:255], v11 offset:21504
v_exp_f32 v24, v24
v_mfma_f32_16x16x32_bf16 v[80:83], a[224:227], v[32:35], v[80:83]
s_waitcnt vmcnt(12)
buffer_load_dwordx4 a[100:103], v0, s[8:11], s38 offen offset:64 nt
v_lshlrev_b32 v232, 16, v224
v_mfma_f32_16x16x32_bf16 v[80:83], a[228:231], v[36:39], v[80:83]
s_waitcnt lgkmcnt(8)
v_exp_f32 v25, v25
v_mfma_f32_16x16x32_bf16 v[84:87], a[232:235], v[36:39], v[84:87]
v_cvt_pk_bf16_f32 v44, v24, v25
v_and_b32 v233, 0xffff0000, v224
v_mfma_f32_16x16x32_bf16 v[84:87], a[236:239], v[32:35], v[84:87]
s_waitcnt lgkmcnt(4)
v_exp_f32 v26, v26
v_mfma_f32_16x16x32_bf16 v[88:91], a[240:243], v[32:35], v[88:91]
v_lshlrev_b32 v234, 16, v225
v_and_b32 v235, 0xffff0000, v225
v_lshlrev_b32 v236, 16, v226
v_and_b32 v237, 0xffff0000, v226
v_lshlrev_b32 v238, 16, v227
v_and_b32 v239, 0xffff0000, v227
v_pk_mul_f32 v[232:233], v[232:233], v[250:251] op_sel_hi:[1,0]
v_pk_mul_f32 v[234:235], v[234:235], v[250:251] op_sel_hi:[1,0]
v_pk_mul_f32 v[236:237], v[236:237], v[250:251] op_sel_hi:[1,0]
v_pk_mul_f32 v[238:239], v[238:239], v[250:251] op_sel_hi:[1,0]
v_mfma_f32_16x16x32_bf16 v[88:91], a[244:247], v[36:39], v[88:91]
s_waitcnt lgkmcnt(0)
v_exp_f32 v27, v27
v_mfma_f32_16x16x32_bf16 v[92:95], a[248:251], v[36:39], v[92:95]
v_cvt_pk_bf16_f32 v45, v26, v27
v_cvt_pk_bf16_f32 v224, v232, v233
v_mfma_f32_16x16x32_bf16 v[92:95], a[252:255], v[32:35], v[92:95]
v_exp_f32 v28, v28
v_mfma_f32_16x16x32_bf16 v[16:19], a[128:131], a[32:35], -4.0
s_barrier
v_mfma_f32_16x16x32_bf16 v[16:19], a[132:135], a[36:39], v[16:19]
s_add_u32 m0, s24, 0x4000
v_exp_f32 v29, v29
v_mfma_f32_16x16x32_bf16 v[16:19], a[136:139], a[40:43], v[16:19]
buffer_load_dwordx4 v2, s[16:19], s82 offen offset:0 lds
v_cvt_pk_bf16_f32 v225, v234, v235
v_mfma_f32_16x16x32_bf16 v[16:19], a[140:143], a[44:47], v[16:19]
v_exp_f32 v30, v30
v_mfma_f32_16x16x32_bf16 v[20:23], a[144:147], a[44:47], -4.0
v_cvt_pk_bf16_f32 v46, v28, v29
v_cvt_pk_bf16_f32 v226, v236, v237
v_mfma_f32_16x16x32_bf16 v[20:23], a[148:151], a[40:43], v[20:23]
v_exp_f32 v31, v31
v_mfma_f32_16x16x32_bf16 v[20:23], a[152:155], a[36:39], v[20:23]
v_cvt_pk_bf16_f32 v47, v30, v31
v_cvt_pk_bf16_f32 v227, v238, v239
v_mfma_f32_16x16x32_bf16 v[20:23], a[156:159], a[32:35], v[20:23]
v_exp_f32 v16, v16
v_mfma_f32_16x16x32_bf16 v[24:27], a[160:163], a[32:35], -4.0
buffer_load_dwordx4 v2, s[16:19], s82 offen offset:2048 lds
ds_write_b128 v251, v[224:227] offset:49152
v_mfma_f32_16x16x32_bf16 v[24:27], a[164:167], a[36:39], v[24:27]
s_add_u32 m0, s24, 0x6000
v_exp_f32 v17, v17
v_mfma_f32_16x16x32_bf16 v[24:27], a[168:171], a[40:43], v[24:27]
v_cvt_pk_bf16_f32 v32, v16, v17
v_lshlrev_b32 v232, 16, v228
v_mfma_f32_16x16x32_bf16 v[24:27], a[172:175], a[44:47], v[24:27]
v_exp_f32 v18, v18
v_mfma_f32_16x16x32_bf16 v[28:31], a[176:179], a[44:47], -4.0
v_and_b32 v233, 0xffff0000, v228
v_lshlrev_b32 v234, 16, v229
v_mfma_f32_16x16x32_bf16 v[28:31], a[180:183], a[40:43], v[28:31]
v_exp_f32 v19, v19
v_mfma_f32_16x16x32_bf16 v[28:31], a[184:187], a[36:39], v[28:31]
buffer_load_dwordx4 v2, s[16:19], s83 offen offset:0 lds
v_cvt_pk_bf16_f32 v33, v18, v19
v_mfma_f32_16x16x32_bf16 v[28:31], a[188:191], a[32:35], v[28:31]
v_exp_f32 v20, v20
v_smfmac_f32_16x16x64_bf16 v[52:55], v[12:15], v[40:47], v1
v_and_b32 v235, 0xffff0000, v229
v_lshlrev_b32 v236, 16, v230
v_and_b32 v237, 0xffff0000, v230
v_lshlrev_b32 v238, 16, v231
v_and_b32 v239, 0xffff0000, v231
v_pk_mul_f32 v[232:233], v[232:233], v[250:251] op_sel_hi:[1,0]
v_pk_mul_f32 v[234:235], v[234:235], v[250:251] op_sel_hi:[1,0]
v_pk_mul_f32 v[236:237], v[236:237], v[250:251] op_sel_hi:[1,0]
v_pk_mul_f32 v[238:239], v[238:239], v[250:251] op_sel_hi:[1,0]
v_mfma_f32_16x16x32_bf16 v[96:99], a[192:195], v[40:43], v[96:99]
v_cvt_pk_bf16_f32 v228, v232, v233
v_cvt_pk_bf16_f32 v229, v234, v235
v_mfma_f32_16x16x32_bf16 v[96:99], a[196:199], v[44:47], v[96:99]
v_exp_f32 v21, v21
v_mfma_f32_16x16x32_bf16 v[100:103], a[200:203], v[44:47], v[100:103]
v_cvt_pk_bf16_f32 v34, v20, v21
v_cvt_pk_bf16_f32 v230, v236, v237
v_mfma_f32_16x16x32_bf16 v[100:103], a[204:207], v[40:43], v[100:103]
v_exp_f32 v22, v22
v_mfma_f32_16x16x32_bf16 v[104:107], a[208:211], v[40:43], v[104:107]
buffer_load_dwordx4 v2, s[16:19], s83 offen offset:2048 lds
v_cvt_pk_bf16_f32 v231, v238, v239
v_mfma_f32_16x16x32_bf16 v[104:107], a[212:215], v[44:47], v[104:107]
v_exp_f32 v23, v23
v_mfma_f32_16x16x32_bf16 v[108:111], a[216:219], v[44:47], v[108:111]
ds_write_b128 v251, v[228:231] offset:53248
v_cvt_pk_bf16_f32 v35, v22, v23
v_mfma_f32_16x16x32_bf16 v[108:111], a[220:223], v[40:43], v[108:111]
v_exp_f32 v24, v24
v_mfma_f32_16x16x32_bf16 v[112:115], a[224:227], v[40:43], v[112:115]
s_waitcnt vmcnt(12)
v_lshlrev_b32 v232, 16, v192
v_and_b32 v233, 0xffff0000, v192
v_mfma_f32_16x16x32_bf16 v[112:115], a[228:231], v[44:47], v[112:115]
v_exp_f32 v25, v25
v_mfma_f32_16x16x32_bf16 v[116:119], a[232:235], v[44:47], v[116:119]
buffer_load_dwordx4 a[104:107], v0, s[8:11], s38 offen offset:128 nt
v_cvt_pk_bf16_f32 v36, v24, v25
v_mfma_f32_16x16x32_bf16 v[116:119], a[236:239], v[40:43], v[116:119]
v_exp_f32 v26, v26
v_mfma_f32_16x16x32_bf16 v[120:123], a[240:243], v[40:43], v[120:123]
v_lshlrev_b32 v234, 16, v193
v_and_b32 v235, 0xffff0000, v193
v_lshlrev_b32 v236, 16, v194
v_and_b32 v237, 0xffff0000, v194
v_lshlrev_b32 v238, 16, v195
v_and_b32 v239, 0xffff0000, v195
v_pk_mul_f32 v[232:233], v[232:233], v[250:251] op_sel_hi:[1,0]
v_pk_mul_f32 v[234:235], v[234:235], v[250:251] op_sel_hi:[1,0]
v_pk_mul_f32 v[236:237], v[236:237], v[250:251] op_sel_hi:[1,0]
v_pk_mul_f32 v[238:239], v[238:239], v[250:251] op_sel_hi:[1,0]
v_mfma_f32_16x16x32_bf16 v[120:123], a[244:247], v[44:47], v[120:123]
v_exp_f32 v27, v27
v_mfma_f32_16x16x32_bf16 v[124:127], a[248:251], v[44:47], v[124:127]
v_cvt_pk_bf16_f32 v37, v26, v27
v_cvt_pk_bf16_f32 v192, v232, v233
v_mfma_f32_16x16x32_bf16 v[124:127], a[252:255], v[40:43], v[124:127]
v_exp_f32 v28, v28
v_mfma_f32_16x16x32_bf16 v[16:19], a[128:131], a[48:51], -4.0
ds_read_b128 a[128:131], v4 offset:32768
v_cvt_pk_bf16_f32 v193, v234, v235
v_mfma_f32_16x16x32_bf16 v[16:19], a[132:135], a[52:55], v[16:19]
v_exp_f32 v29, v29
v_mfma_f32_16x16x32_bf16 v[16:19], a[136:139], a[56:59], v[16:19]
ds_read_b128 a[132:135], v5 offset:32768
v_cvt_pk_bf16_f32 v194, v236, v237
v_mfma_f32_16x16x32_bf16 v[16:19], a[140:143], a[60:63], v[16:19]
v_exp_f32 v30, v30
v_mfma_f32_16x16x32_bf16 v[20:23], a[144:147], a[60:63], -4.0
ds_read_b128 a[136:139], v6 offset:32768
v_cvt_pk_bf16_f32 v38, v28, v29
v_mfma_f32_16x16x32_bf16 v[20:23], a[148:151], a[56:59], v[20:23]
v_exp_f32 v31, v31
v_mfma_f32_16x16x32_bf16 v[20:23], a[152:155], a[52:55], v[20:23]
ds_read_b128 a[140:143], v7 offset:32768
v_cvt_pk_bf16_f32 v39, v30, v31
v_mfma_f32_16x16x32_bf16 v[20:23], a[156:159], a[48:51], v[20:23]
v_exp_f32 v16, v16
v_mfma_f32_16x16x32_bf16 v[24:27], a[160:163], a[48:51], -4.0
ds_read_b128 a[144:147], v7 offset:36864
v_cvt_pk_bf16_f32 v195, v238, v239
v_mfma_f32_16x16x32_bf16 v[24:27], a[164:167], a[52:55], v[24:27]
v_exp_f32 v17, v17
v_mfma_f32_16x16x32_bf16 v[24:27], a[168:171], a[56:59], v[24:27]
ds_read_b128 a[148:151], v6 offset:36864
v_cvt_pk_bf16_f32 v40, v16, v17
v_mfma_f32_16x16x32_bf16 v[24:27], a[172:175], a[60:63], v[24:27]
v_exp_f32 v18, v18
v_mfma_f32_16x16x32_bf16 v[28:31], a[176:179], a[60:63], -4.0
ds_read_b128 a[152:155], v5 offset:36864
buffer_load_dwordx4 a[108:111], v0, s[8:11], s38 offen offset:192 nt
v_mfma_f32_16x16x32_bf16 v[28:31], a[180:183], a[56:59], v[28:31]
v_exp_f32 v19, v19
v_mfma_f32_16x16x32_bf16 v[28:31], a[184:187], a[52:55], v[28:31]
ds_read_b128 a[156:159], v4 offset:36864
v_cvt_pk_bf16_f32 v41, v18, v19
v_mfma_f32_16x16x32_bf16 v[28:31], a[188:191], a[48:51], v[28:31]
v_exp_f32 v20, v20
v_smfmac_f32_16x16x64_bf16 v[56:59], v[12:15], v[32:39], v1
ds_read_b128 a[160:163], v4 offset:40960
v_mfma_f32_16x16x32_bf16 v[128:131], a[192:195], v[32:35], v[128:131]
ds_read_b128 a[164:167], v5 offset:40960
v_lshlrev_b32 v232, 16, v196
v_mfma_f32_16x16x32_bf16 v[128:131], a[196:199], v[36:39], v[128:131]
v_exp_f32 v21, v21
v_mfma_f32_16x16x32_bf16 v[132:135], a[200:203], v[36:39], v[132:135]
ds_read_b128 a[168:171], v6 offset:40960
v_cvt_pk_bf16_f32 v42, v20, v21
v_mfma_f32_16x16x32_bf16 v[132:135], a[204:207], v[32:35], v[132:135]
v_exp_f32 v22, v22
v_mfma_f32_16x16x32_bf16 v[136:139], a[208:211], v[32:35], v[136:139]
ds_read_b128 a[172:175], v7 offset:40960
v_and_b32 v233, 0xffff0000, v196
v_mfma_f32_16x16x32_bf16 v[136:139], a[212:215], v[36:39], v[136:139]
v_exp_f32 v23, v23
v_mfma_f32_16x16x32_bf16 v[140:143], a[216:219], v[36:39], v[140:143]
ds_read_b128 a[176:179], v7 offset:45056
v_cvt_pk_bf16_f32 v43, v22, v23
v_mfma_f32_16x16x32_bf16 v[140:143], a[220:223], v[32:35], v[140:143]
v_exp_f32 v24, v24
v_mfma_f32_16x16x32_bf16 v[144:147], a[224:227], v[32:35], v[144:147]
ds_read_b128 a[180:183], v6 offset:45056
v_lshlrev_b32 v234, 16, v197
v_mfma_f32_16x16x32_bf16 v[144:147], a[228:231], v[36:39], v[144:147]
v_exp_f32 v25, v25
v_mfma_f32_16x16x32_bf16 v[148:151], a[232:235], v[36:39], v[148:151]
ds_read_b128 a[184:187], v5 offset:45056
v_cvt_pk_bf16_f32 v44, v24, v25
v_mfma_f32_16x16x32_bf16 v[148:151], a[236:239], v[32:35], v[148:151]
v_exp_f32 v26, v26
v_mfma_f32_16x16x32_bf16 v[152:155], a[240:243], v[32:35], v[152:155]
ds_read_b128 a[188:191], v4 offset:45056
buffer_load_dwordx4 a[112:115], v0, s[8:11], s39 offen offset:0 nt
v_mfma_f32_16x16x32_bf16 v[152:155], a[244:247], v[36:39], v[152:155]
v_exp_f32 v27, v27
v_mfma_f32_16x16x32_bf16 v[156:159], a[248:251], v[36:39], v[156:159]
ds_write_b128 v251, v[192:195] offset:57344
v_cvt_pk_bf16_f32 v45, v26, v27
v_mfma_f32_16x16x32_bf16 v[156:159], a[252:255], v[32:35], v[156:159]
s_waitcnt lgkmcnt(13)
v_exp_f32 v28, v28
v_mfma_f32_16x16x32_bf16 v[16:19], a[128:131], a[0:3], -4.0
v_and_b32 v235, 0xffff0000, v197
v_lshlrev_b32 v236, 16, v198
v_and_b32 v237, 0xffff0000, v198
v_lshlrev_b32 v238, 16, v199
v_and_b32 v239, 0xffff0000, v199
v_pk_mul_f32 v[232:233], v[232:233], v[250:251] op_sel_hi:[1,0]
v_pk_mul_f32 v[234:235], v[234:235], v[250:251] op_sel_hi:[1,0]
v_pk_mul_f32 v[236:237], v[236:237], v[250:251] op_sel_hi:[1,0]
v_pk_mul_f32 v[238:239], v[238:239], v[250:251] op_sel_hi:[1,0]
v_mfma_f32_16x16x32_bf16 v[16:19], a[132:135], a[4:7], v[16:19]
v_exp_f32 v29, v29
v_mfma_f32_16x16x32_bf16 v[16:19], a[136:139], a[8:11], v[16:19]
v_cvt_pk_bf16_f32 v196, v232, v233
v_cvt_pk_bf16_f32 v197, v234, v235
v_mfma_f32_16x16x32_bf16 v[16:19], a[140:143], a[12:15], v[16:19]
s_waitcnt lgkmcnt(9)
v_exp_f32 v30, v30
v_mfma_f32_16x16x32_bf16 v[20:23], a[144:147], a[12:15], -4.0
v_cvt_pk_bf16_f32 v46, v28, v29
v_cvt_pk_bf16_f32 v198, v236, v237
v_mfma_f32_16x16x32_bf16 v[20:23], a[148:151], a[8:11], v[20:23]
v_exp_f32 v31, v31
v_mfma_f32_16x16x32_bf16 v[20:23], a[152:155], a[4:7], v[20:23]
v_cvt_pk_bf16_f32 v47, v30, v31
v_cvt_pk_bf16_f32 v199, v238, v239
v_mfma_f32_16x16x32_bf16 v[20:23], a[156:159], a[0:3], v[20:23]
s_waitcnt lgkmcnt(5)
v_exp_f32 v16, v16
v_mfma_f32_16x16x32_bf16 v[24:27], a[160:163], a[0:3], -4.0
ds_write_b128 v251, v[196:199] offset:61440
v_mfma_f32_16x16x32_bf16 v[24:27], a[164:167], a[4:7], v[24:27]
v_exp_f32 v17, v17
v_mfma_f32_16x16x32_bf16 v[24:27], a[168:171], a[8:11], v[24:27]
v_cvt_pk_bf16_f32 v32, v16, v17
v_mfma_f32_16x16x32_bf16 v[24:27], a[172:175], a[12:15], v[24:27]
s_waitcnt lgkmcnt(2)
v_exp_f32 v18, v18
v_mfma_f32_16x16x32_bf16 v[28:31], a[176:179], a[12:15], -4.0
v_mfma_f32_16x16x32_bf16 v[28:31], a[180:183], a[8:11], v[28:31]
v_exp_f32 v19, v19
v_mfma_f32_16x16x32_bf16 v[28:31], a[184:187], a[4:7], v[28:31]
buffer_load_dwordx4 a[116:119], v0, s[8:11], s39 offen offset:64 nt
v_cvt_pk_bf16_f32 v33, v18, v19
v_mfma_f32_16x16x32_bf16 v[28:31], a[188:191], a[0:3], v[28:31]
s_waitcnt vmcnt(12)
v_exp_f32 v20, v20
v_smfmac_f32_16x16x64_bf16 v[60:63], v[12:15], v[40:47], v1
s_barrier
v_mfma_f32_16x16x32_bf16 v[160:163], a[192:195], v[40:43], v[160:163]
ds_read_b64_tr_b16 a[192:193], v8 offset:0
ds_read_b64_tr_b16 a[194:195], v8 offset:4096
v_mfma_f32_16x16x32_bf16 v[160:163], a[196:199], v[44:47], v[160:163]
v_exp_f32 v21, v21
v_mfma_f32_16x16x32_bf16 v[164:167], a[200:203], v[44:47], v[164:167]
ds_read_b64_tr_b16 a[196:197], v8 offset:8192
v_cvt_pk_bf16_f32 v34, v20, v21
v_mfma_f32_16x16x32_bf16 v[164:167], a[204:207], v[40:43], v[164:167]
v_exp_f32 v22, v22
v_mfma_f32_16x16x32_bf16 v[168:171], a[208:211], v[40:43], v[168:171]
ds_read_b64_tr_b16 a[198:199], v8 offset:12288
ds_read_b64_tr_b16 a[200:201], v9 offset:8192
v_mfma_f32_16x16x32_bf16 v[168:171], a[212:215], v[44:47], v[168:171]
v_exp_f32 v23, v23
v_mfma_f32_16x16x32_bf16 v[172:175], a[216:219], v[44:47], v[172:175]
ds_read_b64_tr_b16 a[202:203], v9 offset:12288
v_cvt_pk_bf16_f32 v35, v22, v23
v_mfma_f32_16x16x32_bf16 v[172:175], a[220:223], v[40:43], v[172:175]
v_exp_f32 v24, v24
v_mfma_f32_16x16x32_bf16 v[176:179], a[224:227], v[40:43], v[176:179]
ds_read_b64_tr_b16 a[204:205], v9 offset:0
ds_read_b64_tr_b16 a[206:207], v9 offset:4096
v_mfma_f32_16x16x32_bf16 v[176:179], a[228:231], v[44:47], v[176:179]
v_exp_f32 v25, v25
v_mfma_f32_16x16x32_bf16 v[180:183], a[232:235], v[44:47], v[180:183]
ds_read_b64_tr_b16 a[208:209], v10 offset:0
v_cvt_pk_bf16_f32 v36, v24, v25
v_mfma_f32_16x16x32_bf16 v[180:183], a[236:239], v[40:43], v[180:183]
v_exp_f32 v26, v26
v_mfma_f32_16x16x32_bf16 v[184:187], a[240:243], v[40:43], v[184:187]
ds_read_b64_tr_b16 a[210:211], v10 offset:4096
ds_read_b64_tr_b16 a[212:213], v10 offset:8192
v_mfma_f32_16x16x32_bf16 v[184:187], a[244:247], v[44:47], v[184:187]
v_exp_f32 v27, v27
v_mfma_f32_16x16x32_bf16 v[188:191], a[248:251], v[44:47], v[188:191]
ds_read_b64_tr_b16 a[214:215], v10 offset:12288
v_cvt_pk_bf16_f32 v37, v26, v27
v_mfma_f32_16x16x32_bf16 v[188:191], a[252:255], v[40:43], v[188:191]
v_exp_f32 v28, v28
v_mfma_f32_16x16x32_bf16 v[16:19], a[128:131], a[16:19], -4.0
ds_read_b64_tr_b16 a[216:217], v11 offset:8192
ds_read_b64_tr_b16 a[218:219], v11 offset:12288
v_mfma_f32_16x16x32_bf16 v[16:19], a[132:135], a[20:23], v[16:19]
L_pg4:
s_cbranch_vccnz L_pg8
v_exp_f32 v29, v29
v_mfma_f32_16x16x32_bf16 v[16:19], a[136:139], a[24:27], v[16:19]
ds_read_b64_tr_b16 a[220:221], v11 offset:0
ds_read_b64_tr_b16 a[222:223], v11 offset:4096
v_mfma_f32_16x16x32_bf16 v[16:19], a[140:143], a[28:31], v[16:19]
v_exp_f32 v30, v30
v_mfma_f32_16x16x32_bf16 v[20:23], a[144:147], a[28:31], -4.0
ds_read_b64_tr_b16 a[224:225], v8 offset:1024
v_cvt_pk_bf16_f32 v38, v28, v29
v_mfma_f32_16x16x32_bf16 v[20:23], a[148:151], a[24:27], v[20:23]
v_exp_f32 v31, v31
v_mfma_f32_16x16x32_bf16 v[20:23], a[152:155], a[20:23], v[20:23]
ds_read_b64_tr_b16 a[226:227], v8 offset:5120
v_cvt_pk_bf16_f32 v39, v30, v31
v_mfma_f32_16x16x32_bf16 v[20:23], a[156:159], a[16:19], v[20:23]
v_exp_f32 v16, v16
v_mfma_f32_16x16x32_bf16 v[24:27], a[160:163], a[16:19], -4.0
ds_read_b64_tr_b16 a[228:229], v8 offset:9216
ds_read_b64_tr_b16 a[230:231], v8 offset:13312
v_mfma_f32_16x16x32_bf16 v[24:27], a[164:167], a[20:23], v[24:27]
v_exp_f32 v17, v17
v_mfma_f32_16x16x32_bf16 v[24:27], a[168:171], a[24:27], v[24:27]
ds_read_b64_tr_b16 a[232:233], v9 offset:9216
v_cvt_pk_bf16_f32 v40, v16, v17
v_mfma_f32_16x16x32_bf16 v[24:27], a[172:175], a[28:31], v[24:27]
v_exp_f32 v18, v18
v_mfma_f32_16x16x32_bf16 v[28:31], a[176:179], a[28:31], -4.0
ds_read_b64_tr_b16 a[234:235], v9 offset:13312
ds_read_b64_tr_b16 a[236:237], v9 offset:1024
v_mfma_f32_16x16x32_bf16 v[28:31], a[180:183], a[24:27], v[28:31]
v_exp_f32 v19, v19
v_mfma_f32_16x16x32_bf16 v[28:31], a[184:187], a[20:23], v[28:31]
ds_read_b64_tr_b16 a[238:239], v9 offset:5120
v_cvt_pk_bf16_f32 v41, v18, v19
v_mfma_f32_16x16x32_bf16 v[28:31], a[188:191], a[16:19], v[28:31]
v_exp_f32 v20, v20
v_smfmac_f32_16x16x64_bf16 v[48:51], v[12:15], v[32:39], v1
s_waitcnt lgkmcnt(15)
ds_read_b64_tr_b16 a[240:241], v10 offset:1024
v_mfma_f32_16x16x32_bf16 v[64:67], a[192:195], v[32:35], v[64:67]
ds_read_b64_tr_b16 a[242:243], v10 offset:5120
ds_read_b64_tr_b16 a[244:245], v10 offset:9216
v_mfma_f32_16x16x32_bf16 v[64:67], a[196:199], v[36:39], v[64:67]
v_exp_f32 v21, v21
v_mfma_f32_16x16x32_bf16 v[68:71], a[200:203], v[36:39], v[68:71]
ds_read_b64_tr_b16 a[246:247], v10 offset:13312
v_cvt_pk_bf16_f32 v42, v20, v21
v_mfma_f32_16x16x32_bf16 v[68:71], a[204:207], v[32:35], v[68:71]
s_waitcnt lgkmcnt(15)
v_exp_f32 v22, v22
v_mfma_f32_16x16x32_bf16 v[72:75], a[208:211], v[32:35], v[72:75]
ds_read_b64_tr_b16 a[248:249], v11 offset:9216
ds_read_b64_tr_b16 a[250:251], v11 offset:13312
v_mfma_f32_16x16x32_bf16 v[72:75], a[212:215], v[36:39], v[72:75]
s_waitcnt lgkmcnt(14)
v_exp_f32 v23, v23
v_mfma_f32_16x16x32_bf16 v[76:79], a[216:219], v[36:39], v[76:79]
ds_read_b64_tr_b16 a[252:253], v11 offset:1024
v_cvt_pk_bf16_f32 v43, v22, v23
v_mfma_f32_16x16x32_bf16 v[76:79], a[220:223], v[32:35], v[76:79]
s_waitcnt lgkmcnt(11)
ds_read_b64_tr_b16 a[254:255], v11 offset:5120
v_exp_f32 v24, v24
v_mfma_f32_16x16x32_bf16 v[80:83], a[224:227], v[32:35], v[80:83]
buffer_load_dwordx4 a[120:123], v0, s[8:11], s39 offen offset:128 nt
v_mfma_f32_16x16x32_bf16 v[80:83], a[228:231], v[36:39], v[80:83]
s_waitcnt lgkmcnt(8)
v_exp_f32 v25, v25
v_mfma_f32_16x16x32_bf16 v[84:87], a[232:235], v[36:39], v[84:87]
v_cvt_pk_bf16_f32 v44, v24, v25
v_mfma_f32_16x16x32_bf16 v[84:87], a[236:239], v[32:35], v[84:87]
s_waitcnt lgkmcnt(4)
v_exp_f32 v26, v26
v_mfma_f32_16x16x32_bf16 v[88:91], a[240:243], v[32:35], v[88:91]
v_mfma_f32_16x16x32_bf16 v[88:91], a[244:247], v[36:39], v[88:91]
s_waitcnt lgkmcnt(0)
v_exp_f32 v27, v27
v_mfma_f32_16x16x32_bf16 v[92:95], a[248:251], v[36:39], v[92:95]
v_cvt_pk_bf16_f32 v45, v26, v27
v_mfma_f32_16x16x32_bf16 v[92:95], a[252:255], v[32:35], v[92:95]
v_exp_f32 v28, v28
v_mfma_f32_16x16x32_bf16 v[16:19], a[128:131], a[32:35], -4.0
s_barrier
v_mfma_f32_16x16x32_bf16 v[16:19], a[132:135], a[36:39], v[16:19]
v_exp_f32 v29, v29
v_mfma_f32_16x16x32_bf16 v[16:19], a[136:139], a[40:43], v[16:19]
v_mfma_f32_16x16x32_bf16 v[16:19], a[140:143], a[44:47], v[16:19]
v_exp_f32 v30, v30
v_mfma_f32_16x16x32_bf16 v[20:23], a[144:147], a[44:47], -4.0
v_cvt_pk_bf16_f32 v46, v28, v29
v_mfma_f32_16x16x32_bf16 v[20:23], a[148:151], a[40:43], v[20:23]
v_exp_f32 v31, v31
v_mfma_f32_16x16x32_bf16 v[20:23], a[152:155], a[36:39], v[20:23]
v_cvt_pk_bf16_f32 v47, v30, v31
v_mfma_f32_16x16x32_bf16 v[20:23], a[156:159], a[32:35], v[20:23]
v_exp_f32 v16, v16
v_mfma_f32_16x16x32_bf16 v[24:27], a[160:163], a[32:35], -4.0
v_mfma_f32_16x16x32_bf16 v[24:27], a[164:167], a[36:39], v[24:27]
v_exp_f32 v17, v17
v_mfma_f32_16x16x32_bf16 v[24:27], a[168:171], a[40:43], v[24:27]
buffer_load_dwordx4 a[124:127], v0, s[8:11], s39 offen offset:192 nt
v_cvt_pk_bf16_f32 v32, v16, v17
v_mfma_f32_16x16x32_bf16 v[24:27], a[172:175], a[44:47], v[24:27]
v_exp_f32 v18, v18
v_mfma_f32_16x16x32_bf16 v[28:31], a[176:179], a[44:47], -4.0
v_mfma_f32_16x16x32_bf16 v[28:31], a[180:183], a[40:43], v[28:31]
v_exp_f32 v19, v19
v_mfma_f32_16x16x32_bf16 v[28:31], a[184:187], a[36:39], v[28:31]
v_cvt_pk_bf16_f32 v33, v18, v19
v_mfma_f32_16x16x32_bf16 v[28:31], a[188:191], a[32:35], v[28:31]
v_exp_f32 v20, v20
v_smfmac_f32_16x16x64_bf16 v[52:55], v[12:15], v[40:47], v1
v_mfma_f32_16x16x32_bf16 v[96:99], a[192:195], v[40:43], v[96:99]
v_mfma_f32_16x16x32_bf16 v[96:99], a[196:199], v[44:47], v[96:99]
v_exp_f32 v21, v21
v_mfma_f32_16x16x32_bf16 v[100:103], a[200:203], v[44:47], v[100:103]
v_cvt_pk_bf16_f32 v34, v20, v21
v_mfma_f32_16x16x32_bf16 v[100:103], a[204:207], v[40:43], v[100:103]
v_exp_f32 v22, v22
v_mfma_f32_16x16x32_bf16 v[104:107], a[208:211], v[40:43], v[104:107]
v_mfma_f32_16x16x32_bf16 v[104:107], a[212:215], v[44:47], v[104:107]
v_exp_f32 v23, v23
v_mfma_f32_16x16x32_bf16 v[108:111], a[216:219], v[44:47], v[108:111]
v_cvt_pk_bf16_f32 v35, v22, v23
v_mfma_f32_16x16x32_bf16 v[108:111], a[220:223], v[40:43], v[108:111]
v_exp_f32 v24, v24
v_mfma_f32_16x16x32_bf16 v[112:115], a[224:227], v[40:43], v[112:115]
v_mfma_f32_16x16x32_bf16 v[112:115], a[228:231], v[44:47], v[112:115]
v_exp_f32 v25, v25
v_mfma_f32_16x16x32_bf16 v[116:119], a[232:235], v[44:47], v[116:119]
v_cvt_pk_bf16_f32 v36, v24, v25
v_mfma_f32_16x16x32_bf16 v[116:119], a[236:239], v[40:43], v[116:119]
v_exp_f32 v26, v26
v_mfma_f32_16x16x32_bf16 v[120:123], a[240:243], v[40:43], v[120:123]
v_mfma_f32_16x16x32_bf16 v[120:123], a[244:247], v[44:47], v[120:123]
v_exp_f32 v27, v27
v_mfma_f32_16x16x32_bf16 v[124:127], a[248:251], v[44:47], v[124:127]
v_cvt_pk_bf16_f32 v37, v26, v27
v_mfma_f32_16x16x32_bf16 v[124:127], a[252:255], v[40:43], v[124:127]
v_exp_f32 v28, v28
v_mfma_f32_16x16x32_bf16 v[16:19], a[128:131], a[48:51], -4.0
ds_read_b128 a[128:131], v4 offset:49152
v_mfma_f32_16x16x32_bf16 v[16:19], a[132:135], a[52:55], v[16:19]
v_exp_f32 v29, v29
v_mfma_f32_16x16x32_bf16 v[16:19], a[136:139], a[56:59], v[16:19]
ds_read_b128 a[132:135], v5 offset:49152
v_mfma_f32_16x16x32_bf16 v[16:19], a[140:143], a[60:63], v[16:19]
v_exp_f32 v30, v30
v_mfma_f32_16x16x32_bf16 v[20:23], a[144:147], a[60:63], -4.0
ds_read_b128 a[136:139], v6 offset:49152
v_cvt_pk_bf16_f32 v38, v28, v29
v_mfma_f32_16x16x32_bf16 v[20:23], a[148:151], a[56:59], v[20:23]
v_exp_f32 v31, v31
v_mfma_f32_16x16x32_bf16 v[20:23], a[152:155], a[52:55], v[20:23]
ds_read_b128 a[140:143], v7 offset:49152
v_cvt_pk_bf16_f32 v39, v30, v31
v_mfma_f32_16x16x32_bf16 v[20:23], a[156:159], a[48:51], v[20:23]
v_exp_f32 v16, v16
v_mfma_f32_16x16x32_bf16 v[24:27], a[160:163], a[48:51], -4.0
ds_read_b128 a[144:147], v7 offset:53248
v_mfma_f32_16x16x32_bf16 v[24:27], a[164:167], a[52:55], v[24:27]
v_exp_f32 v17, v17
v_mfma_f32_16x16x32_bf16 v[24:27], a[168:171], a[56:59], v[24:27]
ds_read_b128 a[148:151], v6 offset:53248
v_cvt_pk_bf16_f32 v40, v16, v17
v_mfma_f32_16x16x32_bf16 v[24:27], a[172:175], a[60:63], v[24:27]
v_exp_f32 v18, v18
v_mfma_f32_16x16x32_bf16 v[28:31], a[176:179], a[60:63], -4.0
ds_read_b128 a[152:155], v5 offset:53248
v_mfma_f32_16x16x32_bf16 v[28:31], a[180:183], a[56:59], v[28:31]
v_exp_f32 v19, v19
v_mfma_f32_16x16x32_bf16 v[28:31], a[184:187], a[52:55], v[28:31]
ds_read_b128 a[156:159], v4 offset:53248
v_cvt_pk_bf16_f32 v41, v18, v19
v_mfma_f32_16x16x32_bf16 v[28:31], a[188:191], a[48:51], v[28:31]
v_exp_f32 v20, v20
v_smfmac_f32_16x16x64_bf16 v[56:59], v[12:15], v[32:39], v1
ds_read_b128 a[160:163], v4 offset:57344
v_mfma_f32_16x16x32_bf16 v[128:131], a[192:195], v[32:35], v[128:131]
ds_read_b128 a[164:167], v5 offset:57344
v_mfma_f32_16x16x32_bf16 v[128:131], a[196:199], v[36:39], v[128:131]
v_exp_f32 v21, v21
v_mfma_f32_16x16x32_bf16 v[132:135], a[200:203], v[36:39], v[132:135]
ds_read_b128 a[168:171], v6 offset:57344
v_cvt_pk_bf16_f32 v42, v20, v21
v_mfma_f32_16x16x32_bf16 v[132:135], a[204:207], v[32:35], v[132:135]
v_exp_f32 v22, v22
v_mfma_f32_16x16x32_bf16 v[136:139], a[208:211], v[32:35], v[136:139]
ds_read_b128 a[172:175], v7 offset:57344
v_mfma_f32_16x16x32_bf16 v[136:139], a[212:215], v[36:39], v[136:139]
v_exp_f32 v23, v23
v_mfma_f32_16x16x32_bf16 v[140:143], a[216:219], v[36:39], v[140:143]
ds_read_b128 a[176:179], v7 offset:61440
v_cvt_pk_bf16_f32 v43, v22, v23
v_mfma_f32_16x16x32_bf16 v[140:143], a[220:223], v[32:35], v[140:143]
v_exp_f32 v24, v24
v_mfma_f32_16x16x32_bf16 v[144:147], a[224:227], v[32:35], v[144:147]
ds_read_b128 a[180:183], v6 offset:61440
v_mfma_f32_16x16x32_bf16 v[144:147], a[228:231], v[36:39], v[144:147]
v_exp_f32 v25, v25
v_mfma_f32_16x16x32_bf16 v[148:151], a[232:235], v[36:39], v[148:151]
ds_read_b128 a[184:187], v5 offset:61440
v_cvt_pk_bf16_f32 v44, v24, v25
v_mfma_f32_16x16x32_bf16 v[148:151], a[236:239], v[32:35], v[148:151]
v_exp_f32 v26, v26
v_mfma_f32_16x16x32_bf16 v[152:155], a[240:243], v[32:35], v[152:155]
ds_read_b128 a[188:191], v4 offset:61440
v_mfma_f32_16x16x32_bf16 v[152:155], a[244:247], v[36:39], v[152:155]
v_exp_f32 v27, v27
v_mfma_f32_16x16x32_bf16 v[156:159], a[248:251], v[36:39], v[156:159]
v_cvt_pk_bf16_f32 v45, v26, v27
v_mfma_f32_16x16x32_bf16 v[156:159], a[252:255], v[32:35], v[156:159]
s_waitcnt lgkmcnt(12)
v_exp_f32 v28, v28
v_mfma_f32_16x16x32_bf16 v[16:19], a[128:131], a[0:3], -4.0
v_mfma_f32_16x16x32_bf16 v[16:19], a[132:135], a[4:7], v[16:19]
v_exp_f32 v29, v29
v_mfma_f32_16x16x32_bf16 v[16:19], a[136:139], a[8:11], v[16:19]
v_mfma_f32_16x16x32_bf16 v[16:19], a[140:143], a[12:15], v[16:19]
s_waitcnt lgkmcnt(8)
v_exp_f32 v30, v30
v_mfma_f32_16x16x32_bf16 v[20:23], a[144:147], a[12:15], -4.0
v_cvt_pk_bf16_f32 v46, v28, v29
v_mfma_f32_16x16x32_bf16 v[20:23], a[148:151], a[8:11], v[20:23]
v_exp_f32 v31, v31
v_mfma_f32_16x16x32_bf16 v[20:23], a[152:155], a[4:7], v[20:23]
v_cvt_pk_bf16_f32 v47, v30, v31
v_mfma_f32_16x16x32_bf16 v[20:23], a[156:159], a[0:3], v[20:23]
s_waitcnt lgkmcnt(4)
v_exp_f32 v16, v16
v_mfma_f32_16x16x32_bf16 v[24:27], a[160:163], a[0:3], -4.0
v_mfma_f32_16x16x32_bf16 v[24:27], a[164:167], a[4:7], v[24:27]
v_exp_f32 v17, v17
v_mfma_f32_16x16x32_bf16 v[24:27], a[168:171], a[8:11], v[24:27]
v_cvt_pk_bf16_f32 v32, v16, v17
v_mfma_f32_16x16x32_bf16 v[24:27], a[172:175], a[12:15], v[24:27]
s_waitcnt lgkmcnt(0)
v_exp_f32 v18, v18
v_mfma_f32_16x16x32_bf16 v[28:31], a[176:179], a[12:15], -4.0
v_mfma_f32_16x16x32_bf16 v[28:31], a[180:183], a[8:11], v[28:31]
v_exp_f32 v19, v19
v_mfma_f32_16x16x32_bf16 v[28:31], a[184:187], a[4:7], v[28:31]
v_cvt_pk_bf16_f32 v33, v18, v19
v_mfma_f32_16x16x32_bf16 v[28:31], a[188:191], a[0:3], v[28:31]
s_waitcnt vmcnt(6)
v_exp_f32 v20, v20
v_smfmac_f32_16x16x64_bf16 v[60:63], v[12:15], v[40:47], v1
s_barrier
v_mfma_f32_16x16x32_bf16 v[160:163], a[192:195], v[40:43], v[160:163]
ds_read_b64_tr_b16 a[192:193], v8 offset:16384
ds_read_b64_tr_b16 a[194:195], v8 offset:20480
v_mfma_f32_16x16x32_bf16 v[160:163], a[196:199], v[44:47], v[160:163]
v_exp_f32 v21, v21
v_mfma_f32_16x16x32_bf16 v[164:167], a[200:203], v[44:47], v[164:167]
ds_read_b64_tr_b16 a[196:197], v8 offset:24576
v_cvt_pk_bf16_f32 v34, v20, v21
v_mfma_f32_16x16x32_bf16 v[164:167], a[204:207], v[40:43], v[164:167]
v_exp_f32 v22, v22
v_mfma_f32_16x16x32_bf16 v[168:171], a[208:211], v[40:43], v[168:171]
ds_read_b64_tr_b16 a[198:199], v8 offset:28672
ds_read_b64_tr_b16 a[200:201], v9 offset:24576
v_mfma_f32_16x16x32_bf16 v[168:171], a[212:215], v[44:47], v[168:171]
v_exp_f32 v23, v23
v_mfma_f32_16x16x32_bf16 v[172:175], a[216:219], v[44:47], v[172:175]
ds_read_b64_tr_b16 a[202:203], v9 offset:28672
v_cvt_pk_bf16_f32 v35, v22, v23
v_mfma_f32_16x16x32_bf16 v[172:175], a[220:223], v[40:43], v[172:175]
v_exp_f32 v24, v24
v_mfma_f32_16x16x32_bf16 v[176:179], a[224:227], v[40:43], v[176:179]
ds_read_b64_tr_b16 a[204:205], v9 offset:16384
ds_read_b64_tr_b16 a[206:207], v9 offset:20480
v_mfma_f32_16x16x32_bf16 v[176:179], a[228:231], v[44:47], v[176:179]
v_exp_f32 v25, v25
v_mfma_f32_16x16x32_bf16 v[180:183], a[232:235], v[44:47], v[180:183]
ds_read_b64_tr_b16 a[208:209], v10 offset:16384
v_cvt_pk_bf16_f32 v36, v24, v25
v_mfma_f32_16x16x32_bf16 v[180:183], a[236:239], v[40:43], v[180:183]
v_exp_f32 v26, v26
v_mfma_f32_16x16x32_bf16 v[184:187], a[240:243], v[40:43], v[184:187]
ds_read_b64_tr_b16 a[210:211], v10 offset:20480
ds_read_b64_tr_b16 a[212:213], v10 offset:24576
v_mfma_f32_16x16x32_bf16 v[184:187], a[244:247], v[44:47], v[184:187]
v_exp_f32 v27, v27
v_mfma_f32_16x16x32_bf16 v[188:191], a[248:251], v[44:47], v[188:191]
ds_read_b64_tr_b16 a[214:215], v10 offset:28672
v_cvt_pk_bf16_f32 v37, v26, v27
v_mfma_f32_16x16x32_bf16 v[188:191], a[252:255], v[40:43], v[188:191]
v_exp_f32 v28, v28
v_mfma_f32_16x16x32_bf16 v[16:19], a[128:131], a[16:19], -4.0
ds_read_b64_tr_b16 a[216:217], v11 offset:24576
ds_read_b64_tr_b16 a[218:219], v11 offset:28672
v_mfma_f32_16x16x32_bf16 v[16:19], a[132:135], a[20:23], v[16:19]
v_exp_f32 v29, v29
v_mfma_f32_16x16x32_bf16 v[16:19], a[136:139], a[24:27], v[16:19]
ds_read_b64_tr_b16 a[220:221], v11 offset:16384
ds_read_b64_tr_b16 a[222:223], v11 offset:20480
v_mfma_f32_16x16x32_bf16 v[16:19], a[140:143], a[28:31], v[16:19]
v_exp_f32 v30, v30
v_mfma_f32_16x16x32_bf16 v[20:23], a[144:147], a[28:31], -4.0
ds_read_b64_tr_b16 a[224:225], v8 offset:17408
v_cvt_pk_bf16_f32 v38, v28, v29
v_mfma_f32_16x16x32_bf16 v[20:23], a[148:151], a[24:27], v[20:23]
v_exp_f32 v31, v31
v_mfma_f32_16x16x32_bf16 v[20:23], a[152:155], a[20:23], v[20:23]
ds_read_b64_tr_b16 a[226:227], v8 offset:21504
v_cvt_pk_bf16_f32 v39, v30, v31
v_mfma_f32_16x16x32_bf16 v[20:23], a[156:159], a[16:19], v[20:23]
v_exp_f32 v16, v16
v_mfma_f32_16x16x32_bf16 v[24:27], a[160:163], a[16:19], -4.0
ds_read_b64_tr_b16 a[228:229], v8 offset:25600
ds_read_b64_tr_b16 a[230:231], v8 offset:29696
v_mfma_f32_16x16x32_bf16 v[24:27], a[164:167], a[20:23], v[24:27]
v_exp_f32 v17, v17
v_mfma_f32_16x16x32_bf16 v[24:27], a[168:171], a[24:27], v[24:27]
ds_read_b64_tr_b16 a[232:233], v9 offset:25600
v_cvt_pk_bf16_f32 v40, v16, v17
v_mfma_f32_16x16x32_bf16 v[24:27], a[172:175], a[28:31], v[24:27]
v_exp_f32 v18, v18
v_mfma_f32_16x16x32_bf16 v[28:31], a[176:179], a[28:31], -4.0
ds_read_b64_tr_b16 a[234:235], v9 offset:29696
ds_read_b64_tr_b16 a[236:237], v9 offset:17408
v_mfma_f32_16x16x32_bf16 v[28:31], a[180:183], a[24:27], v[28:31]
v_exp_f32 v19, v19
v_mfma_f32_16x16x32_bf16 v[28:31], a[184:187], a[20:23], v[28:31]
ds_read_b64_tr_b16 a[238:239], v9 offset:21504
v_cvt_pk_bf16_f32 v41, v18, v19
v_mfma_f32_16x16x32_bf16 v[28:31], a[188:191], a[16:19], v[28:31]
v_exp_f32 v20, v20
v_smfmac_f32_16x16x64_bf16 v[48:51], v[12:15], v[32:39], v1
s_waitcnt lgkmcnt(15)
ds_read_b64_tr_b16 a[240:241], v10 offset:17408
v_mfma_f32_16x16x32_bf16 v[64:67], a[192:195], v[32:35], v[64:67]
ds_read_b64_tr_b16 a[242:243], v10 offset:21504
ds_read_b64_tr_b16 a[244:245], v10 offset:25600
v_mfma_f32_16x16x32_bf16 v[64:67], a[196:199], v[36:39], v[64:67]
v_exp_f32 v21, v21
v_mfma_f32_16x16x32_bf16 v[68:71], a[200:203], v[36:39], v[68:71]
ds_read_b64_tr_b16 a[246:247], v10 offset:29696
v_cvt_pk_bf16_f32 v42, v20, v21
v_mfma_f32_16x16x32_bf16 v[68:71], a[204:207], v[32:35], v[68:71]
s_waitcnt lgkmcnt(15)
v_exp_f32 v22, v22
v_mfma_f32_16x16x32_bf16 v[72:75], a[208:211], v[32:35], v[72:75]
ds_read_b64_tr_b16 a[248:249], v11 offset:25600
ds_read_b64_tr_b16 a[250:251], v11 offset:29696
v_mfma_f32_16x16x32_bf16 v[72:75], a[212:215], v[36:39], v[72:75]
s_waitcnt lgkmcnt(14)
v_exp_f32 v23, v23
v_mfma_f32_16x16x32_bf16 v[76:79], a[216:219], v[36:39], v[76:79]
ds_read_b64_tr_b16 a[252:253], v11 offset:17408
v_cvt_pk_bf16_f32 v43, v22, v23
v_mfma_f32_16x16x32_bf16 v[76:79], a[220:223], v[32:35], v[76:79]
s_waitcnt lgkmcnt(11)
ds_read_b64_tr_b16 a[254:255], v11 offset:21504
v_exp_f32 v24, v24
v_mfma_f32_16x16x32_bf16 v[80:83], a[224:227], v[32:35], v[80:83]
v_add_f32 v51, v48, v49
v_rcp_f32 v50, v51
v_mfma_f32_16x16x32_bf16 v[80:83], a[228:231], v[36:39], v[80:83]
s_waitcnt lgkmcnt(8)
v_exp_f32 v25, v25
v_mfma_f32_16x16x32_bf16 v[84:87], a[232:235], v[36:39], v[84:87]
v_cvt_pk_bf16_f32 v44, v24, v25
v_subrev_u32 v51, 0x2f800000, v51
v_mfma_f32_16x16x32_bf16 v[84:87], a[236:239], v[32:35], v[84:87]
s_waitcnt lgkmcnt(4)
v_exp_f32 v26, v26
v_mfma_f32_16x16x32_bf16 v[88:91], a[240:243], v[32:35], v[88:91]
v_max_u32 v3, v3, v51
v_mov_b32 v48, 0
v_mfma_f32_16x16x32_bf16 v[88:91], a[244:247], v[36:39], v[88:91]
s_waitcnt lgkmcnt(0)
v_exp_f32 v27, v27
v_mfma_f32_16x16x32_bf16 v[92:95], a[248:251], v[36:39], v[92:95]
v_cvt_pk_bf16_f32 v45, v26, v27
v_mov_b32 v49, 0
v_mfma_f32_16x16x32_bf16 v[92:95], a[252:255], v[32:35], v[92:95]
v_exp_f32 v28, v28
v_mfma_f32_16x16x32_bf16 v[16:19], a[128:131], a[32:35], -4.0
s_barrier
v_mfma_f32_16x16x32_bf16 v[16:19], a[132:135], a[36:39], v[16:19]
s_add_u32 m0, s24, 0x4000
v_exp_f32 v29, v29
v_mfma_f32_16x16x32_bf16 v[16:19], a[136:139], a[40:43], v[16:19]
buffer_load_dwordx4 v2, s[16:19], s78 offen offset:0 lds
v_mov_b32 v51, 0
v_mfma_f32_16x16x32_bf16 v[16:19], a[140:143], a[44:47], v[16:19]
v_exp_f32 v30, v30
v_pk_mul_f32 v[64:65], v[64:65], v[50:51] op_sel_hi:[1,0]
v_pk_mul_f32 v[66:67], v[66:67], v[50:51] op_sel_hi:[1,0]
v_pk_mul_f32 v[68:69], v[68:69], v[50:51] op_sel_hi:[1,0]
v_pk_mul_f32 v[70:71], v[70:71], v[50:51] op_sel_hi:[1,0]
v_pk_mul_f32 v[72:73], v[72:73], v[50:51] op_sel_hi:[1,0]
v_pk_mul_f32 v[74:75], v[74:75], v[50:51] op_sel_hi:[1,0]
v_pk_mul_f32 v[76:77], v[76:77], v[50:51] op_sel_hi:[1,0]
v_pk_mul_f32 v[78:79], v[78:79], v[50:51] op_sel_hi:[1,0]
v_pk_mul_f32 v[80:81], v[80:81], v[50:51] op_sel_hi:[1,0]
v_pk_mul_f32 v[82:83], v[82:83], v[50:51] op_sel_hi:[1,0]
v_pk_mul_f32 v[84:85], v[84:85], v[50:51] op_sel_hi:[1,0]
v_pk_mul_f32 v[86:87], v[86:87], v[50:51] op_sel_hi:[1,0]
v_pk_mul_f32 v[88:89], v[88:89], v[50:51] op_sel_hi:[1,0]
v_pk_mul_f32 v[90:91], v[90:91], v[50:51] op_sel_hi:[1,0]
v_pk_mul_f32 v[92:93], v[92:93], v[50:51] op_sel_hi:[1,0]
v_pk_mul_f32 v[94:95], v[94:95], v[50:51] op_sel_hi:[1,0]
v_mfma_f32_16x16x32_bf16 v[20:23], a[144:147], a[44:47], -4.0
v_cvt_pk_bf16_f32 v46, v28, v29
v_cvt_pk_bf16_f32 v208, v64, v65
v_mfma_f32_16x16x32_bf16 v[20:23], a[148:151], a[40:43], v[20:23]
v_exp_f32 v31, v31
v_mfma_f32_16x16x32_bf16 v[20:23], a[152:155], a[36:39], v[20:23]
v_cvt_pk_bf16_f32 v47, v30, v31
v_cvt_pk_bf16_f32 v209, v66, v67
v_mfma_f32_16x16x32_bf16 v[20:23], a[156:159], a[32:35], v[20:23]
v_exp_f32 v16, v16
v_mfma_f32_16x16x32_bf16 v[24:27], a[160:163], a[32:35], -4.0
buffer_load_dwordx4 v2, s[16:19], s78 offen offset:2048 lds
v_cvt_pk_bf16_f32 v210, v68, v69
v_mfma_f32_16x16x32_bf16 v[24:27], a[164:167], a[36:39], v[24:27]
s_add_u32 m0, s24, 0x6000
v_exp_f32 v17, v17
v_mfma_f32_16x16x32_bf16 v[24:27], a[168:171], a[40:43], v[24:27]
v_cvt_pk_bf16_f32 v32, v16, v17
v_cvt_pk_bf16_f32 v211, v70, v71
v_mfma_f32_16x16x32_bf16 v[24:27], a[172:175], a[44:47], v[24:27]
v_exp_f32 v18, v18
v_mfma_f32_16x16x32_bf16 v[28:31], a[176:179], a[44:47], -4.0
v_cvt_pk_bf16_f32 v212, v72, v73
v_cvt_pk_bf16_f32 v213, v74, v75
v_mfma_f32_16x16x32_bf16 v[28:31], a[180:183], a[40:43], v[28:31]
v_exp_f32 v19, v19
v_mfma_f32_16x16x32_bf16 v[28:31], a[184:187], a[36:39], v[28:31]
buffer_load_dwordx4 a[0:3], v0, s[8:11], s40 offen offset:0 nt
v_cvt_pk_bf16_f32 v33, v18, v19
v_mfma_f32_16x16x32_bf16 v[28:31], a[188:191], a[32:35], v[28:31]
v_exp_f32 v20, v20
v_smfmac_f32_16x16x64_bf16 v[52:55], v[12:15], v[40:47], v1
v_cvt_pk_bf16_f32 v214, v76, v77
v_mfma_f32_16x16x32_bf16 v[96:99], a[192:195], v[40:43], v[96:99]
v_cvt_pk_bf16_f32 v215, v78, v79
v_cvt_pk_bf16_f32 v216, v80, v81
v_mfma_f32_16x16x32_bf16 v[96:99], a[196:199], v[44:47], v[96:99]
v_exp_f32 v21, v21
v_mfma_f32_16x16x32_bf16 v[100:103], a[200:203], v[44:47], v[100:103]
v_cvt_pk_bf16_f32 v34, v20, v21
v_cvt_pk_bf16_f32 v217, v82, v83
v_mfma_f32_16x16x32_bf16 v[100:103], a[204:207], v[40:43], v[100:103]
v_exp_f32 v22, v22
v_mfma_f32_16x16x32_bf16 v[104:107], a[208:211], v[40:43], v[104:107]
buffer_load_dwordx4 v2, s[16:19], s79 offen offset:0 lds
v_mfma_f32_16x16x32_bf16 v[104:107], a[212:215], v[44:47], v[104:107]
v_exp_f32 v23, v23
v_mfma_f32_16x16x32_bf16 v[108:111], a[216:219], v[44:47], v[108:111]
v_cvt_pk_bf16_f32 v35, v22, v23
v_add_f32 v55, v52, v53
v_mfma_f32_16x16x32_bf16 v[108:111], a[220:223], v[40:43], v[108:111]
v_exp_f32 v24, v24
v_mfma_f32_16x16x32_bf16 v[112:115], a[224:227], v[40:43], v[112:115]
v_rcp_f32 v54, v55
v_mfma_f32_16x16x32_bf16 v[112:115], a[228:231], v[44:47], v[112:115]
v_exp_f32 v25, v25
v_mfma_f32_16x16x32_bf16 v[116:119], a[232:235], v[44:47], v[116:119]
v_cvt_pk_bf16_f32 v36, v24, v25
v_cvt_pk_bf16_f32 v218, v84, v85
v_mfma_f32_16x16x32_bf16 v[116:119], a[236:239], v[40:43], v[116:119]
v_exp_f32 v26, v26
v_mfma_f32_16x16x32_bf16 v[120:123], a[240:243], v[40:43], v[120:123]
buffer_load_dwordx4 v2, s[16:19], s79 offen offset:2048 lds
v_mfma_f32_16x16x32_bf16 v[120:123], a[244:247], v[44:47], v[120:123]
v_exp_f32 v27, v27
v_mfma_f32_16x16x32_bf16 v[124:127], a[248:251], v[44:47], v[124:127]
v_cvt_pk_bf16_f32 v37, v26, v27
v_cvt_pk_bf16_f32 v219, v86, v87
v_mfma_f32_16x16x32_bf16 v[124:127], a[252:255], v[40:43], v[124:127]
v_exp_f32 v28, v28
v_mfma_f32_16x16x32_bf16 v[16:19], a[128:131], a[48:51], -4.0
v_cvt_pk_bf16_f32 v220, v88, v89
v_cvt_pk_bf16_f32 v221, v90, v91
v_mfma_f32_16x16x32_bf16 v[16:19], a[132:135], a[52:55], v[16:19]
v_exp_f32 v29, v29
v_mfma_f32_16x16x32_bf16 v[16:19], a[136:139], a[56:59], v[16:19]
buffer_load_dwordx4 a[4:7], v0, s[8:11], s40 offen offset:64 nt
v_cvt_pk_bf16_f32 v222, v92, v93
v_mfma_f32_16x16x32_bf16 v[16:19], a[140:143], a[60:63], v[16:19]
v_exp_f32 v30, v30
v_mfma_f32_16x16x32_bf16 v[20:23], a[144:147], a[60:63], -4.0
v_cvt_pk_bf16_f32 v38, v28, v29
v_cvt_pk_bf16_f32 v223, v94, v95
v_mfma_f32_16x16x32_bf16 v[20:23], a[148:151], a[56:59], v[20:23]
v_exp_f32 v31, v31
v_mfma_f32_16x16x32_bf16 v[20:23], a[152:155], a[52:55], v[20:23]
v_cvt_pk_bf16_f32 v39, v30, v31
v_subrev_u32 v55, 0x2f800000, v55
v_mfma_f32_16x16x32_bf16 v[20:23], a[156:159], a[48:51], v[20:23]
v_exp_f32 v16, v16
v_mfma_f32_16x16x32_bf16 v[24:27], a[160:163], a[48:51], -4.0
v_max_u32 v3, v3, v55
v_mov_b32 v52, 0
v_mfma_f32_16x16x32_bf16 v[24:27], a[164:167], a[52:55], v[24:27]
v_exp_f32 v17, v17
v_mfma_f32_16x16x32_bf16 v[24:27], a[168:171], a[56:59], v[24:27]
v_cvt_pk_bf16_f32 v40, v16, v17
v_mov_b32 v53, 0
v_mfma_f32_16x16x32_bf16 v[24:27], a[172:175], a[60:63], v[24:27]
v_exp_f32 v18, v18
v_mfma_f32_16x16x32_bf16 v[28:31], a[176:179], a[60:63], -4.0
v_mov_b32 v55, 0
v_mul_f32 v96, v54, v96
v_mfma_f32_16x16x32_bf16 v[28:31], a[180:183], a[56:59], v[28:31]
v_exp_f32 v19, v19
v_mfma_f32_16x16x32_bf16 v[28:31], a[184:187], a[52:55], v[28:31]
v_cvt_pk_bf16_f32 v41, v18, v19
v_mul_f32 v97, v54, v97
v_mfma_f32_16x16x32_bf16 v[28:31], a[188:191], a[48:51], v[28:31]
v_exp_f32 v20, v20
v_smfmac_f32_16x16x64_bf16 v[56:59], v[12:15], v[32:39], v1
v_mul_f32 v98, v54, v98
v_mfma_f32_16x16x32_bf16 v[128:131], a[192:195], v[32:35], v[128:131]
v_mul_f32 v99, v54, v99
v_cvt_pk_bf16_f32 v224, v96, v97
v_mfma_f32_16x16x32_bf16 v[128:131], a[196:199], v[36:39], v[128:131]
v_exp_f32 v21, v21
v_mfma_f32_16x16x32_bf16 v[132:135], a[200:203], v[36:39], v[132:135]
buffer_load_dwordx4 a[8:11], v0, s[8:11], s40 offen offset:128 nt
v_cvt_pk_bf16_f32 v42, v20, v21
v_mfma_f32_16x16x32_bf16 v[132:135], a[204:207], v[32:35], v[132:135]
v_exp_f32 v22, v22
v_mfma_f32_16x16x32_bf16 v[136:139], a[208:211], v[32:35], v[136:139]
v_add_f32 v59, v56, v57
v_rcp_f32 v58, v59
v_mfma_f32_16x16x32_bf16 v[136:139], a[212:215], v[36:39], v[136:139]
v_exp_f32 v23, v23
v_mfma_f32_16x16x32_bf16 v[140:143], a[216:219], v[36:39], v[140:143]
v_cvt_pk_bf16_f32 v43, v22, v23
v_cvt_pk_bf16_f32 v225, v98, v99
v_mfma_f32_16x16x32_bf16 v[140:143], a[220:223], v[32:35], v[140:143]
v_exp_f32 v24, v24
v_mfma_f32_16x16x32_bf16 v[144:147], a[224:227], v[32:35], v[144:147]
v_mul_f32 v100, v54, v100
v_mul_f32 v101, v54, v101
v_mfma_f32_16x16x32_bf16 v[144:147], a[228:231], v[36:39], v[144:147]
v_exp_f32 v25, v25
v_mfma_f32_16x16x32_bf16 v[148:151], a[232:235], v[36:39], v[148:151]
v_cvt_pk_bf16_f32 v44, v24, v25
v_mul_f32 v102, v54, v102
v_mfma_f32_16x16x32_bf16 v[148:151], a[236:239], v[32:35], v[148:151]
v_exp_f32 v26, v26
v_mfma_f32_16x16x32_bf16 v[152:155], a[240:243], v[32:35], v[152:155]
v_mul_f32 v103, v54, v103
v_cvt_pk_bf16_f32 v226, v100, v101
v_mfma_f32_16x16x32_bf16 v[152:155], a[244:247], v[36:39], v[152:155]
v_exp_f32 v27, v27
v_mfma_f32_16x16x32_bf16 v[156:159], a[248:251], v[36:39], v[156:159]
v_cvt_pk_bf16_f32 v45, v26, v27
v_cvt_pk_bf16_f32 v227, v102, v103
v_mfma_f32_16x16x32_bf16 v[156:159], a[252:255], v[32:35], v[156:159]
v_exp_f32 v28, v28
v_mfma_f32_16x16x32_bf16 v[16:19], a[128:131], a[64:67], -4.0
v_mul_f32 v104, v54, v104
v_mul_f32 v105, v54, v105
v_mfma_f32_16x16x32_bf16 v[16:19], a[132:135], a[68:71], v[16:19]
v_exp_f32 v29, v29
v_mfma_f32_16x16x32_bf16 v[16:19], a[136:139], a[72:75], v[16:19]
v_mul_f32 v106, v54, v106
v_mul_f32 v107, v54, v107
v_mfma_f32_16x16x32_bf16 v[16:19], a[140:143], a[76:79], v[16:19]
v_exp_f32 v30, v30
v_pk_mul_f32 v[128:129], v[128:129], v[58:59] op_sel_hi:[1,0]
v_pk_mul_f32 v[130:131], v[130:131], v[58:59] op_sel_hi:[1,0]
v_pk_mul_f32 v[132:133], v[132:133], v[58:59] op_sel_hi:[1,0]
v_pk_mul_f32 v[134:135], v[134:135], v[58:59] op_sel_hi:[1,0]
v_pk_mul_f32 v[136:137], v[136:137], v[58:59] op_sel_hi:[1,0]
v_pk_mul_f32 v[138:139], v[138:139], v[58:59] op_sel_hi:[1,0]
v_pk_mul_f32 v[140:141], v[140:141], v[58:59] op_sel_hi:[1,0]
v_pk_mul_f32 v[142:143], v[142:143], v[58:59] op_sel_hi:[1,0]
v_pk_mul_f32 v[144:145], v[144:145], v[58:59] op_sel_hi:[1,0]
v_pk_mul_f32 v[146:147], v[146:147], v[58:59] op_sel_hi:[1,0]
v_pk_mul_f32 v[148:149], v[148:149], v[58:59] op_sel_hi:[1,0]
v_pk_mul_f32 v[150:151], v[150:151], v[58:59] op_sel_hi:[1,0]
v_pk_mul_f32 v[152:153], v[152:153], v[58:59] op_sel_hi:[1,0]
v_pk_mul_f32 v[154:155], v[154:155], v[58:59] op_sel_hi:[1,0]
v_pk_mul_f32 v[156:157], v[156:157], v[58:59] op_sel_hi:[1,0]
v_pk_mul_f32 v[158:159], v[158:159], v[58:59] op_sel_hi:[1,0]
v_mfma_f32_16x16x32_bf16 v[20:23], a[144:147], a[76:79], -4.0
v_cvt_pk_bf16_f32 v46, v28, v29
v_cvt_pk_bf16_f32 v228, v104, v105
v_mfma_f32_16x16x32_bf16 v[20:23], a[148:151], a[72:75], v[20:23]
v_exp_f32 v31, v31
v_mfma_f32_16x16x32_bf16 v[20:23], a[152:155], a[68:71], v[20:23]
v_cvt_pk_bf16_f32 v47, v30, v31
v_cvt_pk_bf16_f32 v229, v106, v107
v_mfma_f32_16x16x32_bf16 v[20:23], a[156:159], a[64:67], v[20:23]
v_exp_f32 v16, v16
v_mfma_f32_16x16x32_bf16 v[24:27], a[160:163], a[64:67], -4.0
L_pg5:
s_cbranch_vccnz L_pg9
buffer_load_dwordx4 a[12:15], v0, s[8:11], s40 offen offset:192 nt
v_mul_f32 v108, v54, v108
v_mfma_f32_16x16x32_bf16 v[24:27], a[164:167], a[68:71], v[24:27]
v_exp_f32 v17, v17
v_mfma_f32_16x16x32_bf16 v[24:27], a[168:171], a[72:75], v[24:27]
v_cvt_pk_bf16_f32 v32, v16, v17
v_mul_f32 v109, v54, v109
v_mfma_f32_16x16x32_bf16 v[24:27], a[172:175], a[76:79], v[24:27]
v_exp_f32 v18, v18
v_mfma_f32_16x16x32_bf16 v[28:31], a[176:179], a[76:79], -4.0
v_mul_f32 v110, v54, v110
v_mul_f32 v111, v54, v111
v_mfma_f32_16x16x32_bf16 v[28:31], a[180:183], a[72:75], v[28:31]
v_exp_f32 v19, v19
v_mfma_f32_16x16x32_bf16 v[28:31], a[184:187], a[68:71], v[28:31]
v_cvt_pk_bf16_f32 v33, v18, v19
v_cvt_pk_bf16_f32 v230, v108, v109
v_mfma_f32_16x16x32_bf16 v[28:31], a[188:191], a[64:67], v[28:31]
v_exp_f32 v20, v20
v_smfmac_f32_16x16x64_bf16 v[60:63], v[12:15], v[40:47], v1
v_cvt_pk_bf16_f32 v231, v110, v111
v_mfma_f32_16x16x32_bf16 v[160:163], a[192:195], v[40:43], v[160:163]
v_mul_f32 v112, v54, v112
v_mul_f32 v113, v54, v113
v_mfma_f32_16x16x32_bf16 v[160:163], a[196:199], v[44:47], v[160:163]
v_exp_f32 v21, v21
v_mfma_f32_16x16x32_bf16 v[164:167], a[200:203], v[44:47], v[164:167]
v_cvt_pk_bf16_f32 v34, v20, v21
v_mul_f32 v114, v54, v114
v_mfma_f32_16x16x32_bf16 v[164:167], a[204:207], v[40:43], v[164:167]
v_exp_f32 v22, v22
v_mfma_f32_16x16x32_bf16 v[168:171], a[208:211], v[40:43], v[168:171]
v_add_f32 v63, v60, v61
v_rcp_f32 v62, v63
v_mfma_f32_16x16x32_bf16 v[168:171], a[212:215], v[44:47], v[168:171]
v_exp_f32 v23, v23
v_mfma_f32_16x16x32_bf16 v[172:175], a[216:219], v[44:47], v[172:175]
v_cvt_pk_bf16_f32 v35, v22, v23
v_mul_f32 v115, v54, v115
v_mfma_f32_16x16x32_bf16 v[172:175], a[220:223], v[40:43], v[172:175]
v_exp_f32 v24, v24
v_mfma_f32_16x16x32_bf16 v[176:179], a[224:227], v[40:43], v[176:179]
v_cvt_pk_bf16_f32 v232, v112, v113
v_cvt_pk_bf16_f32 v233, v114, v115
v_mfma_f32_16x16x32_bf16 v[176:179], a[228:231], v[44:47], v[176:179]
v_exp_f32 v25, v25
v_mfma_f32_16x16x32_bf16 v[180:183], a[232:235], v[44:47], v[180:183]
v_cvt_pk_bf16_f32 v36, v24, v25
v_mul_f32 v116, v54, v116
v_mfma_f32_16x16x32_bf16 v[180:183], a[236:239], v[40:43], v[180:183]
v_exp_f32 v26, v26
v_mfma_f32_16x16x32_bf16 v[184:187], a[240:243], v[40:43], v[184:187]
v_mul_f32 v117, v54, v117
v_mul_f32 v118, v54, v118
v_mfma_f32_16x16x32_bf16 v[184:187], a[244:247], v[44:47], v[184:187]
v_exp_f32 v27, v27
v_mfma_f32_16x16x32_bf16 v[188:191], a[248:251], v[44:47], v[188:191]
v_cvt_pk_bf16_f32 v37, v26, v27
v_mul_f32 v119, v54, v119
v_mfma_f32_16x16x32_bf16 v[188:191], a[252:255], v[40:43], v[188:191]
v_exp_f32 v28, v28
v_mfma_f32_16x16x32_bf16 v[16:19], a[128:131], a[80:83], -4.0
buffer_load_dwordx4 a[16:19], v0, s[8:11], s41 offen offset:0 nt
v_cvt_pk_bf16_f32 v234, v116, v117
v_mfma_f32_16x16x32_bf16 v[16:19], a[132:135], a[84:87], v[16:19]
v_exp_f32 v29, v29
v_mfma_f32_16x16x32_bf16 v[16:19], a[136:139], a[88:91], v[16:19]
v_cvt_pk_bf16_f32 v235, v118, v119
v_mul_f32 v120, v54, v120
v_mfma_f32_16x16x32_bf16 v[16:19], a[140:143], a[92:95], v[16:19]
v_exp_f32 v30, v30
v_mfma_f32_16x16x32_bf16 v[20:23], a[144:147], a[92:95], -4.0
v_cvt_pk_bf16_f32 v38, v28, v29
v_mul_f32 v121, v54, v121
v_mfma_f32_16x16x32_bf16 v[20:23], a[148:151], a[88:91], v[20:23]
v_exp_f32 v31, v31
v_mfma_f32_16x16x32_bf16 v[20:23], a[152:155], a[84:87], v[20:23]
v_cvt_pk_bf16_f32 v39, v30, v31
v_mul_f32 v122, v54, v122
v_mfma_f32_16x16x32_bf16 v[20:23], a[156:159], a[80:83], v[20:23]
v_exp_f32 v16, v16
v_mfma_f32_16x16x32_bf16 v[24:27], a[160:163], a[80:83], -4.0
v_mul_f32 v123, v54, v123
v_cvt_pk_bf16_f32 v236, v120, v121
v_mfma_f32_16x16x32_bf16 v[24:27], a[164:167], a[84:87], v[24:27]
v_exp_f32 v17, v17
v_mfma_f32_16x16x32_bf16 v[24:27], a[168:171], a[88:91], v[24:27]
v_cvt_pk_bf16_f32 v40, v16, v17
v_cvt_pk_bf16_f32 v237, v122, v123
v_mfma_f32_16x16x32_bf16 v[24:27], a[172:175], a[92:95], v[24:27]
v_exp_f32 v18, v18
v_mfma_f32_16x16x32_bf16 v[28:31], a[176:179], a[92:95], -4.0
v_mul_f32 v124, v54, v124
v_mul_f32 v125, v54, v125
v_mfma_f32_16x16x32_bf16 v[28:31], a[180:183], a[88:91], v[28:31]
v_exp_f32 v19, v19
v_mfma_f32_16x16x32_bf16 v[28:31], a[184:187], a[84:87], v[28:31]
v_cvt_pk_bf16_f32 v41, v18, v19
v_mul_f32 v126, v54, v126
v_mfma_f32_16x16x32_bf16 v[28:31], a[188:191], a[80:83], v[28:31]
v_exp_f32 v20, v20
v_smfmac_f32_16x16x64_bf16 v[48:51], v[12:15], v[32:39], v1
v_mul_f32 v127, v54, v127
v_mfma_f32_16x16x32_bf16 v[64:67], a[192:195], v[32:35], 0
v_cvt_pk_bf16_f32 v238, v124, v125
v_cvt_pk_bf16_f32 v239, v126, v127
v_mfma_f32_16x16x32_bf16 v[64:67], a[196:199], v[36:39], v[64:67]
v_exp_f32 v21, v21
v_mfma_f32_16x16x32_bf16 v[68:71], a[200:203], v[36:39], 0
v_cvt_pk_bf16_f32 v42, v20, v21
v_subrev_u32 v59, 0x2f800000, v59
v_mfma_f32_16x16x32_bf16 v[68:71], a[204:207], v[32:35], v[68:71]
v_exp_f32 v22, v22
v_mfma_f32_16x16x32_bf16 v[72:75], a[208:211], v[32:35], 0
v_max_u32 v3, v3, v59
v_mov_b32 v56, 0
v_mfma_f32_16x16x32_bf16 v[72:75], a[212:215], v[36:39], v[72:75]
v_exp_f32 v23, v23
v_mfma_f32_16x16x32_bf16 v[76:79], a[216:219], v[36:39], 0
v_cvt_pk_bf16_f32 v43, v22, v23
v_mov_b32 v57, 0
v_mfma_f32_16x16x32_bf16 v[76:79], a[220:223], v[32:35], v[76:79]
v_exp_f32 v24, v24
v_mfma_f32_16x16x32_bf16 v[80:83], a[224:227], v[32:35], 0
buffer_load_dwordx4 a[20:23], v0, s[8:11], s41 offen offset:64 nt
v_mov_b32 v59, 0
v_mfma_f32_16x16x32_bf16 v[80:83], a[228:231], v[36:39], v[80:83]
v_exp_f32 v25, v25
v_mfma_f32_16x16x32_bf16 v[84:87], a[232:235], v[36:39], 0
v_cvt_pk_bf16_f32 v44, v24, v25
v_cvt_pk_bf16_f32 v240, v128, v129
v_mfma_f32_16x16x32_bf16 v[84:87], a[236:239], v[32:35], v[84:87]
v_exp_f32 v26, v26
v_mfma_f32_16x16x32_bf16 v[88:91], a[240:243], v[32:35], 0
v_cvt_pk_bf16_f32 v241, v130, v131
v_cvt_pk_bf16_f32 v242, v132, v133
v_mfma_f32_16x16x32_bf16 v[88:91], a[244:247], v[36:39], v[88:91]
v_exp_f32 v27, v27
v_mfma_f32_16x16x32_bf16 v[92:95], a[248:251], v[36:39], 0
v_cvt_pk_bf16_f32 v45, v26, v27
v_cvt_pk_bf16_f32 v243, v134, v135
v_mfma_f32_16x16x32_bf16 v[92:95], a[252:255], v[32:35], v[92:95]
v_exp_f32 v28, v28
v_mfma_f32_16x16x32_bf16 v[16:19], a[128:131], a[96:99], -4.0
v_cvt_pk_bf16_f32 v244, v136, v137
v_cvt_pk_bf16_f32 v245, v138, v139
v_mfma_f32_16x16x32_bf16 v[16:19], a[132:135], a[100:103], v[16:19]
s_waitcnt vmcnt(14)
v_exp_f32 v29, v29
v_mfma_f32_16x16x32_bf16 v[16:19], a[136:139], a[104:107], v[16:19]
v_cvt_pk_bf16_f32 v246, v140, v141
v_cvt_pk_bf16_f32 v247, v142, v143
v_mfma_f32_16x16x32_bf16 v[16:19], a[140:143], a[108:111], v[16:19]
v_exp_f32 v30, v30
v_mfma_f32_16x16x32_bf16 v[20:23], a[144:147], a[108:111], -4.0
v_cvt_pk_bf16_f32 v46, v28, v29
v_cvt_pk_bf16_f32 v248, v144, v145
v_mfma_f32_16x16x32_bf16 v[20:23], a[148:151], a[104:107], v[20:23]
v_exp_f32 v31, v31
v_mfma_f32_16x16x32_bf16 v[20:23], a[152:155], a[100:103], v[20:23]
v_cvt_pk_bf16_f32 v47, v30, v31
v_cvt_pk_bf16_f32 v249, v146, v147
v_mfma_f32_16x16x32_bf16 v[20:23], a[156:159], a[96:99], v[20:23]
v_exp_f32 v16, v16
v_mfma_f32_16x16x32_bf16 v[24:27], a[160:163], a[96:99], -4.0
v_cvt_pk_bf16_f32 v250, v148, v149
v_cvt_pk_bf16_f32 v251, v150, v151
v_mfma_f32_16x16x32_bf16 v[24:27], a[164:167], a[100:103], v[24:27]
v_exp_f32 v17, v17
v_mfma_f32_16x16x32_bf16 v[24:27], a[168:171], a[104:107], v[24:27]
v_cvt_pk_bf16_f32 v32, v16, v17
v_cvt_pk_bf16_f32 v252, v152, v153
v_mfma_f32_16x16x32_bf16 v[24:27], a[172:175], a[108:111], v[24:27]
v_exp_f32 v18, v18
v_mfma_f32_16x16x32_bf16 v[28:31], a[176:179], a[108:111], -4.0
v_cvt_pk_bf16_f32 v253, v154, v155
v_cvt_pk_bf16_f32 v254, v156, v157
v_mfma_f32_16x16x32_bf16 v[28:31], a[180:183], a[104:107], v[28:31]
v_exp_f32 v19, v19
v_mfma_f32_16x16x32_bf16 v[28:31], a[184:187], a[100:103], v[28:31]
v_cvt_pk_bf16_f32 v33, v18, v19
v_cvt_pk_bf16_f32 v255, v158, v159
v_mfma_f32_16x16x32_bf16 v[28:31], a[188:191], a[96:99], v[28:31]
v_exp_f32 v20, v20
v_smfmac_f32_16x16x64_bf16 v[52:55], v[12:15], v[40:47], v1
buffer_load_dwordx4 a[24:27], v0, s[8:11], s41 offen offset:128 nt
v_mfma_f32_16x16x32_bf16 v[96:99], a[192:195], v[40:43], 0
v_subrev_u32 v63, 0x2f800000, v63
v_max_u32 v3, v3, v63
v_mfma_f32_16x16x32_bf16 v[96:99], a[196:199], v[44:47], v[96:99]
v_exp_f32 v21, v21
v_mfma_f32_16x16x32_bf16 v[100:103], a[200:203], v[44:47], 0
v_cvt_pk_bf16_f32 v34, v20, v21
v_mov_b32 v60, 0
v_mfma_f32_16x16x32_bf16 v[100:103], a[204:207], v[40:43], v[100:103]
v_exp_f32 v22, v22
v_mfma_f32_16x16x32_bf16 v[104:107], a[208:211], v[40:43], 0
v_mov_b32 v61, 0
v_mov_b32 v63, 0
v_mfma_f32_16x16x32_bf16 v[104:107], a[212:215], v[44:47], v[104:107]
v_exp_f32 v23, v23
v_mfma_f32_16x16x32_bf16 v[108:111], a[216:219], v[44:47], 0
v_cvt_pk_bf16_f32 v35, v22, v23
v_mul_f32 v160, v62, v160
v_mfma_f32_16x16x32_bf16 v[108:111], a[220:223], v[40:43], v[108:111]
v_exp_f32 v24, v24
v_mfma_f32_16x16x32_bf16 v[112:115], a[224:227], v[40:43], 0
v_mul_f32 v161, v62, v161
v_mul_f32 v162, v62, v162
v_mfma_f32_16x16x32_bf16 v[112:115], a[228:231], v[44:47], v[112:115]
v_exp_f32 v25, v25
v_mfma_f32_16x16x32_bf16 v[116:119], a[232:235], v[44:47], 0
v_cvt_pk_bf16_f32 v36, v24, v25
v_mul_f32 v163, v62, v163
v_mfma_f32_16x16x32_bf16 v[116:119], a[236:239], v[40:43], v[116:119]
v_exp_f32 v26, v26
v_mfma_f32_16x16x32_bf16 v[120:123], a[240:243], v[40:43], 0
v_cvt_pk_bf16_f32 v192, v160, v161
v_cvt_pk_bf16_f32 v193, v162, v163
v_mfma_f32_16x16x32_bf16 v[120:123], a[244:247], v[44:47], v[120:123]
v_exp_f32 v27, v27
v_mfma_f32_16x16x32_bf16 v[124:127], a[248:251], v[44:47], 0
v_cvt_pk_bf16_f32 v37, v26, v27
v_mul_f32 v164, v62, v164
v_mfma_f32_16x16x32_bf16 v[124:127], a[252:255], v[40:43], v[124:127]
s_waitcnt vmcnt(11)
v_exp_f32 v28, v28
v_mfma_f32_16x16x32_bf16 v[16:19], a[128:131], a[112:115], -4.0
ds_read_b128 a[128:131], v4 offset:32768
v_mul_f32 v165, v62, v165
v_mfma_f32_16x16x32_bf16 v[16:19], a[132:135], a[116:119], v[16:19]
v_exp_f32 v29, v29
v_mfma_f32_16x16x32_bf16 v[16:19], a[136:139], a[120:123], v[16:19]
ds_read_b128 a[132:135], v5 offset:32768
v_mul_f32 v166, v62, v166
v_mfma_f32_16x16x32_bf16 v[16:19], a[140:143], a[124:127], v[16:19]
v_exp_f32 v30, v30
v_mfma_f32_16x16x32_bf16 v[20:23], a[144:147], a[124:127], -4.0
ds_read_b128 a[136:139], v6 offset:32768
v_cvt_pk_bf16_f32 v38, v28, v29
v_mfma_f32_16x16x32_bf16 v[20:23], a[148:151], a[120:123], v[20:23]
v_exp_f32 v31, v31
v_mfma_f32_16x16x32_bf16 v[20:23], a[152:155], a[116:119], v[20:23]
ds_read_b128 a[140:143], v7 offset:32768
v_cvt_pk_bf16_f32 v39, v30, v31
v_mfma_f32_16x16x32_bf16 v[20:23], a[156:159], a[112:115], v[20:23]
v_exp_f32 v16, v16
v_mfma_f32_16x16x32_bf16 v[24:27], a[160:163], a[112:115], -4.0
ds_read_b128 a[144:147], v7 offset:36864
buffer_load_dwordx4 a[28:31], v0, s[8:11], s41 offen offset:192 nt
v_mfma_f32_16x16x32_bf16 v[24:27], a[164:167], a[116:119], v[24:27]
v_exp_f32 v17, v17
v_mfma_f32_16x16x32_bf16 v[24:27], a[168:171], a[120:123], v[24:27]
ds_read_b128 a[148:151], v6 offset:36864
v_cvt_pk_bf16_f32 v40, v16, v17
v_mfma_f32_16x16x32_bf16 v[24:27], a[172:175], a[124:127], v[24:27]
v_exp_f32 v18, v18
v_mfma_f32_16x16x32_bf16 v[28:31], a[176:179], a[124:127], -4.0
ds_read_b128 a[152:155], v5 offset:36864
v_mul_f32 v167, v62, v167
v_mfma_f32_16x16x32_bf16 v[28:31], a[180:183], a[120:123], v[28:31]
v_exp_f32 v19, v19
v_mfma_f32_16x16x32_bf16 v[28:31], a[184:187], a[116:119], v[28:31]
ds_read_b128 a[156:159], v4 offset:36864
v_cvt_pk_bf16_f32 v41, v18, v19
v_mfma_f32_16x16x32_bf16 v[28:31], a[188:191], a[112:115], v[28:31]
v_exp_f32 v20, v20
v_smfmac_f32_16x16x64_bf16 v[56:59], v[12:15], v[32:39], v1
ds_read_b128 a[160:163], v4 offset:40960
v_mfma_f32_16x16x32_bf16 v[128:131], a[192:195], v[32:35], 0
ds_read_b128 a[164:167], v5 offset:40960
v_cvt_pk_bf16_f32 v194, v164, v165
v_mfma_f32_16x16x32_bf16 v[128:131], a[196:199], v[36:39], v[128:131]
v_exp_f32 v21, v21
v_mfma_f32_16x16x32_bf16 v[132:135], a[200:203], v[36:39], 0
ds_read_b128 a[168:171], v6 offset:40960
v_cvt_pk_bf16_f32 v42, v20, v21
v_mfma_f32_16x16x32_bf16 v[132:135], a[204:207], v[32:35], v[132:135]
v_exp_f32 v22, v22
v_mfma_f32_16x16x32_bf16 v[136:139], a[208:211], v[32:35], 0
ds_read_b128 a[172:175], v7 offset:40960
v_cvt_pk_bf16_f32 v195, v166, v167
v_mfma_f32_16x16x32_bf16 v[136:139], a[212:215], v[36:39], v[136:139]
v_exp_f32 v23, v23
v_mfma_f32_16x16x32_bf16 v[140:143], a[216:219], v[36:39], 0
ds_read_b128 a[176:179], v7 offset:45056
v_cvt_pk_bf16_f32 v43, v22, v23
v_mfma_f32_16x16x32_bf16 v[140:143], a[220:223], v[32:35], v[140:143]
v_exp_f32 v24, v24
v_mfma_f32_16x16x32_bf16 v[144:147], a[224:227], v[32:35], 0
ds_read_b128 a[180:183], v6 offset:45056
v_mul_f32 v168, v62, v168
v_mfma_f32_16x16x32_bf16 v[144:147], a[228:231], v[36:39], v[144:147]
v_exp_f32 v25, v25
v_mfma_f32_16x16x32_bf16 v[148:151], a[232:235], v[36:39], 0
ds_read_b128 a[184:187], v5 offset:45056
v_cvt_pk_bf16_f32 v44, v24, v25
v_mfma_f32_16x16x32_bf16 v[148:151], a[236:239], v[32:35], v[148:151]
v_exp_f32 v26, v26
v_mfma_f32_16x16x32_bf16 v[152:155], a[240:243], v[32:35], 0
ds_read_b128 a[188:191], v4 offset:45056
v_mul_f32 v169, v62, v169
v_mfma_f32_16x16x32_bf16 v[152:155], a[244:247], v[36:39], v[152:155]
v_exp_f32 v27, v27
v_mfma_f32_16x16x32_bf16 v[156:159], a[248:251], v[36:39], 0
v_cvt_pk_bf16_f32 v45, v26, v27
v_mul_f32 v170, v62, v170
v_mfma_f32_16x16x32_bf16 v[156:159], a[252:255], v[32:35], v[156:159]
s_waitcnt lgkmcnt(12)
v_exp_f32 v28, v28
v_mfma_f32_16x16x32_bf16 v[16:19], a[128:131], a[64:67], -4.0
buffer_load_dwordx4 a[32:35], v0, s[8:11], s42 offen offset:0 nt
v_mul_f32 v171, v62, v171
v_mfma_f32_16x16x32_bf16 v[16:19], a[132:135], a[68:71], v[16:19]
v_exp_f32 v29, v29
v_mfma_f32_16x16x32_bf16 v[16:19], a[136:139], a[72:75], v[16:19]
v_cvt_pk_bf16_f32 v196, v168, v169
v_cvt_pk_bf16_f32 v197, v170, v171
v_mfma_f32_16x16x32_bf16 v[16:19], a[140:143], a[76:79], v[16:19]
s_waitcnt lgkmcnt(8)
v_exp_f32 v30, v30
v_mfma_f32_16x16x32_bf16 v[20:23], a[144:147], a[76:79], -4.0
v_cvt_pk_bf16_f32 v46, v28, v29
v_mul_f32 v172, v62, v172
v_mfma_f32_16x16x32_bf16 v[20:23], a[148:151], a[72:75], v[20:23]
v_exp_f32 v31, v31
v_mfma_f32_16x16x32_bf16 v[20:23], a[152:155], a[68:71], v[20:23]
v_cvt_pk_bf16_f32 v47, v30, v31
v_mul_f32 v173, v62, v173
v_mfma_f32_16x16x32_bf16 v[20:23], a[156:159], a[64:67], v[20:23]
s_waitcnt lgkmcnt(4)
v_exp_f32 v16, v16
v_mfma_f32_16x16x32_bf16 v[24:27], a[160:163], a[64:67], -4.0
v_mul_f32 v174, v62, v174
v_mul_f32 v175, v62, v175
v_mfma_f32_16x16x32_bf16 v[24:27], a[164:167], a[68:71], v[24:27]
v_exp_f32 v17, v17
v_mfma_f32_16x16x32_bf16 v[24:27], a[168:171], a[72:75], v[24:27]
v_cvt_pk_bf16_f32 v32, v16, v17
v_cvt_pk_bf16_f32 v198, v172, v173
v_mfma_f32_16x16x32_bf16 v[24:27], a[172:175], a[76:79], v[24:27]
s_waitcnt lgkmcnt(0)
v_exp_f32 v18, v18
v_mfma_f32_16x16x32_bf16 v[28:31], a[176:179], a[76:79], -4.0
v_cvt_pk_bf16_f32 v199, v174, v175
v_mul_f32 v176, v62, v176
v_mfma_f32_16x16x32_bf16 v[28:31], a[180:183], a[72:75], v[28:31]
v_exp_f32 v19, v19
v_mfma_f32_16x16x32_bf16 v[28:31], a[184:187], a[68:71], v[28:31]
v_cvt_pk_bf16_f32 v33, v18, v19
v_mul_f32 v177, v62, v177
v_mfma_f32_16x16x32_bf16 v[28:31], a[188:191], a[64:67], v[28:31]
v_exp_f32 v20, v20
v_smfmac_f32_16x16x64_bf16 v[60:63], v[12:15], v[40:47], v1
s_nop 7
v_mul_f32 v178, v62, v178
v_mfma_f32_16x16x32_bf16 v[160:163], a[192:195], v[40:43], 0
ds_read_b64_tr_b16 a[192:193], v8 offset:0
ds_read_b64_tr_b16 a[194:195], v8 offset:4096
v_mfma_f32_16x16x32_bf16 v[160:163], a[196:199], v[44:47], v[160:163]
v_exp_f32 v21, v21
v_mfma_f32_16x16x32_bf16 v[164:167], a[200:203], v[44:47], 0
ds_read_b64_tr_b16 a[196:197], v8 offset:8192
v_cvt_pk_bf16_f32 v34, v20, v21
v_mfma_f32_16x16x32_bf16 v[164:167], a[204:207], v[40:43], v[164:167]
v_exp_f32 v22, v22
v_mfma_f32_16x16x32_bf16 v[168:171], a[208:211], v[40:43], 0
ds_read_b64_tr_b16 a[198:199], v8 offset:12288
ds_read_b64_tr_b16 a[200:201], v9 offset:8192
v_mfma_f32_16x16x32_bf16 v[168:171], a[212:215], v[44:47], v[168:171]
v_exp_f32 v23, v23
v_mul_f32 v179, v62, v179
v_cvt_pk_bf16_f32 v200, v176, v177
v_cvt_pk_bf16_f32 v201, v178, v179
v_mfma_f32_16x16x32_bf16 v[172:175], a[216:219], v[44:47], 0
ds_read_b64_tr_b16 a[202:203], v9 offset:12288
v_cvt_pk_bf16_f32 v35, v22, v23
v_mfma_f32_16x16x32_bf16 v[172:175], a[220:223], v[40:43], v[172:175]
v_exp_f32 v24, v24
v_mul_f32 v180, v62, v180
v_mul_f32 v181, v62, v181
v_mul_f32 v182, v62, v182
v_mul_f32 v183, v62, v183
v_cvt_pk_bf16_f32 v202, v180, v181
v_cvt_pk_bf16_f32 v203, v182, v183
v_mfma_f32_16x16x32_bf16 v[176:179], a[224:227], v[40:43], 0
ds_read_b64_tr_b16 a[204:205], v9 offset:0
ds_read_b64_tr_b16 a[206:207], v9 offset:4096
v_mfma_f32_16x16x32_bf16 v[176:179], a[228:231], v[44:47], v[176:179]
v_exp_f32 v25, v25
v_mul_f32 v184, v62, v184
v_mul_f32 v185, v62, v185
v_mul_f32 v186, v62, v186
v_mul_f32 v187, v62, v187
v_cvt_pk_bf16_f32 v204, v184, v185
v_cvt_pk_bf16_f32 v205, v186, v187
v_mfma_f32_16x16x32_bf16 v[180:183], a[232:235], v[44:47], 0
ds_read_b64_tr_b16 a[208:209], v10 offset:0
v_cvt_pk_bf16_f32 v36, v24, v25
v_mfma_f32_16x16x32_bf16 v[180:183], a[236:239], v[40:43], v[180:183]
v_exp_f32 v26, v26
v_mul_f32 v188, v62, v188
v_mul_f32 v189, v62, v189
v_mul_f32 v190, v62, v190
v_mul_f32 v191, v62, v191
v_cvt_pk_bf16_f32 v206, v188, v189
v_cvt_pk_bf16_f32 v207, v190, v191
v_mfma_f32_16x16x32_bf16 v[184:187], a[240:243], v[40:43], 0
ds_read_b64_tr_b16 a[210:211], v10 offset:4096
ds_read_b64_tr_b16 a[212:213], v10 offset:8192
v_mfma_f32_16x16x32_bf16 v[184:187], a[244:247], v[44:47], v[184:187]
v_exp_f32 v27, v27
v_mfma_f32_16x16x32_bf16 v[188:191], a[248:251], v[44:47], 0
ds_read_b64_tr_b16 a[214:215], v10 offset:12288
v_cvt_pk_bf16_f32 v37, v26, v27
v_mfma_f32_16x16x32_bf16 v[188:191], a[252:255], v[40:43], v[188:191]
v_exp_f32 v28, v28
v_mfma_f32_16x16x32_bf16 v[16:19], a[128:131], a[80:83], -4.0
ds_read_b64_tr_b16 a[216:217], v11 offset:8192
ds_read_b64_tr_b16 a[218:219], v11 offset:12288
v_mfma_f32_16x16x32_bf16 v[16:19], a[132:135], a[84:87], v[16:19]
v_exp_f32 v29, v29
v_mfma_f32_16x16x32_bf16 v[16:19], a[136:139], a[88:91], v[16:19]
ds_read_b64_tr_b16 a[220:221], v11 offset:0
ds_read_b64_tr_b16 a[222:223], v11 offset:4096
v_mfma_f32_16x16x32_bf16 v[16:19], a[140:143], a[92:95], v[16:19]
v_exp_f32 v30, v30
v_mfma_f32_16x16x32_bf16 v[20:23], a[144:147], a[92:95], -4.0
ds_read_b64_tr_b16 a[224:225], v8 offset:1024
v_cvt_pk_bf16_f32 v38, v28, v29
v_mfma_f32_16x16x32_bf16 v[20:23], a[148:151], a[88:91], v[20:23]
v_exp_f32 v31, v31
v_mfma_f32_16x16x32_bf16 v[20:23], a[152:155], a[84:87], v[20:23]
ds_read_b64_tr_b16 a[226:227], v8 offset:5120
v_cvt_pk_bf16_f32 v39, v30, v31
v_mfma_f32_16x16x32_bf16 v[20:23], a[156:159], a[80:83], v[20:23]
v_exp_f32 v16, v16
v_mfma_f32_16x16x32_bf16 v[24:27], a[160:163], a[80:83], -4.0
ds_read_b64_tr_b16 a[228:229], v8 offset:9216
ds_read_b64_tr_b16 a[230:231], v8 offset:13312
v_mfma_f32_16x16x32_bf16 v[24:27], a[164:167], a[84:87], v[24:27]
v_exp_f32 v17, v17
v_mfma_f32_16x16x32_bf16 v[24:27], a[168:171], a[88:91], v[24:27]
ds_read_b64_tr_b16 a[232:233], v9 offset:9216
v_cvt_pk_bf16_f32 v40, v16, v17
v_mfma_f32_16x16x32_bf16 v[24:27], a[172:175], a[92:95], v[24:27]
v_exp_f32 v18, v18
v_mfma_f32_16x16x32_bf16 v[28:31], a[176:179], a[92:95], -4.0
ds_read_b64_tr_b16 a[234:235], v9 offset:13312
ds_read_b64_tr_b16 a[236:237], v9 offset:1024
v_mfma_f32_16x16x32_bf16 v[28:31], a[180:183], a[88:91], v[28:31]
v_exp_f32 v19, v19
v_mfma_f32_16x16x32_bf16 v[28:31], a[184:187], a[84:87], v[28:31]
ds_read_b64_tr_b16 a[238:239], v9 offset:5120
v_cvt_pk_bf16_f32 v41, v18, v19
v_mfma_f32_16x16x32_bf16 v[28:31], a[188:191], a[80:83], v[28:31]
v_exp_f32 v20, v20
v_smfmac_f32_16x16x64_bf16 v[48:51], v[12:15], v[32:39], v1
s_waitcnt lgkmcnt(15)
ds_read_b64_tr_b16 a[240:241], v10 offset:1024
v_mfma_f32_16x16x32_bf16 v[64:67], a[192:195], v[32:35], v[64:67]
ds_read_b64_tr_b16 a[242:243], v10 offset:5120
ds_read_b64_tr_b16 a[244:245], v10 offset:9216
v_mfma_f32_16x16x32_bf16 v[64:67], a[196:199], v[36:39], v[64:67]
v_exp_f32 v21, v21
v_mfma_f32_16x16x32_bf16 v[68:71], a[200:203], v[36:39], v[68:71]
ds_read_b64_tr_b16 a[246:247], v10 offset:13312
v_cvt_pk_bf16_f32 v42, v20, v21
v_mfma_f32_16x16x32_bf16 v[68:71], a[204:207], v[32:35], v[68:71]
s_waitcnt lgkmcnt(15)
v_exp_f32 v22, v22
v_mfma_f32_16x16x32_bf16 v[72:75], a[208:211], v[32:35], v[72:75]
ds_read_b64_tr_b16 a[248:249], v11 offset:9216
ds_read_b64_tr_b16 a[250:251], v11 offset:13312
v_mfma_f32_16x16x32_bf16 v[72:75], a[212:215], v[36:39], v[72:75]
s_waitcnt lgkmcnt(14)
v_exp_f32 v23, v23
v_mfma_f32_16x16x32_bf16 v[76:79], a[216:219], v[36:39], v[76:79]
ds_read_b64_tr_b16 a[252:253], v11 offset:1024
v_cvt_pk_bf16_f32 v43, v22, v23
v_mfma_f32_16x16x32_bf16 v[76:79], a[220:223], v[32:35], v[76:79]
s_waitcnt lgkmcnt(11)
ds_read_b64_tr_b16 a[254:255], v11 offset:5120
v_exp_f32 v24, v24
v_mfma_f32_16x16x32_bf16 v[80:83], a[224:227], v[32:35], v[80:83]
buffer_load_dwordx4 a[36:39], v0, s[8:11], s42 offen offset:64 nt
v_mfma_f32_16x16x32_bf16 v[80:83], a[228:231], v[36:39], v[80:83]
s_waitcnt lgkmcnt(8)
v_exp_f32 v25, v25
v_mfma_f32_16x16x32_bf16 v[84:87], a[232:235], v[36:39], v[84:87]
v_cvt_pk_bf16_f32 v44, v24, v25
v_mfma_f32_16x16x32_bf16 v[84:87], a[236:239], v[32:35], v[84:87]
s_waitcnt lgkmcnt(4)
v_exp_f32 v26, v26
v_mfma_f32_16x16x32_bf16 v[88:91], a[240:243], v[32:35], v[88:91]
v_permlane16_swap_b32 v208, v210
v_mfma_f32_16x16x32_bf16 v[88:91], a[244:247], v[36:39], v[88:91]
s_waitcnt lgkmcnt(0)
v_exp_f32 v27, v27
v_mfma_f32_16x16x32_bf16 v[92:95], a[248:251], v[36:39], v[92:95]
v_cvt_pk_bf16_f32 v45, v26, v27
v_mfma_f32_16x16x32_bf16 v[92:95], a[252:255], v[32:35], v[92:95]
v_exp_f32 v28, v28
v_mfma_f32_16x16x32_bf16 v[16:19], a[128:131], a[96:99], -4.0
s_barrier
v_mfma_f32_16x16x32_bf16 v[16:19], a[132:135], a[100:103], v[16:19]
s_add_u32 m0, s24, 0x0
v_exp_f32 v29, v29
v_mfma_f32_16x16x32_bf16 v[16:19], a[136:139], a[104:107], v[16:19]
buffer_load_dwordx4 v2, s[16:19], s76 offen offset:0 lds
v_mfma_f32_16x16x32_bf16 v[16:19], a[140:143], a[108:111], v[16:19]
v_exp_f32 v30, v30
v_mfma_f32_16x16x32_bf16 v[20:23], a[144:147], a[108:111], -4.0
v_cvt_pk_bf16_f32 v46, v28, v29
v_mfma_f32_16x16x32_bf16 v[20:23], a[148:151], a[104:107], v[20:23]
v_exp_f32 v31, v31
v_mfma_f32_16x16x32_bf16 v[20:23], a[152:155], a[100:103], v[20:23]
v_cvt_pk_bf16_f32 v47, v30, v31
v_mfma_f32_16x16x32_bf16 v[20:23], a[156:159], a[96:99], v[20:23]
v_exp_f32 v16, v16
v_mfma_f32_16x16x32_bf16 v[24:27], a[160:163], a[96:99], -4.0
buffer_load_dwordx4 v2, s[16:19], s76 offen offset:2048 lds
v_mfma_f32_16x16x32_bf16 v[24:27], a[164:167], a[100:103], v[24:27]
s_add_u32 m0, s24, 0x2000
v_exp_f32 v17, v17
v_mfma_f32_16x16x32_bf16 v[24:27], a[168:171], a[104:107], v[24:27]
v_cvt_pk_bf16_f32 v32, v16, v17
v_mfma_f32_16x16x32_bf16 v[24:27], a[172:175], a[108:111], v[24:27]
v_exp_f32 v18, v18
v_mfma_f32_16x16x32_bf16 v[28:31], a[176:179], a[108:111], -4.0
v_permlane16_swap_b32 v209, v211
v_mfma_f32_16x16x32_bf16 v[28:31], a[180:183], a[104:107], v[28:31]
v_exp_f32 v19, v19
v_mfma_f32_16x16x32_bf16 v[28:31], a[184:187], a[100:103], v[28:31]
buffer_load_dwordx4 a[40:43], v0, s[8:11], s42 offen offset:128 nt
v_cvt_pk_bf16_f32 v33, v18, v19
v_mfma_f32_16x16x32_bf16 v[28:31], a[188:191], a[96:99], v[28:31]
v_exp_f32 v20, v20
v_smfmac_f32_16x16x64_bf16 v[52:55], v[12:15], v[40:47], v1
v_mfma_f32_16x16x32_bf16 v[96:99], a[192:195], v[40:43], v[96:99]
v_permlane16_swap_b32 v212, v214
v_mfma_f32_16x16x32_bf16 v[96:99], a[196:199], v[44:47], v[96:99]
v_exp_f32 v21, v21
v_mfma_f32_16x16x32_bf16 v[100:103], a[200:203], v[44:47], v[100:103]
v_cvt_pk_bf16_f32 v34, v20, v21
v_mfma_f32_16x16x32_bf16 v[100:103], a[204:207], v[40:43], v[100:103]
v_exp_f32 v22, v22
v_mfma_f32_16x16x32_bf16 v[104:107], a[208:211], v[40:43], v[104:107]
buffer_load_dwordx4 v2, s[16:19], s77 offen offset:0 lds
v_mfma_f32_16x16x32_bf16 v[104:107], a[212:215], v[44:47], v[104:107]
v_exp_f32 v23, v23
v_mfma_f32_16x16x32_bf16 v[108:111], a[216:219], v[44:47], v[108:111]
v_cvt_pk_bf16_f32 v35, v22, v23
v_mfma_f32_16x16x32_bf16 v[108:111], a[220:223], v[40:43], v[108:111]
v_exp_f32 v24, v24
v_mfma_f32_16x16x32_bf16 v[112:115], a[224:227], v[40:43], v[112:115]
v_permlane16_swap_b32 v213, v215
v_mfma_f32_16x16x32_bf16 v[112:115], a[228:231], v[44:47], v[112:115]
v_exp_f32 v25, v25
v_mfma_f32_16x16x32_bf16 v[116:119], a[232:235], v[44:47], v[116:119]
v_cvt_pk_bf16_f32 v36, v24, v25
v_mfma_f32_16x16x32_bf16 v[116:119], a[236:239], v[40:43], v[116:119]
v_exp_f32 v26, v26
v_mfma_f32_16x16x32_bf16 v[120:123], a[240:243], v[40:43], v[120:123]
buffer_load_dwordx4 v2, s[16:19], s77 offen offset:2048 lds
v_mfma_f32_16x16x32_bf16 v[120:123], a[244:247], v[44:47], v[120:123]
v_exp_f32 v27, v27
v_mfma_f32_16x16x32_bf16 v[124:127], a[248:251], v[44:47], v[124:127]
v_cvt_pk_bf16_f32 v37, v26, v27
v_mfma_f32_16x16x32_bf16 v[124:127], a[252:255], v[40:43], v[124:127]
v_exp_f32 v28, v28
v_mfma_f32_16x16x32_bf16 v[16:19], a[128:131], a[112:115], -4.0
ds_read_b128 a[128:131], v4 offset:16384
v_mfma_f32_16x16x32_bf16 v[16:19], a[132:135], a[116:119], v[16:19]
v_exp_f32 v29, v29
v_mfma_f32_16x16x32_bf16 v[16:19], a[136:139], a[120:123], v[16:19]
ds_read_b128 a[132:135], v5 offset:16384
buffer_load_dwordx4 a[44:47], v0, s[8:11], s42 offen offset:192 nt
v_mfma_f32_16x16x32_bf16 v[16:19], a[140:143], a[124:127], v[16:19]
v_exp_f32 v30, v30
v_mfma_f32_16x16x32_bf16 v[20:23], a[144:147], a[124:127], -4.0
ds_read_b128 a[136:139], v6 offset:16384
v_cvt_pk_bf16_f32 v38, v28, v29
v_mfma_f32_16x16x32_bf16 v[20:23], a[148:151], a[120:123], v[20:23]
v_exp_f32 v31, v31
v_mfma_f32_16x16x32_bf16 v[20:23], a[152:155], a[116:119], v[20:23]
ds_read_b128 a[140:143], v7 offset:16384
v_cvt_pk_bf16_f32 v39, v30, v31
v_mfma_f32_16x16x32_bf16 v[20:23], a[156:159], a[112:115], v[20:23]
v_exp_f32 v16, v16
v_mfma_f32_16x16x32_bf16 v[24:27], a[160:163], a[112:115], -4.0
ds_read_b128 a[144:147], v7 offset:20480
v_mfma_f32_16x16x32_bf16 v[24:27], a[164:167], a[116:119], v[24:27]
v_exp_f32 v17, v17
v_mfma_f32_16x16x32_bf16 v[24:27], a[168:171], a[120:123], v[24:27]
ds_read_b128 a[148:151], v6 offset:20480
v_cvt_pk_bf16_f32 v40, v16, v17
v_mfma_f32_16x16x32_bf16 v[24:27], a[172:175], a[124:127], v[24:27]
v_exp_f32 v18, v18
v_mfma_f32_16x16x32_bf16 v[28:31], a[176:179], a[124:127], -4.0
ds_read_b128 a[152:155], v5 offset:20480
v_mfma_f32_16x16x32_bf16 v[28:31], a[180:183], a[120:123], v[28:31]
v_exp_f32 v19, v19
v_mfma_f32_16x16x32_bf16 v[28:31], a[184:187], a[116:119], v[28:31]
ds_read_b128 a[156:159], v4 offset:20480
v_cvt_pk_bf16_f32 v41, v18, v19
v_mfma_f32_16x16x32_bf16 v[28:31], a[188:191], a[112:115], v[28:31]
v_exp_f32 v20, v20
v_smfmac_f32_16x16x64_bf16 v[56:59], v[12:15], v[32:39], v1
ds_read_b128 a[160:163], v4 offset:24576
v_mfma_f32_16x16x32_bf16 v[128:131], a[192:195], v[32:35], v[128:131]
L_pg6:
s_cbranch_vccnz L_pg10
ds_read_b128 a[164:167], v5 offset:24576
v_mfma_f32_16x16x32_bf16 v[128:131], a[196:199], v[36:39], v[128:131]
v_exp_f32 v21, v21
v_mfma_f32_16x16x32_bf16 v[132:135], a[200:203], v[36:39], v[132:135]
ds_read_b128 a[168:171], v6 offset:24576
v_cvt_pk_bf16_f32 v42, v20, v21
v_mfma_f32_16x16x32_bf16 v[132:135], a[204:207], v[32:35], v[132:135]
v_exp_f32 v22, v22
v_mfma_f32_16x16x32_bf16 v[136:139], a[208:211], v[32:35], v[136:139]
ds_read_b128 a[172:175], v7 offset:24576
buffer_load_dwordx4 a[48:51], v0, s[8:11], s43 offen offset:0 nt
v_mfma_f32_16x16x32_bf16 v[136:139], a[212:215], v[36:39], v[136:139]
v_exp_f32 v23, v23
v_mfma_f32_16x16x32_bf16 v[140:143], a[216:219], v[36:39], v[140:143]
ds_read_b128 a[176:179], v7 offset:28672
v_cvt_pk_bf16_f32 v43, v22, v23
v_mfma_f32_16x16x32_bf16 v[140:143], a[220:223], v[32:35], v[140:143]
v_exp_f32 v24, v24
v_mfma_f32_16x16x32_bf16 v[144:147], a[224:227], v[32:35], v[144:147]
ds_read_b128 a[180:183], v6 offset:28672
v_mfma_f32_16x16x32_bf16 v[144:147], a[228:231], v[36:39], v[144:147]
v_exp_f32 v25, v25
v_mfma_f32_16x16x32_bf16 v[148:151], a[232:235], v[36:39], v[148:151]
ds_read_b128 a[184:187], v5 offset:28672
v_cvt_pk_bf16_f32 v44, v24, v25
v_mfma_f32_16x16x32_bf16 v[148:151], a[236:239], v[32:35], v[148:151]
v_exp_f32 v26, v26
v_mfma_f32_16x16x32_bf16 v[152:155], a[240:243], v[32:35], v[152:155]
ds_read_b128 a[188:191], v4 offset:28672
v_mfma_f32_16x16x32_bf16 v[152:155], a[244:247], v[36:39], v[152:155]
v_exp_f32 v27, v27
v_mfma_f32_16x16x32_bf16 v[156:159], a[248:251], v[36:39], v[156:159]
v_cvt_pk_bf16_f32 v45, v26, v27
v_mfma_f32_16x16x32_bf16 v[156:159], a[252:255], v[32:35], v[156:159]
s_waitcnt lgkmcnt(12)
v_exp_f32 v28, v28
v_mfma_f32_16x16x32_bf16 v[16:19], a[128:131], a[64:67], -4.0
v_permlane16_swap_b32 v216, v218
v_mfma_f32_16x16x32_bf16 v[16:19], a[132:135], a[68:71], v[16:19]
v_exp_f32 v29, v29
v_mfma_f32_16x16x32_bf16 v[16:19], a[136:139], a[72:75], v[16:19]
v_permlane16_swap_b32 v217, v219
v_mfma_f32_16x16x32_bf16 v[16:19], a[140:143], a[76:79], v[16:19]
s_waitcnt lgkmcnt(8)
v_exp_f32 v30, v30
v_mfma_f32_16x16x32_bf16 v[20:23], a[144:147], a[76:79], -4.0
v_cvt_pk_bf16_f32 v46, v28, v29
v_mfma_f32_16x16x32_bf16 v[20:23], a[148:151], a[72:75], v[20:23]
v_exp_f32 v31, v31
v_mfma_f32_16x16x32_bf16 v[20:23], a[152:155], a[68:71], v[20:23]
buffer_load_dwordx4 a[52:55], v0, s[8:11], s43 offen offset:64 nt
v_cvt_pk_bf16_f32 v47, v30, v31
v_mfma_f32_16x16x32_bf16 v[20:23], a[156:159], a[64:67], v[20:23]
s_waitcnt lgkmcnt(4)
v_exp_f32 v16, v16
v_mfma_f32_16x16x32_bf16 v[24:27], a[160:163], a[64:67], -4.0
v_permlane16_swap_b32 v220, v222
v_mfma_f32_16x16x32_bf16 v[24:27], a[164:167], a[68:71], v[24:27]
v_exp_f32 v17, v17
v_mfma_f32_16x16x32_bf16 v[24:27], a[168:171], a[72:75], v[24:27]
v_cvt_pk_bf16_f32 v32, v16, v17
v_mfma_f32_16x16x32_bf16 v[24:27], a[172:175], a[76:79], v[24:27]
s_waitcnt lgkmcnt(0)
v_exp_f32 v18, v18
v_mfma_f32_16x16x32_bf16 v[28:31], a[176:179], a[76:79], -4.0
v_permlane16_swap_b32 v221, v223
v_mfma_f32_16x16x32_bf16 v[28:31], a[180:183], a[72:75], v[28:31]
v_exp_f32 v19, v19
v_mfma_f32_16x16x32_bf16 v[28:31], a[184:187], a[68:71], v[28:31]
v_cvt_pk_bf16_f32 v33, v18, v19
v_mfma_f32_16x16x32_bf16 v[28:31], a[188:191], a[64:67], v[28:31]
s_waitcnt vmcnt(17)
v_exp_f32 v20, v20
v_smfmac_f32_16x16x64_bf16 v[60:63], v[12:15], v[40:47], v1
s_barrier
v_mfma_f32_16x16x32_bf16 v[160:163], a[192:195], v[40:43], v[160:163]
ds_read_b64_tr_b16 a[192:193], v8 offset:16384
ds_read_b64_tr_b16 a[194:195], v8 offset:20480
v_mfma_f32_16x16x32_bf16 v[160:163], a[196:199], v[44:47], v[160:163]
v_exp_f32 v21, v21
v_mfma_f32_16x16x32_bf16 v[164:167], a[200:203], v[44:47], v[164:167]
ds_read_b64_tr_b16 a[196:197], v8 offset:24576
v_cvt_pk_bf16_f32 v34, v20, v21
v_mfma_f32_16x16x32_bf16 v[164:167], a[204:207], v[40:43], v[164:167]
v_exp_f32 v22, v22
v_mfma_f32_16x16x32_bf16 v[168:171], a[208:211], v[40:43], v[168:171]
ds_read_b64_tr_b16 a[198:199], v8 offset:28672
ds_read_b64_tr_b16 a[200:201], v9 offset:24576
v_mfma_f32_16x16x32_bf16 v[168:171], a[212:215], v[44:47], v[168:171]
v_exp_f32 v23, v23
v_mfma_f32_16x16x32_bf16 v[172:175], a[216:219], v[44:47], v[172:175]
ds_read_b64_tr_b16 a[202:203], v9 offset:28672
v_cvt_pk_bf16_f32 v35, v22, v23
v_mfma_f32_16x16x32_bf16 v[172:175], a[220:223], v[40:43], v[172:175]
v_exp_f32 v24, v24
v_mfma_f32_16x16x32_bf16 v[176:179], a[224:227], v[40:43], v[176:179]
ds_read_b64_tr_b16 a[204:205], v9 offset:16384
ds_read_b64_tr_b16 a[206:207], v9 offset:20480
v_mfma_f32_16x16x32_bf16 v[176:179], a[228:231], v[44:47], v[176:179]
v_exp_f32 v25, v25
v_mfma_f32_16x16x32_bf16 v[180:183], a[232:235], v[44:47], v[180:183]
ds_read_b64_tr_b16 a[208:209], v10 offset:16384
v_cvt_pk_bf16_f32 v36, v24, v25
v_mfma_f32_16x16x32_bf16 v[180:183], a[236:239], v[40:43], v[180:183]
v_exp_f32 v26, v26
v_mfma_f32_16x16x32_bf16 v[184:187], a[240:243], v[40:43], v[184:187]
ds_read_b64_tr_b16 a[210:211], v10 offset:20480
ds_read_b64_tr_b16 a[212:213], v10 offset:24576
v_mfma_f32_16x16x32_bf16 v[184:187], a[244:247], v[44:47], v[184:187]
v_exp_f32 v27, v27
v_mfma_f32_16x16x32_bf16 v[188:191], a[248:251], v[44:47], v[188:191]
ds_read_b64_tr_b16 a[214:215], v10 offset:28672
v_cvt_pk_bf16_f32 v37, v26, v27
v_mfma_f32_16x16x32_bf16 v[188:191], a[252:255], v[40:43], v[188:191]
v_exp_f32 v28, v28
v_mfma_f32_16x16x32_bf16 v[16:19], a[128:131], a[80:83], -4.0
ds_read_b64_tr_b16 a[216:217], v11 offset:24576
ds_read_b64_tr_b16 a[218:219], v11 offset:28672
v_mfma_f32_16x16x32_bf16 v[16:19], a[132:135], a[84:87], v[16:19]
v_exp_f32 v29, v29
v_mfma_f32_16x16x32_bf16 v[16:19], a[136:139], a[88:91], v[16:19]
ds_read_b64_tr_b16 a[220:221], v11 offset:16384
ds_read_b64_tr_b16 a[222:223], v11 offset:20480
v_mfma_f32_16x16x32_bf16 v[16:19], a[140:143], a[92:95], v[16:19]
v_exp_f32 v30, v30
v_mfma_f32_16x16x32_bf16 v[20:23], a[144:147], a[92:95], -4.0
ds_read_b64_tr_b16 a[224:225], v8 offset:17408
v_cvt_pk_bf16_f32 v38, v28, v29
v_mfma_f32_16x16x32_bf16 v[20:23], a[148:151], a[88:91], v[20:23]
v_exp_f32 v31, v31
v_mfma_f32_16x16x32_bf16 v[20:23], a[152:155], a[84:87], v[20:23]
ds_read_b64_tr_b16 a[226:227], v8 offset:21504
v_cvt_pk_bf16_f32 v39, v30, v31
v_mfma_f32_16x16x32_bf16 v[20:23], a[156:159], a[80:83], v[20:23]
v_exp_f32 v16, v16
v_mfma_f32_16x16x32_bf16 v[24:27], a[160:163], a[80:83], -4.0
ds_read_b64_tr_b16 a[228:229], v8 offset:25600
ds_read_b64_tr_b16 a[230:231], v8 offset:29696
v_mfma_f32_16x16x32_bf16 v[24:27], a[164:167], a[84:87], v[24:27]
v_exp_f32 v17, v17
v_mfma_f32_16x16x32_bf16 v[24:27], a[168:171], a[88:91], v[24:27]
ds_read_b64_tr_b16 a[232:233], v9 offset:25600
v_cvt_pk_bf16_f32 v40, v16, v17
v_mfma_f32_16x16x32_bf16 v[24:27], a[172:175], a[92:95], v[24:27]
v_exp_f32 v18, v18
v_mfma_f32_16x16x32_bf16 v[28:31], a[176:179], a[92:95], -4.0
ds_read_b64_tr_b16 a[234:235], v9 offset:29696
ds_read_b64_tr_b16 a[236:237], v9 offset:17408
v_mfma_f32_16x16x32_bf16 v[28:31], a[180:183], a[88:91], v[28:31]
v_exp_f32 v19, v19
v_mfma_f32_16x16x32_bf16 v[28:31], a[184:187], a[84:87], v[28:31]
ds_read_b64_tr_b16 a[238:239], v9 offset:21504
v_cvt_pk_bf16_f32 v41, v18, v19
v_mfma_f32_16x16x32_bf16 v[28:31], a[188:191], a[80:83], v[28:31]
v_exp_f32 v20, v20
v_smfmac_f32_16x16x64_bf16 v[48:51], v[12:15], v[32:39], v1
s_waitcnt lgkmcnt(15)
ds_read_b64_tr_b16 a[240:241], v10 offset:17408
v_mfma_f32_16x16x32_bf16 v[64:67], a[192:195], v[32:35], v[64:67]
ds_read_b64_tr_b16 a[242:243], v10 offset:21504
ds_read_b64_tr_b16 a[244:245], v10 offset:25600
v_mfma_f32_16x16x32_bf16 v[64:67], a[196:199], v[36:39], v[64:67]
v_exp_f32 v21, v21
v_mfma_f32_16x16x32_bf16 v[68:71], a[200:203], v[36:39], v[68:71]
ds_read_b64_tr_b16 a[246:247], v10 offset:29696
v_cvt_pk_bf16_f32 v42, v20, v21
v_mfma_f32_16x16x32_bf16 v[68:71], a[204:207], v[32:35], v[68:71]
s_waitcnt lgkmcnt(15)
v_exp_f32 v22, v22
v_mfma_f32_16x16x32_bf16 v[72:75], a[208:211], v[32:35], v[72:75]
ds_read_b64_tr_b16 a[248:249], v11 offset:25600
ds_read_b64_tr_b16 a[250:251], v11 offset:29696
v_mfma_f32_16x16x32_bf16 v[72:75], a[212:215], v[36:39], v[72:75]
s_waitcnt lgkmcnt(14)
v_exp_f32 v23, v23
v_mfma_f32_16x16x32_bf16 v[76:79], a[216:219], v[36:39], v[76:79]
ds_read_b64_tr_b16 a[252:253], v11 offset:17408
v_cvt_pk_bf16_f32 v43, v22, v23
v_mfma_f32_16x16x32_bf16 v[76:79], a[220:223], v[32:35], v[76:79]
s_waitcnt lgkmcnt(11)
ds_read_b64_tr_b16 a[254:255], v11 offset:21504
v_exp_f32 v24, v24
v_mfma_f32_16x16x32_bf16 v[80:83], a[224:227], v[32:35], v[80:83]
buffer_load_dwordx4 a[56:59], v0, s[8:11], s43 offen offset:128 nt
v_mfma_f32_16x16x32_bf16 v[80:83], a[228:231], v[36:39], v[80:83]
s_waitcnt lgkmcnt(8)
v_exp_f32 v25, v25
v_mfma_f32_16x16x32_bf16 v[84:87], a[232:235], v[36:39], v[84:87]
v_cvt_pk_bf16_f32 v44, v24, v25
v_mfma_f32_16x16x32_bf16 v[84:87], a[236:239], v[32:35], v[84:87]
s_waitcnt lgkmcnt(4)
v_exp_f32 v26, v26
v_mfma_f32_16x16x32_bf16 v[88:91], a[240:243], v[32:35], v[88:91]
v_permlane16_swap_b32 v224, v226
v_mfma_f32_16x16x32_bf16 v[88:91], a[244:247], v[36:39], v[88:91]
s_waitcnt lgkmcnt(0)
v_exp_f32 v27, v27
v_mfma_f32_16x16x32_bf16 v[92:95], a[248:251], v[36:39], v[92:95]
v_cvt_pk_bf16_f32 v45, v26, v27
v_mfma_f32_16x16x32_bf16 v[92:95], a[252:255], v[32:35], v[92:95]
v_exp_f32 v28, v28
v_mfma_f32_16x16x32_bf16 v[16:19], a[128:131], a[96:99], -4.0
s_barrier
v_mfma_f32_16x16x32_bf16 v[16:19], a[132:135], a[100:103], v[16:19]
s_add_u32 m0, s24, 0x4000
v_exp_f32 v29, v29
v_mfma_f32_16x16x32_bf16 v[16:19], a[136:139], a[104:107], v[16:19]
buffer_load_dwordx4 v2, s[16:19], s74 offen offset:0 lds
v_mfma_f32_16x16x32_bf16 v[16:19], a[140:143], a[108:111], v[16:19]
v_exp_f32 v30, v30
v_mfma_f32_16x16x32_bf16 v[20:23], a[144:147], a[108:111], -4.0
v_cvt_pk_bf16_f32 v46, v28, v29
v_mfma_f32_16x16x32_bf16 v[20:23], a[148:151], a[104:107], v[20:23]
v_exp_f32 v31, v31
v_mfma_f32_16x16x32_bf16 v[20:23], a[152:155], a[100:103], v[20:23]
v_cvt_pk_bf16_f32 v47, v30, v31
v_mfma_f32_16x16x32_bf16 v[20:23], a[156:159], a[96:99], v[20:23]
v_exp_f32 v16, v16
v_mfma_f32_16x16x32_bf16 v[24:27], a[160:163], a[96:99], -4.0
buffer_load_dwordx4 v2, s[16:19], s74 offen offset:2048 lds
v_mfma_f32_16x16x32_bf16 v[24:27], a[164:167], a[100:103], v[24:27]
s_add_u32 m0, s24, 0x6000
v_exp_f32 v17, v17
v_mfma_f32_16x16x32_bf16 v[24:27], a[168:171], a[104:107], v[24:27]
v_cvt_pk_bf16_f32 v32, v16, v17
v_mfma_f32_16x16x32_bf16 v[24:27], a[172:175], a[108:111], v[24:27]
v_exp_f32 v18, v18
v_mfma_f32_16x16x32_bf16 v[28:31], a[176:179], a[108:111], -4.0
v_permlane16_swap_b32 v225, v227
v_mfma_f32_16x16x32_bf16 v[28:31], a[180:183], a[104:107], v[28:31]
v_exp_f32 v19, v19
v_mfma_f32_16x16x32_bf16 v[28:31], a[184:187], a[100:103], v[28:31]
buffer_load_dwordx4 a[60:63], v0, s[8:11], s43 offen offset:192 nt
v_cvt_pk_bf16_f32 v33, v18, v19
v_mfma_f32_16x16x32_bf16 v[28:31], a[188:191], a[96:99], v[28:31]
v_exp_f32 v20, v20
v_smfmac_f32_16x16x64_bf16 v[52:55], v[12:15], v[40:47], v1
v_mfma_f32_16x16x32_bf16 v[96:99], a[192:195], v[40:43], v[96:99]
v_permlane16_swap_b32 v228, v230
v_mfma_f32_16x16x32_bf16 v[96:99], a[196:199], v[44:47], v[96:99]
v_exp_f32 v21, v21
v_mfma_f32_16x16x32_bf16 v[100:103], a[200:203], v[44:47], v[100:103]
v_cvt_pk_bf16_f32 v34, v20, v21
v_mfma_f32_16x16x32_bf16 v[100:103], a[204:207], v[40:43], v[100:103]
v_exp_f32 v22, v22
v_mfma_f32_16x16x32_bf16 v[104:107], a[208:211], v[40:43], v[104:107]
buffer_load_dwordx4 v2, s[16:19], s75 offen offset:0 lds
v_mfma_f32_16x16x32_bf16 v[104:107], a[212:215], v[44:47], v[104:107]
v_exp_f32 v23, v23
v_mfma_f32_16x16x32_bf16 v[108:111], a[216:219], v[44:47], v[108:111]
v_cvt_pk_bf16_f32 v35, v22, v23
v_mfma_f32_16x16x32_bf16 v[108:111], a[220:223], v[40:43], v[108:111]
v_exp_f32 v24, v24
v_mfma_f32_16x16x32_bf16 v[112:115], a[224:227], v[40:43], v[112:115]
v_permlane16_swap_b32 v229, v231
v_mfma_f32_16x16x32_bf16 v[112:115], a[228:231], v[44:47], v[112:115]
v_exp_f32 v25, v25
v_mfma_f32_16x16x32_bf16 v[116:119], a[232:235], v[44:47], v[116:119]
v_cvt_pk_bf16_f32 v36, v24, v25
v_mfma_f32_16x16x32_bf16 v[116:119], a[236:239], v[40:43], v[116:119]
v_exp_f32 v26, v26
v_mfma_f32_16x16x32_bf16 v[120:123], a[240:243], v[40:43], v[120:123]
buffer_load_dwordx4 v2, s[16:19], s75 offen offset:2048 lds
v_mfma_f32_16x16x32_bf16 v[120:123], a[244:247], v[44:47], v[120:123]
v_exp_f32 v27, v27
v_mfma_f32_16x16x32_bf16 v[124:127], a[248:251], v[44:47], v[124:127]
v_cvt_pk_bf16_f32 v37, v26, v27
v_mfma_f32_16x16x32_bf16 v[124:127], a[252:255], v[40:43], v[124:127]
v_exp_f32 v28, v28
v_mfma_f32_16x16x32_bf16 v[16:19], a[128:131], a[112:115], -4.0
ds_read_b128 a[128:131], v4 offset:0
v_mfma_f32_16x16x32_bf16 v[16:19], a[132:135], a[116:119], v[16:19]
v_exp_f32 v29, v29
v_mfma_f32_16x16x32_bf16 v[16:19], a[136:139], a[120:123], v[16:19]
ds_read_b128 a[132:135], v5 offset:0
v_mfma_f32_16x16x32_bf16 v[16:19], a[140:143], a[124:127], v[16:19]
v_exp_f32 v30, v30
v_mfma_f32_16x16x32_bf16 v[20:23], a[144:147], a[124:127], -4.0
ds_read_b128 a[136:139], v6 offset:0
v_cvt_pk_bf16_f32 v38, v28, v29
v_mfma_f32_16x16x32_bf16 v[20:23], a[148:151], a[120:123], v[20:23]
v_exp_f32 v31, v31
v_mfma_f32_16x16x32_bf16 v[20:23], a[152:155], a[116:119], v[20:23]
ds_read_b128 a[140:143], v7 offset:0
v_cvt_pk_bf16_f32 v39, v30, v31
v_mfma_f32_16x16x32_bf16 v[20:23], a[156:159], a[112:115], v[20:23]
v_exp_f32 v16, v16
v_mfma_f32_16x16x32_bf16 v[24:27], a[160:163], a[112:115], -4.0
ds_read_b128 a[144:147], v7 offset:4096
v_mfma_f32_16x16x32_bf16 v[24:27], a[164:167], a[116:119], v[24:27]
v_exp_f32 v17, v17
v_mfma_f32_16x16x32_bf16 v[24:27], a[168:171], a[120:123], v[24:27]
ds_read_b128 a[148:151], v6 offset:4096
v_cvt_pk_bf16_f32 v40, v16, v17
v_mfma_f32_16x16x32_bf16 v[24:27], a[172:175], a[124:127], v[24:27]
v_exp_f32 v18, v18
v_mfma_f32_16x16x32_bf16 v[28:31], a[176:179], a[124:127], -4.0
ds_read_b128 a[152:155], v5 offset:4096
v_mfma_f32_16x16x32_bf16 v[28:31], a[180:183], a[120:123], v[28:31]
v_exp_f32 v19, v19
v_mfma_f32_16x16x32_bf16 v[28:31], a[184:187], a[116:119], v[28:31]
ds_read_b128 a[156:159], v4 offset:4096
v_cvt_pk_bf16_f32 v41, v18, v19
v_mfma_f32_16x16x32_bf16 v[28:31], a[188:191], a[112:115], v[28:31]
v_exp_f32 v20, v20
v_smfmac_f32_16x16x64_bf16 v[56:59], v[12:15], v[32:39], v1
ds_read_b128 a[160:163], v4 offset:8192
v_mfma_f32_16x16x32_bf16 v[128:131], a[192:195], v[32:35], v[128:131]
ds_read_b128 a[164:167], v5 offset:8192
v_mfma_f32_16x16x32_bf16 v[128:131], a[196:199], v[36:39], v[128:131]
v_exp_f32 v21, v21
v_mfma_f32_16x16x32_bf16 v[132:135], a[200:203], v[36:39], v[132:135]
ds_read_b128 a[168:171], v6 offset:8192
v_cvt_pk_bf16_f32 v42, v20, v21
v_mfma_f32_16x16x32_bf16 v[132:135], a[204:207], v[32:35], v[132:135]
v_exp_f32 v22, v22
v_mfma_f32_16x16x32_bf16 v[136:139], a[208:211], v[32:35], v[136:139]
ds_read_b128 a[172:175], v7 offset:8192
v_mfma_f32_16x16x32_bf16 v[136:139], a[212:215], v[36:39], v[136:139]
v_exp_f32 v23, v23
v_mfma_f32_16x16x32_bf16 v[140:143], a[216:219], v[36:39], v[140:143]
ds_read_b128 a[176:179], v7 offset:12288
v_cvt_pk_bf16_f32 v43, v22, v23
v_mfma_f32_16x16x32_bf16 v[140:143], a[220:223], v[32:35], v[140:143]
v_exp_f32 v24, v24
v_mfma_f32_16x16x32_bf16 v[144:147], a[224:227], v[32:35], v[144:147]
ds_read_b128 a[180:183], v6 offset:12288
v_mfma_f32_16x16x32_bf16 v[144:147], a[228:231], v[36:39], v[144:147]
v_exp_f32 v25, v25
v_mfma_f32_16x16x32_bf16 v[148:151], a[232:235], v[36:39], v[148:151]
ds_read_b128 a[184:187], v5 offset:12288
v_cvt_pk_bf16_f32 v44, v24, v25
v_mfma_f32_16x16x32_bf16 v[148:151], a[236:239], v[32:35], v[148:151]
v_exp_f32 v26, v26
v_mfma_f32_16x16x32_bf16 v[152:155], a[240:243], v[32:35], v[152:155]
ds_read_b128 a[188:191], v4 offset:12288
v_mfma_f32_16x16x32_bf16 v[152:155], a[244:247], v[36:39], v[152:155]
v_exp_f32 v27, v27
v_mfma_f32_16x16x32_bf16 v[156:159], a[248:251], v[36:39], v[156:159]
v_cvt_pk_bf16_f32 v45, v26, v27
v_mfma_f32_16x16x32_bf16 v[156:159], a[252:255], v[32:35], v[156:159]
s_waitcnt lgkmcnt(12)
v_exp_f32 v28, v28
v_mfma_f32_16x16x32_bf16 v[16:19], a[128:131], a[64:67], -4.0
v_permlane16_swap_b32 v232, v234
v_mfma_f32_16x16x32_bf16 v[16:19], a[132:135], a[68:71], v[16:19]
v_exp_f32 v29, v29
v_mfma_f32_16x16x32_bf16 v[16:19], a[136:139], a[72:75], v[16:19]
v_permlane16_swap_b32 v233, v235
v_mfma_f32_16x16x32_bf16 v[16:19], a[140:143], a[76:79], v[16:19]
s_waitcnt lgkmcnt(8)
v_exp_f32 v30, v30
v_mfma_f32_16x16x32_bf16 v[20:23], a[144:147], a[76:79], -4.0
v_cvt_pk_bf16_f32 v46, v28, v29
v_mfma_f32_16x16x32_bf16 v[20:23], a[148:151], a[72:75], v[20:23]
v_exp_f32 v31, v31
v_mfma_f32_16x16x32_bf16 v[20:23], a[152:155], a[68:71], v[20:23]
v_cvt_pk_bf16_f32 v47, v30, v31
v_mfma_f32_16x16x32_bf16 v[20:23], a[156:159], a[64:67], v[20:23]
s_waitcnt lgkmcnt(4)
v_exp_f32 v16, v16
v_mfma_f32_16x16x32_bf16 v[24:27], a[160:163], a[64:67], -4.0
v_permlane16_swap_b32 v236, v238
v_mfma_f32_16x16x32_bf16 v[24:27], a[164:167], a[68:71], v[24:27]
v_exp_f32 v17, v17
v_mfma_f32_16x16x32_bf16 v[24:27], a[168:171], a[72:75], v[24:27]
v_cvt_pk_bf16_f32 v32, v16, v17
v_mfma_f32_16x16x32_bf16 v[24:27], a[172:175], a[76:79], v[24:27]
s_waitcnt lgkmcnt(0)
v_exp_f32 v18, v18
v_mfma_f32_16x16x32_bf16 v[28:31], a[176:179], a[76:79], -4.0
v_permlane16_swap_b32 v237, v239
v_mfma_f32_16x16x32_bf16 v[28:31], a[180:183], a[72:75], v[28:31]
v_exp_f32 v19, v19
v_mfma_f32_16x16x32_bf16 v[28:31], a[184:187], a[68:71], v[28:31]
v_cvt_pk_bf16_f32 v33, v18, v19
v_mfma_f32_16x16x32_bf16 v[28:31], a[188:191], a[64:67], v[28:31]
s_waitcnt vmcnt(9)
v_exp_f32 v20, v20
v_smfmac_f32_16x16x64_bf16 v[60:63], v[12:15], v[40:47], v1
s_barrier
v_mfma_f32_16x16x32_bf16 v[160:163], a[192:195], v[40:43], v[160:163]
ds_read_b64_tr_b16 a[192:193], v8 offset:0
ds_read_b64_tr_b16 a[194:195], v8 offset:4096
v_mfma_f32_16x16x32_bf16 v[160:163], a[196:199], v[44:47], v[160:163]
v_exp_f32 v21, v21
v_mfma_f32_16x16x32_bf16 v[164:167], a[200:203], v[44:47], v[164:167]
ds_read_b64_tr_b16 a[196:197], v8 offset:8192
v_cvt_pk_bf16_f32 v34, v20, v21
v_mfma_f32_16x16x32_bf16 v[164:167], a[204:207], v[40:43], v[164:167]
v_exp_f32 v22, v22
v_mfma_f32_16x16x32_bf16 v[168:171], a[208:211], v[40:43], v[168:171]
ds_read_b64_tr_b16 a[198:199], v8 offset:12288
ds_read_b64_tr_b16 a[200:201], v9 offset:8192
v_mfma_f32_16x16x32_bf16 v[168:171], a[212:215], v[44:47], v[168:171]
v_exp_f32 v23, v23
v_mfma_f32_16x16x32_bf16 v[172:175], a[216:219], v[44:47], v[172:175]
ds_read_b64_tr_b16 a[202:203], v9 offset:12288
v_cvt_pk_bf16_f32 v35, v22, v23
v_mfma_f32_16x16x32_bf16 v[172:175], a[220:223], v[40:43], v[172:175]
v_exp_f32 v24, v24
v_mfma_f32_16x16x32_bf16 v[176:179], a[224:227], v[40:43], v[176:179]
ds_read_b64_tr_b16 a[204:205], v9 offset:0
ds_read_b64_tr_b16 a[206:207], v9 offset:4096
v_mfma_f32_16x16x32_bf16 v[176:179], a[228:231], v[44:47], v[176:179]
v_exp_f32 v25, v25
v_mfma_f32_16x16x32_bf16 v[180:183], a[232:235], v[44:47], v[180:183]
ds_read_b64_tr_b16 a[208:209], v10 offset:0
v_cvt_pk_bf16_f32 v36, v24, v25
v_mfma_f32_16x16x32_bf16 v[180:183], a[236:239], v[40:43], v[180:183]
v_exp_f32 v26, v26
v_mfma_f32_16x16x32_bf16 v[184:187], a[240:243], v[40:43], v[184:187]
ds_read_b64_tr_b16 a[210:211], v10 offset:4096
ds_read_b64_tr_b16 a[212:213], v10 offset:8192
v_mfma_f32_16x16x32_bf16 v[184:187], a[244:247], v[44:47], v[184:187]
v_exp_f32 v27, v27
v_mfma_f32_16x16x32_bf16 v[188:191], a[248:251], v[44:47], v[188:191]
ds_read_b64_tr_b16 a[214:215], v10 offset:12288
v_cvt_pk_bf16_f32 v37, v26, v27
v_mfma_f32_16x16x32_bf16 v[188:191], a[252:255], v[40:43], v[188:191]
v_exp_f32 v28, v28
v_mfma_f32_16x16x32_bf16 v[16:19], a[128:131], a[80:83], -4.0
ds_read_b64_tr_b16 a[216:217], v11 offset:8192
ds_read_b64_tr_b16 a[218:219], v11 offset:12288
v_mfma_f32_16x16x32_bf16 v[16:19], a[132:135], a[84:87], v[16:19]
v_exp_f32 v29, v29
v_mfma_f32_16x16x32_bf16 v[16:19], a[136:139], a[88:91], v[16:19]
ds_read_b64_tr_b16 a[220:221], v11 offset:0
ds_read_b64_tr_b16 a[222:223], v11 offset:4096
v_mfma_f32_16x16x32_bf16 v[16:19], a[140:143], a[92:95], v[16:19]
v_exp_f32 v30, v30
v_mfma_f32_16x16x32_bf16 v[20:23], a[144:147], a[92:95], -4.0
ds_read_b64_tr_b16 a[224:225], v8 offset:1024
v_cvt_pk_bf16_f32 v38, v28, v29
v_mfma_f32_16x16x32_bf16 v[20:23], a[148:151], a[88:91], v[20:23]
v_exp_f32 v31, v31
v_mfma_f32_16x16x32_bf16 v[20:23], a[152:155], a[84:87], v[20:23]
ds_read_b64_tr_b16 a[226:227], v8 offset:5120
v_cvt_pk_bf16_f32 v39, v30, v31
v_mfma_f32_16x16x32_bf16 v[20:23], a[156:159], a[80:83], v[20:23]
v_exp_f32 v16, v16
v_mfma_f32_16x16x32_bf16 v[24:27], a[160:163], a[80:83], -4.0
ds_read_b64_tr_b16 a[228:229], v8 offset:9216
ds_read_b64_tr_b16 a[230:231], v8 offset:13312
v_mfma_f32_16x16x32_bf16 v[24:27], a[164:167], a[84:87], v[24:27]
v_exp_f32 v17, v17
v_mfma_f32_16x16x32_bf16 v[24:27], a[168:171], a[88:91], v[24:27]
ds_read_b64_tr_b16 a[232:233], v9 offset:9216
v_cvt_pk_bf16_f32 v40, v16, v17
v_mfma_f32_16x16x32_bf16 v[24:27], a[172:175], a[92:95], v[24:27]
v_exp_f32 v18, v18
v_mfma_f32_16x16x32_bf16 v[28:31], a[176:179], a[92:95], -4.0
ds_read_b64_tr_b16 a[234:235], v9 offset:13312
ds_read_b64_tr_b16 a[236:237], v9 offset:1024
v_mfma_f32_16x16x32_bf16 v[28:31], a[180:183], a[88:91], v[28:31]
v_exp_f32 v19, v19
v_mfma_f32_16x16x32_bf16 v[28:31], a[184:187], a[84:87], v[28:31]
ds_read_b64_tr_b16 a[238:239], v9 offset:5120
v_cvt_pk_bf16_f32 v41, v18, v19
v_mfma_f32_16x16x32_bf16 v[28:31], a[188:191], a[80:83], v[28:31]
v_exp_f32 v20, v20
v_smfmac_f32_16x16x64_bf16 v[48:51], v[12:15], v[32:39], v1
s_waitcnt lgkmcnt(15)
ds_read_b64_tr_b16 a[240:241], v10 offset:1024
v_mfma_f32_16x16x32_bf16 v[64:67], a[192:195], v[32:35], v[64:67]
ds_read_b64_tr_b16 a[242:243], v10 offset:5120
ds_read_b64_tr_b16 a[244:245], v10 offset:9216
v_mfma_f32_16x16x32_bf16 v[64:67], a[196:199], v[36:39], v[64:67]
v_exp_f32 v21, v21
v_mfma_f32_16x16x32_bf16 v[68:71], a[200:203], v[36:39], v[68:71]
ds_read_b64_tr_b16 a[246:247], v10 offset:13312
v_cvt_pk_bf16_f32 v42, v20, v21
v_mfma_f32_16x16x32_bf16 v[68:71], a[204:207], v[32:35], v[68:71]
s_waitcnt lgkmcnt(15)
v_exp_f32 v22, v22
v_mfma_f32_16x16x32_bf16 v[72:75], a[208:211], v[32:35], v[72:75]
ds_read_b64_tr_b16 a[248:249], v11 offset:9216
ds_read_b64_tr_b16 a[250:251], v11 offset:13312
v_mfma_f32_16x16x32_bf16 v[72:75], a[212:215], v[36:39], v[72:75]
s_waitcnt lgkmcnt(14)
v_exp_f32 v23, v23
v_mfma_f32_16x16x32_bf16 v[76:79], a[216:219], v[36:39], v[76:79]
ds_read_b64_tr_b16 a[252:253], v11 offset:1024
v_cvt_pk_bf16_f32 v43, v22, v23
v_mfma_f32_16x16x32_bf16 v[76:79], a[220:223], v[32:35], v[76:79]
s_waitcnt lgkmcnt(11)
ds_read_b64_tr_b16 a[254:255], v11 offset:5120
v_exp_f32 v24, v24
v_mfma_f32_16x16x32_bf16 v[80:83], a[224:227], v[32:35], v[80:83]
v_subrev_u32 v4, 0x10000, v4
v_subrev_u32 v5, 0x10000, v5
v_mfma_f32_16x16x32_bf16 v[80:83], a[228:231], v[36:39], v[80:83]
s_waitcnt lgkmcnt(8)
v_exp_f32 v25, v25
v_mfma_f32_16x16x32_bf16 v[84:87], a[232:235], v[36:39], v[84:87]
v_cvt_pk_bf16_f32 v44, v24, v25
v_subrev_u32 v6, 0x10000, v6
v_mfma_f32_16x16x32_bf16 v[84:87], a[236:239], v[32:35], v[84:87]
s_waitcnt lgkmcnt(4)
v_exp_f32 v26, v26
v_mfma_f32_16x16x32_bf16 v[88:91], a[240:243], v[32:35], v[88:91]
v_subrev_u32 v7, 0x10000, v7
v_mfma_f32_16x16x32_bf16 v[88:91], a[244:247], v[36:39], v[88:91]
s_waitcnt lgkmcnt(0)
v_exp_f32 v27, v27
v_mfma_f32_16x16x32_bf16 v[92:95], a[248:251], v[36:39], v[92:95]
v_cvt_pk_bf16_f32 v45, v26, v27
v_mfma_f32_16x16x32_bf16 v[92:95], a[252:255], v[32:35], v[92:95]
v_exp_f32 v28, v28
v_mfma_f32_16x16x32_bf16 v[16:19], a[128:131], a[96:99], -4.0
s_barrier
v_mfma_f32_16x16x32_bf16 v[16:19], a[132:135], a[100:103], v[16:19]
s_add_u32 m0, s24, 0x0
v_exp_f32 v29, v29
v_mfma_f32_16x16x32_bf16 v[16:19], a[136:139], a[104:107], v[16:19]
buffer_load_dwordx4 v2, s[16:19], s72 offen offset:0 lds
v_mfma_f32_16x16x32_bf16 v[16:19], a[140:143], a[108:111], v[16:19]
v_exp_f32 v30, v30
v_mfma_f32_16x16x32_bf16 v[20:23], a[144:147], a[108:111], -4.0
v_cvt_pk_bf16_f32 v46, v28, v29
v_mfma_f32_16x16x32_bf16 v[20:23], a[148:151], a[104:107], v[20:23]
v_exp_f32 v31, v31
v_mfma_f32_16x16x32_bf16 v[20:23], a[152:155], a[100:103], v[20:23]
v_cvt_pk_bf16_f32 v47, v30, v31
v_mfma_f32_16x16x32_bf16 v[20:23], a[156:159], a[96:99], v[20:23]
v_exp_f32 v16, v16
v_mfma_f32_16x16x32_bf16 v[24:27], a[160:163], a[96:99], -4.0
buffer_load_dwordx4 v2, s[16:19], s72 offen offset:2048 lds
v_mfma_f32_16x16x32_bf16 v[24:27], a[164:167], a[100:103], v[24:27]
s_add_u32 m0, s24, 0x2000
v_exp_f32 v17, v17
v_mfma_f32_16x16x32_bf16 v[24:27], a[168:171], a[104:107], v[24:27]
v_cvt_pk_bf16_f32 v32, v16, v17
v_mfma_f32_16x16x32_bf16 v[24:27], a[172:175], a[108:111], v[24:27]
v_exp_f32 v18, v18
v_mfma_f32_16x16x32_bf16 v[28:31], a[176:179], a[108:111], -4.0
v_permlane16_swap_b32 v240, v242
v_mfma_f32_16x16x32_bf16 v[28:31], a[180:183], a[104:107], v[28:31]
v_exp_f32 v19, v19
v_mfma_f32_16x16x32_bf16 v[28:31], a[184:187], a[100:103], v[28:31]
v_cvt_pk_bf16_f32 v33, v18, v19
v_mfma_f32_16x16x32_bf16 v[28:31], a[188:191], a[96:99], v[28:31]
v_exp_f32 v20, v20
v_smfmac_f32_16x16x64_bf16 v[52:55], v[12:15], v[40:47], v1
v_mfma_f32_16x16x32_bf16 v[96:99], a[192:195], v[40:43], v[96:99]
buffer_load_dwordx4 v2, s[16:19], s73 offen offset:0 lds
v_mfma_f32_16x16x32_bf16 v[96:99], a[196:199], v[44:47], v[96:99]
v_exp_f32 v21, v21
v_mfma_f32_16x16x32_bf16 v[100:103], a[200:203], v[44:47], v[100:103]
v_cvt_pk_bf16_f32 v34, v20, v21
v_mfma_f32_16x16x32_bf16 v[100:103], a[204:207], v[40:43], v[100:103]
v_exp_f32 v22, v22
v_mfma_f32_16x16x32_bf16 v[104:107], a[208:211], v[40:43], v[104:107]
v_permlane16_swap_b32 v241, v243
v_mfma_f32_16x16x32_bf16 v[104:107], a[212:215], v[44:47], v[104:107]
v_exp_f32 v23, v23
v_mfma_f32_16x16x32_bf16 v[108:111], a[216:219], v[44:47], v[108:111]
v_cvt_pk_bf16_f32 v35, v22, v23
v_mfma_f32_16x16x32_bf16 v[108:111], a[220:223], v[40:43], v[108:111]
v_exp_f32 v24, v24
v_mfma_f32_16x16x32_bf16 v[112:115], a[224:227], v[40:43], v[112:115]
buffer_load_dwordx4 v2, s[16:19], s73 offen offset:2048 lds
v_mfma_f32_16x16x32_bf16 v[112:115], a[228:231], v[44:47], v[112:115]
v_exp_f32 v25, v25
v_mfma_f32_16x16x32_bf16 v[116:119], a[232:235], v[44:47], v[116:119]
v_cvt_pk_bf16_f32 v36, v24, v25
v_mfma_f32_16x16x32_bf16 v[116:119], a[236:239], v[40:43], v[116:119]
v_exp_f32 v26, v26
v_mfma_f32_16x16x32_bf16 v[120:123], a[240:243], v[40:43], v[120:123]
v_permlane16_swap_b32 v244, v246
v_mfma_f32_16x16x32_bf16 v[120:123], a[244:247], v[44:47], v[120:123]
v_exp_f32 v27, v27
v_mfma_f32_16x16x32_bf16 v[124:127], a[248:251], v[44:47], v[124:127]
v_cvt_pk_bf16_f32 v37, v26, v27
v_mfma_f32_16x16x32_bf16 v[124:127], a[252:255], v[40:43], v[124:127]
v_exp_f32 v28, v28
v_mfma_f32_16x16x32_bf16 v[16:19], a[128:131], a[112:115], -4.0
ds_read_b128 a[128:131], v4 offset:49152
v_mfma_f32_16x16x32_bf16 v[16:19], a[132:135], a[116:119], v[16:19]
v_exp_f32 v29, v29
v_mfma_f32_16x16x32_bf16 v[16:19], a[136:139], a[120:123], v[16:19]
ds_read_b128 a[132:135], v5 offset:49152
v_mfma_f32_16x16x32_bf16 v[16:19], a[140:143], a[124:127], v[16:19]
v_exp_f32 v30, v30
v_mfma_f32_16x16x32_bf16 v[20:23], a[144:147], a[124:127], -4.0
ds_read_b128 a[136:139], v6 offset:49152
v_cvt_pk_bf16_f32 v38, v28, v29
v_mfma_f32_16x16x32_bf16 v[20:23], a[148:151], a[120:123], v[20:23]
v_exp_f32 v31, v31
v_mfma_f32_16x16x32_bf16 v[20:23], a[152:155], a[116:119], v[20:23]
ds_read_b128 a[140:143], v7 offset:49152
v_cvt_pk_bf16_f32 v39, v30, v31
v_mfma_f32_16x16x32_bf16 v[20:23], a[156:159], a[112:115], v[20:23]
v_exp_f32 v16, v16
v_mfma_f32_16x16x32_bf16 v[24:27], a[160:163], a[112:115], -4.0
L_pg7:
s_cbranch_vccnz L_pg11
ds_read_b128 a[144:147], v7 offset:53248
v_mfma_f32_16x16x32_bf16 v[24:27], a[164:167], a[116:119], v[24:27]
v_exp_f32 v17, v17
v_mfma_f32_16x16x32_bf16 v[24:27], a[168:171], a[120:123], v[24:27]
ds_read_b128 a[148:151], v6 offset:53248
v_cvt_pk_bf16_f32 v40, v16, v17
v_mfma_f32_16x16x32_bf16 v[24:27], a[172:175], a[124:127], v[24:27]
v_exp_f32 v18, v18
v_mfma_f32_16x16x32_bf16 v[28:31], a[176:179], a[124:127], -4.0
ds_read_b128 a[152:155], v5 offset:53248
v_mfma_f32_16x16x32_bf16 v[28:31], a[180:183], a[120:123], v[28:31]
v_exp_f32 v19, v19
v_mfma_f32_16x16x32_bf16 v[28:31], a[184:187], a[116:119], v[28:31]
ds_read_b128 a[156:159], v4 offset:53248
v_cvt_pk_bf16_f32 v41, v18, v19
v_mfma_f32_16x16x32_bf16 v[28:31], a[188:191], a[112:115], v[28:31]
v_exp_f32 v20, v20
v_smfmac_f32_16x16x64_bf16 v[56:59], v[12:15], v[32:39], v1
ds_read_b128 a[160:163], v4 offset:57344
v_mfma_f32_16x16x32_bf16 v[128:131], a[192:195], v[32:35], v[128:131]
ds_read_b128 a[164:167], v5 offset:57344
v_mfma_f32_16x16x32_bf16 v[128:131], a[196:199], v[36:39], v[128:131]
v_exp_f32 v21, v21
v_mfma_f32_16x16x32_bf16 v[132:135], a[200:203], v[36:39], v[132:135]
ds_read_b128 a[168:171], v6 offset:57344
v_cvt_pk_bf16_f32 v42, v20, v21
v_mfma_f32_16x16x32_bf16 v[132:135], a[204:207], v[32:35], v[132:135]
v_exp_f32 v22, v22
v_mfma_f32_16x16x32_bf16 v[136:139], a[208:211], v[32:35], v[136:139]
ds_read_b128 a[172:175], v7 offset:57344
v_mfma_f32_16x16x32_bf16 v[136:139], a[212:215], v[36:39], v[136:139]
v_exp_f32 v23, v23
v_mfma_f32_16x16x32_bf16 v[140:143], a[216:219], v[36:39], v[140:143]
ds_read_b128 a[176:179], v7 offset:61440
v_cvt_pk_bf16_f32 v43, v22, v23
v_mfma_f32_16x16x32_bf16 v[140:143], a[220:223], v[32:35], v[140:143]
v_exp_f32 v24, v24
v_mfma_f32_16x16x32_bf16 v[144:147], a[224:227], v[32:35], v[144:147]
ds_read_b128 a[180:183], v6 offset:61440
v_mfma_f32_16x16x32_bf16 v[144:147], a[228:231], v[36:39], v[144:147]
v_exp_f32 v25, v25
v_mfma_f32_16x16x32_bf16 v[148:151], a[232:235], v[36:39], v[148:151]
ds_read_b128 a[184:187], v5 offset:61440
v_cvt_pk_bf16_f32 v44, v24, v25
v_mfma_f32_16x16x32_bf16 v[148:151], a[236:239], v[32:35], v[148:151]
v_exp_f32 v26, v26
v_mfma_f32_16x16x32_bf16 v[152:155], a[240:243], v[32:35], v[152:155]
ds_read_b128 a[188:191], v4 offset:61440
v_mfma_f32_16x16x32_bf16 v[152:155], a[244:247], v[36:39], v[152:155]
v_exp_f32 v27, v27
v_mfma_f32_16x16x32_bf16 v[156:159], a[248:251], v[36:39], v[156:159]
v_cvt_pk_bf16_f32 v45, v26, v27
v_mfma_f32_16x16x32_bf16 v[156:159], a[252:255], v[32:35], v[156:159]
s_waitcnt lgkmcnt(12)
v_exp_f32 v28, v28
v_mfma_f32_16x16x32_bf16 v[16:19], a[128:131], a[64:67], -4.0
v_permlane16_swap_b32 v245, v247
v_mfma_f32_16x16x32_bf16 v[16:19], a[132:135], a[68:71], v[16:19]
v_exp_f32 v29, v29
v_mfma_f32_16x16x32_bf16 v[16:19], a[136:139], a[72:75], v[16:19]
v_permlane16_swap_b32 v248, v250
v_mfma_f32_16x16x32_bf16 v[16:19], a[140:143], a[76:79], v[16:19]
s_waitcnt lgkmcnt(8)
v_exp_f32 v30, v30
v_mfma_f32_16x16x32_bf16 v[20:23], a[144:147], a[76:79], -4.0
v_cvt_pk_bf16_f32 v46, v28, v29
v_mfma_f32_16x16x32_bf16 v[20:23], a[148:151], a[72:75], v[20:23]
v_exp_f32 v31, v31
v_mfma_f32_16x16x32_bf16 v[20:23], a[152:155], a[68:71], v[20:23]
v_cvt_pk_bf16_f32 v47, v30, v31
v_mfma_f32_16x16x32_bf16 v[20:23], a[156:159], a[64:67], v[20:23]
s_waitcnt lgkmcnt(4)
v_exp_f32 v16, v16
v_mfma_f32_16x16x32_bf16 v[24:27], a[160:163], a[64:67], -4.0
v_permlane16_swap_b32 v249, v251
v_mfma_f32_16x16x32_bf16 v[24:27], a[164:167], a[68:71], v[24:27]
v_exp_f32 v17, v17
v_mfma_f32_16x16x32_bf16 v[24:27], a[168:171], a[72:75], v[24:27]
v_cvt_pk_bf16_f32 v32, v16, v17
v_mfma_f32_16x16x32_bf16 v[24:27], a[172:175], a[76:79], v[24:27]
s_waitcnt lgkmcnt(0)
v_exp_f32 v18, v18
v_mfma_f32_16x16x32_bf16 v[28:31], a[176:179], a[76:79], -4.0
v_permlane16_swap_b32 v252, v254
v_mfma_f32_16x16x32_bf16 v[28:31], a[180:183], a[72:75], v[28:31]
v_exp_f32 v19, v19
v_mfma_f32_16x16x32_bf16 v[28:31], a[184:187], a[68:71], v[28:31]
v_cvt_pk_bf16_f32 v33, v18, v19
v_mfma_f32_16x16x32_bf16 v[28:31], a[188:191], a[64:67], v[28:31]
s_waitcnt vmcnt(4)
v_exp_f32 v20, v20
v_smfmac_f32_16x16x64_bf16 v[60:63], v[12:15], v[40:47], v1
s_barrier
v_mfma_f32_16x16x32_bf16 v[160:163], a[192:195], v[40:43], v[160:163]
ds_read_b64_tr_b16 a[192:193], v8 offset:16384
ds_read_b64_tr_b16 a[194:195], v8 offset:20480
v_mfma_f32_16x16x32_bf16 v[160:163], a[196:199], v[44:47], v[160:163]
v_exp_f32 v21, v21
v_mfma_f32_16x16x32_bf16 v[164:167], a[200:203], v[44:47], v[164:167]
ds_read_b64_tr_b16 a[196:197], v8 offset:24576
v_cvt_pk_bf16_f32 v34, v20, v21
v_mfma_f32_16x16x32_bf16 v[164:167], a[204:207], v[40:43], v[164:167]
v_exp_f32 v22, v22
v_mfma_f32_16x16x32_bf16 v[168:171], a[208:211], v[40:43], v[168:171]
ds_read_b64_tr_b16 a[198:199], v8 offset:28672
ds_read_b64_tr_b16 a[200:201], v9 offset:24576
v_mfma_f32_16x16x32_bf16 v[168:171], a[212:215], v[44:47], v[168:171]
v_exp_f32 v23, v23
v_mfma_f32_16x16x32_bf16 v[172:175], a[216:219], v[44:47], v[172:175]
ds_read_b64_tr_b16 a[202:203], v9 offset:28672
v_cvt_pk_bf16_f32 v35, v22, v23
v_mfma_f32_16x16x32_bf16 v[172:175], a[220:223], v[40:43], v[172:175]
v_exp_f32 v24, v24
v_mfma_f32_16x16x32_bf16 v[176:179], a[224:227], v[40:43], v[176:179]
ds_read_b64_tr_b16 a[204:205], v9 offset:16384
ds_read_b64_tr_b16 a[206:207], v9 offset:20480
v_mfma_f32_16x16x32_bf16 v[176:179], a[228:231], v[44:47], v[176:179]
v_exp_f32 v25, v25
v_mfma_f32_16x16x32_bf16 v[180:183], a[232:235], v[44:47], v[180:183]
ds_read_b64_tr_b16 a[208:209], v10 offset:16384
v_cvt_pk_bf16_f32 v36, v24, v25
v_mfma_f32_16x16x32_bf16 v[180:183], a[236:239], v[40:43], v[180:183]
v_exp_f32 v26, v26
v_mfma_f32_16x16x32_bf16 v[184:187], a[240:243], v[40:43], v[184:187]
ds_read_b64_tr_b16 a[210:211], v10 offset:20480
ds_read_b64_tr_b16 a[212:213], v10 offset:24576
v_mfma_f32_16x16x32_bf16 v[184:187], a[244:247], v[44:47], v[184:187]
v_exp_f32 v27, v27
v_mfma_f32_16x16x32_bf16 v[188:191], a[248:251], v[44:47], v[188:191]
ds_read_b64_tr_b16 a[214:215], v10 offset:28672
v_cvt_pk_bf16_f32 v37, v26, v27
v_mfma_f32_16x16x32_bf16 v[188:191], a[252:255], v[40:43], v[188:191]
v_exp_f32 v28, v28
v_mfma_f32_16x16x32_bf16 v[16:19], a[128:131], a[80:83], -4.0
ds_read_b64_tr_b16 a[216:217], v11 offset:24576
ds_read_b64_tr_b16 a[218:219], v11 offset:28672
v_mfma_f32_16x16x32_bf16 v[16:19], a[132:135], a[84:87], v[16:19]
v_exp_f32 v29, v29
v_mfma_f32_16x16x32_bf16 v[16:19], a[136:139], a[88:91], v[16:19]
ds_read_b64_tr_b16 a[220:221], v11 offset:16384
ds_read_b64_tr_b16 a[222:223], v11 offset:20480
v_mfma_f32_16x16x32_bf16 v[16:19], a[140:143], a[92:95], v[16:19]
v_exp_f32 v30, v30
v_mfma_f32_16x16x32_bf16 v[20:23], a[144:147], a[92:95], -4.0
ds_read_b64_tr_b16 a[224:225], v8 offset:17408
v_cvt_pk_bf16_f32 v38, v28, v29
v_mfma_f32_16x16x32_bf16 v[20:23], a[148:151], a[88:91], v[20:23]
v_exp_f32 v31, v31
v_mfma_f32_16x16x32_bf16 v[20:23], a[152:155], a[84:87], v[20:23]
ds_read_b64_tr_b16 a[226:227], v8 offset:21504
v_cvt_pk_bf16_f32 v39, v30, v31
v_mfma_f32_16x16x32_bf16 v[20:23], a[156:159], a[80:83], v[20:23]
v_exp_f32 v16, v16
v_mfma_f32_16x16x32_bf16 v[24:27], a[160:163], a[80:83], -4.0
ds_read_b64_tr_b16 a[228:229], v8 offset:25600
ds_read_b64_tr_b16 a[230:231], v8 offset:29696
v_mfma_f32_16x16x32_bf16 v[24:27], a[164:167], a[84:87], v[24:27]
v_exp_f32 v17, v17
v_mfma_f32_16x16x32_bf16 v[24:27], a[168:171], a[88:91], v[24:27]
ds_read_b64_tr_b16 a[232:233], v9 offset:25600
v_cvt_pk_bf16_f32 v40, v16, v17
v_mfma_f32_16x16x32_bf16 v[24:27], a[172:175], a[92:95], v[24:27]
v_exp_f32 v18, v18
v_mfma_f32_16x16x32_bf16 v[28:31], a[176:179], a[92:95], -4.0
ds_read_b64_tr_b16 a[234:235], v9 offset:29696
ds_read_b64_tr_b16 a[236:237], v9 offset:17408
v_mfma_f32_16x16x32_bf16 v[28:31], a[180:183], a[88:91], v[28:31]
v_exp_f32 v19, v19
v_mfma_f32_16x16x32_bf16 v[28:31], a[184:187], a[84:87], v[28:31]
ds_read_b64_tr_b16 a[238:239], v9 offset:21504
v_cvt_pk_bf16_f32 v41, v18, v19
v_mfma_f32_16x16x32_bf16 v[28:31], a[188:191], a[80:83], v[28:31]
v_exp_f32 v20, v20
v_smfmac_f32_16x16x64_bf16 v[48:51], v[12:15], v[32:39], v1
s_waitcnt lgkmcnt(15)
ds_read_b64_tr_b16 a[240:241], v10 offset:17408
v_mfma_f32_16x16x32_bf16 v[64:67], a[192:195], v[32:35], v[64:67]
ds_read_b64_tr_b16 a[242:243], v10 offset:21504
ds_read_b64_tr_b16 a[244:245], v10 offset:25600
v_mfma_f32_16x16x32_bf16 v[64:67], a[196:199], v[36:39], v[64:67]
v_exp_f32 v21, v21
v_mfma_f32_16x16x32_bf16 v[68:71], a[200:203], v[36:39], v[68:71]
ds_read_b64_tr_b16 a[246:247], v10 offset:29696
v_cvt_pk_bf16_f32 v42, v20, v21
v_mfma_f32_16x16x32_bf16 v[68:71], a[204:207], v[32:35], v[68:71]
s_waitcnt lgkmcnt(15)
v_exp_f32 v22, v22
v_mfma_f32_16x16x32_bf16 v[72:75], a[208:211], v[32:35], v[72:75]
ds_read_b64_tr_b16 a[248:249], v11 offset:25600
ds_read_b64_tr_b16 a[250:251], v11 offset:29696
v_mfma_f32_16x16x32_bf16 v[72:75], a[212:215], v[36:39], v[72:75]
s_waitcnt lgkmcnt(14)
v_exp_f32 v23, v23
v_mfma_f32_16x16x32_bf16 v[76:79], a[216:219], v[36:39], v[76:79]
ds_read_b64_tr_b16 a[252:253], v11 offset:17408
v_cvt_pk_bf16_f32 v43, v22, v23
v_mfma_f32_16x16x32_bf16 v[76:79], a[220:223], v[32:35], v[76:79]
s_waitcnt lgkmcnt(11)
ds_read_b64_tr_b16 a[254:255], v11 offset:21504
v_exp_f32 v24, v24
v_mfma_f32_16x16x32_bf16 v[80:83], a[224:227], v[32:35], v[80:83]
v_permlane16_swap_b32 v253, v255
v_mfma_f32_16x16x32_bf16 v[80:83], a[228:231], v[36:39], v[80:83]
s_waitcnt lgkmcnt(8)
v_exp_f32 v25, v25
v_mfma_f32_16x16x32_bf16 v[84:87], a[232:235], v[36:39], v[84:87]
v_cvt_pk_bf16_f32 v44, v24, v25
v_mfma_f32_16x16x32_bf16 v[84:87], a[236:239], v[32:35], v[84:87]
s_waitcnt lgkmcnt(4)
v_exp_f32 v26, v26
v_mfma_f32_16x16x32_bf16 v[88:91], a[240:243], v[32:35], v[88:91]
v_permlane16_swap_b32 v192, v194
v_mfma_f32_16x16x32_bf16 v[88:91], a[244:247], v[36:39], v[88:91]
s_waitcnt lgkmcnt(0)
v_exp_f32 v27, v27
v_mfma_f32_16x16x32_bf16 v[92:95], a[248:251], v[36:39], v[92:95]
v_cvt_pk_bf16_f32 v45, v26, v27
v_mfma_f32_16x16x32_bf16 v[92:95], a[252:255], v[32:35], v[92:95]
v_exp_f32 v28, v28
v_mfma_f32_16x16x32_bf16 v[16:19], a[128:131], a[96:99], -4.0
s_barrier
v_mfma_f32_16x16x32_bf16 v[16:19], a[132:135], a[100:103], v[16:19]
s_add_u32 m0, s24, 0x4000
v_exp_f32 v29, v29
v_mfma_f32_16x16x32_bf16 v[16:19], a[136:139], a[104:107], v[16:19]
buffer_load_dwordx4 v2, s[16:19], s70 offen offset:0 lds
v_mfma_f32_16x16x32_bf16 v[16:19], a[140:143], a[108:111], v[16:19]
v_exp_f32 v30, v30
v_mfma_f32_16x16x32_bf16 v[20:23], a[144:147], a[108:111], -4.0
v_cvt_pk_bf16_f32 v46, v28, v29
v_mfma_f32_16x16x32_bf16 v[20:23], a[148:151], a[104:107], v[20:23]
v_exp_f32 v31, v31
v_mfma_f32_16x16x32_bf16 v[20:23], a[152:155], a[100:103], v[20:23]
v_cvt_pk_bf16_f32 v47, v30, v31
v_mfma_f32_16x16x32_bf16 v[20:23], a[156:159], a[96:99], v[20:23]
v_exp_f32 v16, v16
v_mfma_f32_16x16x32_bf16 v[24:27], a[160:163], a[96:99], -4.0
buffer_load_dwordx4 v2, s[16:19], s70 offen offset:2048 lds
v_mfma_f32_16x16x32_bf16 v[24:27], a[164:167], a[100:103], v[24:27]
s_add_u32 m0, s24, 0x6000
v_exp_f32 v17, v17
v_mfma_f32_16x16x32_bf16 v[24:27], a[168:171], a[104:107], v[24:27]
v_cvt_pk_bf16_f32 v32, v16, v17
v_mfma_f32_16x16x32_bf16 v[24:27], a[172:175], a[108:111], v[24:27]
v_exp_f32 v18, v18
v_mfma_f32_16x16x32_bf16 v[28:31], a[176:179], a[108:111], -4.0
v_permlane16_swap_b32 v193, v195
v_mfma_f32_16x16x32_bf16 v[28:31], a[180:183], a[104:107], v[28:31]
v_exp_f32 v19, v19
v_mfma_f32_16x16x32_bf16 v[28:31], a[184:187], a[100:103], v[28:31]
v_cvt_pk_bf16_f32 v33, v18, v19
v_mfma_f32_16x16x32_bf16 v[28:31], a[188:191], a[96:99], v[28:31]
v_exp_f32 v20, v20
v_smfmac_f32_16x16x64_bf16 v[52:55], v[12:15], v[40:47], v1
v_mfma_f32_16x16x32_bf16 v[96:99], a[192:195], v[40:43], v[96:99]
buffer_load_dwordx4 v2, s[16:19], s71 offen offset:0 lds
v_mfma_f32_16x16x32_bf16 v[96:99], a[196:199], v[44:47], v[96:99]
v_exp_f32 v21, v21
v_mfma_f32_16x16x32_bf16 v[100:103], a[200:203], v[44:47], v[100:103]
v_cvt_pk_bf16_f32 v34, v20, v21
v_mfma_f32_16x16x32_bf16 v[100:103], a[204:207], v[40:43], v[100:103]
v_exp_f32 v22, v22
v_mfma_f32_16x16x32_bf16 v[104:107], a[208:211], v[40:43], v[104:107]
v_permlane16_swap_b32 v196, v198
v_mfma_f32_16x16x32_bf16 v[104:107], a[212:215], v[44:47], v[104:107]
v_exp_f32 v23, v23
v_mfma_f32_16x16x32_bf16 v[108:111], a[216:219], v[44:47], v[108:111]
v_cvt_pk_bf16_f32 v35, v22, v23
v_mfma_f32_16x16x32_bf16 v[108:111], a[220:223], v[40:43], v[108:111]
v_exp_f32 v24, v24
v_mfma_f32_16x16x32_bf16 v[112:115], a[224:227], v[40:43], v[112:115]
buffer_load_dwordx4 v2, s[16:19], s71 offen offset:2048 lds
v_mfma_f32_16x16x32_bf16 v[112:115], a[228:231], v[44:47], v[112:115]
v_exp_f32 v25, v25
v_mfma_f32_16x16x32_bf16 v[116:119], a[232:235], v[44:47], v[116:119]
v_cvt_pk_bf16_f32 v36, v24, v25
v_mfma_f32_16x16x32_bf16 v[116:119], a[236:239], v[40:43], v[116:119]
v_exp_f32 v26, v26
v_mfma_f32_16x16x32_bf16 v[120:123], a[240:243], v[40:43], v[120:123]
v_permlane16_swap_b32 v197, v199
v_mfma_f32_16x16x32_bf16 v[120:123], a[244:247], v[44:47], v[120:123]
v_exp_f32 v27, v27
v_mfma_f32_16x16x32_bf16 v[124:127], a[248:251], v[44:47], v[124:127]
v_cvt_pk_bf16_f32 v37, v26, v27
v_mfma_f32_16x16x32_bf16 v[124:127], a[252:255], v[40:43], v[124:127]
v_exp_f32 v28, v28
v_mfma_f32_16x16x32_bf16 v[16:19], a[128:131], a[112:115], -4.0
ds_read_b128 a[128:131], v4 offset:32768
v_mfma_f32_16x16x32_bf16 v[16:19], a[132:135], a[116:119], v[16:19]
v_exp_f32 v29, v29
v_mfma_f32_16x16x32_bf16 v[16:19], a[136:139], a[120:123], v[16:19]
ds_read_b128 a[132:135], v5 offset:32768
v_mfma_f32_16x16x32_bf16 v[16:19], a[140:143], a[124:127], v[16:19]
v_exp_f32 v30, v30
v_mfma_f32_16x16x32_bf16 v[20:23], a[144:147], a[124:127], -4.0
ds_read_b128 a[136:139], v6 offset:32768
v_cvt_pk_bf16_f32 v38, v28, v29
v_mfma_f32_16x16x32_bf16 v[20:23], a[148:151], a[120:123], v[20:23]
v_exp_f32 v31, v31
v_mfma_f32_16x16x32_bf16 v[20:23], a[152:155], a[116:119], v[20:23]
ds_read_b128 a[140:143], v7 offset:32768
v_cvt_pk_bf16_f32 v39, v30, v31
v_mfma_f32_16x16x32_bf16 v[20:23], a[156:159], a[112:115], v[20:23]
v_exp_f32 v16, v16
v_mfma_f32_16x16x32_bf16 v[24:27], a[160:163], a[112:115], -4.0
ds_read_b128 a[144:147], v7 offset:36864
v_mfma_f32_16x16x32_bf16 v[24:27], a[164:167], a[116:119], v[24:27]
v_exp_f32 v17, v17
v_mfma_f32_16x16x32_bf16 v[24:27], a[168:171], a[120:123], v[24:27]
ds_read_b128 a[148:151], v6 offset:36864
v_cvt_pk_bf16_f32 v40, v16, v17
v_mfma_f32_16x16x32_bf16 v[24:27], a[172:175], a[124:127], v[24:27]
v_exp_f32 v18, v18
v_mfma_f32_16x16x32_bf16 v[28:31], a[176:179], a[124:127], -4.0
ds_read_b128 a[152:155], v5 offset:36864
v_mfma_f32_16x16x32_bf16 v[28:31], a[180:183], a[120:123], v[28:31]
v_exp_f32 v19, v19
v_mfma_f32_16x16x32_bf16 v[28:31], a[184:187], a[116:119], v[28:31]
ds_read_b128 a[156:159], v4 offset:36864
v_cvt_pk_bf16_f32 v41, v18, v19
v_mfma_f32_16x16x32_bf16 v[28:31], a[188:191], a[112:115], v[28:31]
v_exp_f32 v20, v20
v_smfmac_f32_16x16x64_bf16 v[56:59], v[12:15], v[32:39], v1
ds_read_b128 a[160:163], v4 offset:40960
v_mfma_f32_16x16x32_bf16 v[128:131], a[192:195], v[32:35], v[128:131]
ds_read_b128 a[164:167], v5 offset:40960
v_mfma_f32_16x16x32_bf16 v[128:131], a[196:199], v[36:39], v[128:131]
v_exp_f32 v21, v21
v_mfma_f32_16x16x32_bf16 v[132:135], a[200:203], v[36:39], v[132:135]
ds_read_b128 a[168:171], v6 offset:40960
v_cvt_pk_bf16_f32 v42, v20, v21
v_mfma_f32_16x16x32_bf16 v[132:135], a[204:207], v[32:35], v[132:135]
v_exp_f32 v22, v22
v_mfma_f32_16x16x32_bf16 v[136:139], a[208:211], v[32:35], v[136:139]
ds_read_b128 a[172:175], v7 offset:40960
v_mfma_f32_16x16x32_bf16 v[136:139], a[212:215], v[36:39], v[136:139]
v_exp_f32 v23, v23
v_mfma_f32_16x16x32_bf16 v[140:143], a[216:219], v[36:39], v[140:143]
ds_read_b128 a[176:179], v7 offset:45056
v_cvt_pk_bf16_f32 v43, v22, v23
v_mfma_f32_16x16x32_bf16 v[140:143], a[220:223], v[32:35], v[140:143]
v_exp_f32 v24, v24
v_mfma_f32_16x16x32_bf16 v[144:147], a[224:227], v[32:35], v[144:147]
buffer_store_dwordx4 v[208:211], v0, s[20:23], s32 offen offset:0 sc1
v_mfma_f32_16x16x32_bf16 v[144:147], a[228:231], v[36:39], v[144:147]
v_exp_f32 v25, v25
v_mfma_f32_16x16x32_bf16 v[148:151], a[232:235], v[36:39], v[148:151]
ds_read_b128 a[180:183], v6 offset:45056
v_cvt_pk_bf16_f32 v44, v24, v25
v_mfma_f32_16x16x32_bf16 v[148:151], a[236:239], v[32:35], v[148:151]
v_exp_f32 v26, v26
v_mfma_f32_16x16x32_bf16 v[152:155], a[240:243], v[32:35], v[152:155]
ds_read_b128 a[184:187], v5 offset:45056
v_mfma_f32_16x16x32_bf16 v[152:155], a[244:247], v[36:39], v[152:155]
v_exp_f32 v27, v27
v_mfma_f32_16x16x32_bf16 v[156:159], a[248:251], v[36:39], v[156:159]
ds_read_b128 a[188:191], v4 offset:45056
v_cvt_pk_bf16_f32 v45, v26, v27
v_mfma_f32_16x16x32_bf16 v[156:159], a[252:255], v[32:35], v[156:159]
s_waitcnt lgkmcnt(12)
v_exp_f32 v28, v28
v_mfma_f32_16x16x32_bf16 v[16:19], a[128:131], a[64:67], -4.0
v_permlane16_swap_b32 v200, v202
v_mfma_f32_16x16x32_bf16 v[16:19], a[132:135], a[68:71], v[16:19]
v_exp_f32 v29, v29
v_mfma_f32_16x16x32_bf16 v[16:19], a[136:139], a[72:75], v[16:19]
v_permlane16_swap_b32 v201, v203
v_mfma_f32_16x16x32_bf16 v[16:19], a[140:143], a[76:79], v[16:19]
s_waitcnt lgkmcnt(8)
v_exp_f32 v30, v30
v_mfma_f32_16x16x32_bf16 v[20:23], a[144:147], a[76:79], -4.0
v_cvt_pk_bf16_f32 v46, v28, v29
v_mfma_f32_16x16x32_bf16 v[20:23], a[148:151], a[72:75], v[20:23]
v_exp_f32 v31, v31
v_mfma_f32_16x16x32_bf16 v[20:23], a[152:155], a[68:71], v[20:23]
v_cvt_pk_bf16_f32 v47, v30, v31
v_mfma_f32_16x16x32_bf16 v[20:23], a[156:159], a[64:67], v[20:23]
s_waitcnt lgkmcnt(4)
v_exp_f32 v16, v16
v_mfma_f32_16x16x32_bf16 v[24:27], a[160:163], a[64:67], -4.0
v_permlane16_swap_b32 v204, v206
v_mfma_f32_16x16x32_bf16 v[24:27], a[164:167], a[68:71], v[24:27]
v_exp_f32 v17, v17
v_mfma_f32_16x16x32_bf16 v[24:27], a[168:171], a[72:75], v[24:27]
v_cvt_pk_bf16_f32 v32, v16, v17
v_mfma_f32_16x16x32_bf16 v[24:27], a[172:175], a[76:79], v[24:27]
s_waitcnt lgkmcnt(0)
v_exp_f32 v18, v18
v_mfma_f32_16x16x32_bf16 v[28:31], a[176:179], a[76:79], -4.0
buffer_store_dwordx4 v[212:215], v0, s[20:23], s32 offen offset:64 sc1
v_mfma_f32_16x16x32_bf16 v[28:31], a[180:183], a[72:75], v[28:31]
v_exp_f32 v19, v19
v_mfma_f32_16x16x32_bf16 v[28:31], a[184:187], a[68:71], v[28:31]
v_cvt_pk_bf16_f32 v33, v18, v19
v_mfma_f32_16x16x32_bf16 v[28:31], a[188:191], a[64:67], v[28:31]
s_waitcnt vmcnt(6)
v_exp_f32 v20, v20
v_smfmac_f32_16x16x64_bf16 v[60:63], v[12:15], v[40:47], v1
s_barrier
v_mfma_f32_16x16x32_bf16 v[160:163], a[192:195], v[40:43], v[160:163]
ds_read_b64_tr_b16 a[192:193], v8 offset:0
ds_read_b64_tr_b16 a[194:195], v8 offset:4096
v_mfma_f32_16x16x32_bf16 v[160:163], a[196:199], v[44:47], v[160:163]
v_exp_f32 v21, v21
v_mfma_f32_16x16x32_bf16 v[164:167], a[200:203], v[44:47], v[164:167]
ds_read_b64_tr_b16 a[196:197], v8 offset:8192
v_cvt_pk_bf16_f32 v34, v20, v21
v_mfma_f32_16x16x32_bf16 v[164:167], a[204:207], v[40:43], v[164:167]
v_exp_f32 v22, v22
v_mfma_f32_16x16x32_bf16 v[168:171], a[208:211], v[40:43], v[168:171]
ds_read_b64_tr_b16 a[198:199], v8 offset:12288
ds_read_b64_tr_b16 a[200:201], v9 offset:8192
v_mfma_f32_16x16x32_bf16 v[168:171], a[212:215], v[44:47], v[168:171]
v_exp_f32 v23, v23
v_mfma_f32_16x16x32_bf16 v[172:175], a[216:219], v[44:47], v[172:175]
ds_read_b64_tr_b16 a[202:203], v9 offset:12288
v_cvt_pk_bf16_f32 v35, v22, v23
v_mfma_f32_16x16x32_bf16 v[172:175], a[220:223], v[40:43], v[172:175]
v_exp_f32 v24, v24
v_mfma_f32_16x16x32_bf16 v[176:179], a[224:227], v[40:43], v[176:179]
ds_read_b64_tr_b16 a[204:205], v9 offset:0
ds_read_b64_tr_b16 a[206:207], v9 offset:4096
v_mfma_f32_16x16x32_bf16 v[176:179], a[228:231], v[44:47], v[176:179]
v_exp_f32 v25, v25
v_mfma_f32_16x16x32_bf16 v[180:183], a[232:235], v[44:47], v[180:183]
ds_read_b64_tr_b16 a[208:209], v10 offset:0
v_cvt_pk_bf16_f32 v36, v24, v25
v_mfma_f32_16x16x32_bf16 v[180:183], a[236:239], v[40:43], v[180:183]
v_exp_f32 v26, v26
v_mfma_f32_16x16x32_bf16 v[184:187], a[240:243], v[40:43], v[184:187]
ds_read_b64_tr_b16 a[210:211], v10 offset:4096
ds_read_b64_tr_b16 a[212:213], v10 offset:8192
v_mfma_f32_16x16x32_bf16 v[184:187], a[244:247], v[44:47], v[184:187]
v_exp_f32 v27, v27
v_mfma_f32_16x16x32_bf16 v[188:191], a[248:251], v[44:47], v[188:191]
ds_read_b64_tr_b16 a[214:215], v10 offset:12288
v_cvt_pk_bf16_f32 v37, v26, v27
v_mfma_f32_16x16x32_bf16 v[188:191], a[252:255], v[40:43], v[188:191]
v_exp_f32 v28, v28
v_mfma_f32_16x16x32_bf16 v[16:19], a[128:131], a[80:83], -4.0
ds_read_b64_tr_b16 a[216:217], v11 offset:8192
ds_read_b64_tr_b16 a[218:219], v11 offset:12288
v_mfma_f32_16x16x32_bf16 v[16:19], a[132:135], a[84:87], v[16:19]
v_exp_f32 v29, v29
v_mfma_f32_16x16x32_bf16 v[16:19], a[136:139], a[88:91], v[16:19]
ds_read_b64_tr_b16 a[220:221], v11 offset:0
ds_read_b64_tr_b16 a[222:223], v11 offset:4096
v_mfma_f32_16x16x32_bf16 v[16:19], a[140:143], a[92:95], v[16:19]
v_exp_f32 v30, v30
v_mfma_f32_16x16x32_bf16 v[20:23], a[144:147], a[92:95], -4.0
ds_read_b64_tr_b16 a[224:225], v8 offset:1024
v_cvt_pk_bf16_f32 v38, v28, v29
v_mfma_f32_16x16x32_bf16 v[20:23], a[148:151], a[88:91], v[20:23]
v_exp_f32 v31, v31
v_mfma_f32_16x16x32_bf16 v[20:23], a[152:155], a[84:87], v[20:23]
ds_read_b64_tr_b16 a[226:227], v8 offset:5120
v_cvt_pk_bf16_f32 v39, v30, v31
v_mfma_f32_16x16x32_bf16 v[20:23], a[156:159], a[80:83], v[20:23]
v_exp_f32 v16, v16
v_mfma_f32_16x16x32_bf16 v[24:27], a[160:163], a[80:83], -4.0
ds_read_b64_tr_b16 a[228:229], v8 offset:9216
ds_read_b64_tr_b16 a[230:231], v8 offset:13312
v_mfma_f32_16x16x32_bf16 v[24:27], a[164:167], a[84:87], v[24:27]
v_exp_f32 v17, v17
v_mfma_f32_16x16x32_bf16 v[24:27], a[168:171], a[88:91], v[24:27]
ds_read_b64_tr_b16 a[232:233], v9 offset:9216
v_cvt_pk_bf16_f32 v40, v16, v17
v_mfma_f32_16x16x32_bf16 v[24:27], a[172:175], a[92:95], v[24:27]
v_exp_f32 v18, v18
v_mfma_f32_16x16x32_bf16 v[28:31], a[176:179], a[92:95], -4.0
ds_read_b64_tr_b16 a[234:235], v9 offset:13312
ds_read_b64_tr_b16 a[236:237], v9 offset:1024
v_mfma_f32_16x16x32_bf16 v[28:31], a[180:183], a[88:91], v[28:31]
v_exp_f32 v19, v19
v_mfma_f32_16x16x32_bf16 v[28:31], a[184:187], a[84:87], v[28:31]
ds_read_b64_tr_b16 a[238:239], v9 offset:5120
v_cvt_pk_bf16_f32 v41, v18, v19
v_mfma_f32_16x16x32_bf16 v[28:31], a[188:191], a[80:83], v[28:31]
v_exp_f32 v20, v20
v_smfmac_f32_16x16x64_bf16 v[48:51], v[12:15], v[32:39], v1
s_waitcnt lgkmcnt(15)
buffer_store_dwordx4 v[216:219], v0, s[20:23], s32 offen offset:128 sc1
v_mfma_f32_16x16x32_bf16 v[64:67], a[192:195], v[32:35], v[64:67]
ds_read_b64_tr_b16 a[240:241], v10 offset:1024
ds_read_b64_tr_b16 a[242:243], v10 offset:5120
v_mfma_f32_16x16x32_bf16 v[64:67], a[196:199], v[36:39], v[64:67]
v_exp_f32 v21, v21
v_mfma_f32_16x16x32_bf16 v[68:71], a[200:203], v[36:39], v[68:71]
ds_read_b64_tr_b16 a[244:245], v10 offset:9216
v_cvt_pk_bf16_f32 v42, v20, v21
v_mfma_f32_16x16x32_bf16 v[68:71], a[204:207], v[32:35], v[68:71]
s_waitcnt lgkmcnt(15)
v_exp_f32 v22, v22
v_mfma_f32_16x16x32_bf16 v[72:75], a[208:211], v[32:35], v[72:75]
ds_read_b64_tr_b16 a[246:247], v10 offset:13312
ds_read_b64_tr_b16 a[248:249], v11 offset:9216
v_mfma_f32_16x16x32_bf16 v[72:75], a[212:215], v[36:39], v[72:75]
s_waitcnt lgkmcnt(13)
v_exp_f32 v23, v23
v_mfma_f32_16x16x32_bf16 v[76:79], a[216:219], v[36:39], v[76:79]
ds_read_b64_tr_b16 a[250:251], v11 offset:13312
v_cvt_pk_bf16_f32 v43, v22, v23
v_mfma_f32_16x16x32_bf16 v[76:79], a[220:223], v[32:35], v[76:79]
s_waitcnt lgkmcnt(10)
ds_read_b64_tr_b16 a[252:253], v11 offset:1024
ds_read_b64_tr_b16 a[254:255], v11 offset:5120
v_exp_f32 v24, v24
v_mfma_f32_16x16x32_bf16 v[80:83], a[224:227], v[32:35], v[80:83]
v_permlane16_swap_b32 v205, v207
v_mfma_f32_16x16x32_bf16 v[80:83], a[228:231], v[36:39], v[80:83]
s_waitcnt lgkmcnt(8)
v_exp_f32 v25, v25
v_mfma_f32_16x16x32_bf16 v[84:87], a[232:235], v[36:39], v[84:87]
v_cvt_pk_bf16_f32 v44, v24, v25
v_mfma_f32_16x16x32_bf16 v[84:87], a[236:239], v[32:35], v[84:87]
s_waitcnt lgkmcnt(4)
v_exp_f32 v26, v26
v_mfma_f32_16x16x32_bf16 v[88:91], a[240:243], v[32:35], v[88:91]
v_mfma_f32_16x16x32_bf16 v[88:91], a[244:247], v[36:39], v[88:91]
s_waitcnt lgkmcnt(0)
v_exp_f32 v27, v27
v_mfma_f32_16x16x32_bf16 v[92:95], a[248:251], v[36:39], v[92:95]
v_cvt_pk_bf16_f32 v45, v26, v27
v_mfma_f32_16x16x32_bf16 v[92:95], a[252:255], v[32:35], v[92:95]
v_exp_f32 v28, v28
v_mfma_f32_16x16x32_bf16 v[16:19], a[128:131], a[96:99], -4.0
s_barrier
v_mfma_f32_16x16x32_bf16 v[16:19], a[132:135], a[100:103], v[16:19]
s_add_u32 m0, s24, 0x0
v_exp_f32 v29, v29
v_mfma_f32_16x16x32_bf16 v[16:19], a[136:139], a[104:107], v[16:19]
buffer_store_dwordx4 v[220:223], v0, s[20:23], s32 offen offset:192 sc1
v_mfma_f32_16x16x32_bf16 v[16:19], a[140:143], a[108:111], v[16:19]
v_exp_f32 v30, v30
v_mfma_f32_16x16x32_bf16 v[20:23], a[144:147], a[108:111], -4.0
v_cvt_pk_bf16_f32 v46, v28, v29
v_mfma_f32_16x16x32_bf16 v[20:23], a[148:151], a[104:107], v[20:23]
v_exp_f32 v31, v31
v_mfma_f32_16x16x32_bf16 v[20:23], a[152:155], a[100:103], v[20:23]
v_cvt_pk_bf16_f32 v47, v30, v31
v_mfma_f32_16x16x32_bf16 v[20:23], a[156:159], a[96:99], v[20:23]
v_exp_f32 v16, v16
v_mfma_f32_16x16x32_bf16 v[24:27], a[160:163], a[96:99], -4.0
buffer_load_dwordx4 v2, s[16:19], s68 offen offset:0 lds
v_mfma_f32_16x16x32_bf16 v[24:27], a[164:167], a[100:103], v[24:27]
v_exp_f32 v17, v17
v_mfma_f32_16x16x32_bf16 v[24:27], a[168:171], a[104:107], v[24:27]
v_cvt_pk_bf16_f32 v32, v16, v17
v_mfma_f32_16x16x32_bf16 v[24:27], a[172:175], a[108:111], v[24:27]
v_exp_f32 v18, v18
v_mfma_f32_16x16x32_bf16 v[28:31], a[176:179], a[108:111], -4.0
v_mfma_f32_16x16x32_bf16 v[28:31], a[180:183], a[104:107], v[28:31]
v_exp_f32 v19, v19
v_mfma_f32_16x16x32_bf16 v[28:31], a[184:187], a[100:103], v[28:31]
v_cvt_pk_bf16_f32 v33, v18, v19
v_mfma_f32_16x16x32_bf16 v[28:31], a[188:191], a[96:99], v[28:31]
v_exp_f32 v20, v20
v_smfmac_f32_16x16x64_bf16 v[52:55], v[12:15], v[40:47], v1
v_mfma_f32_16x16x32_bf16 v[96:99], a[192:195], v[40:43], v[96:99]
buffer_load_dwordx4 v2, s[16:19], s68 offen offset:2048 lds
v_mfma_f32_16x16x32_bf16 v[96:99], a[196:199], v[44:47], v[96:99]
s_add_u32 m0, s24, 0x2000
v_exp_f32 v21, v21
v_mfma_f32_16x16x32_bf16 v[100:103], a[200:203], v[44:47], v[100:103]
v_cvt_pk_bf16_f32 v34, v20, v21
v_mfma_f32_16x16x32_bf16 v[100:103], a[204:207], v[40:43], v[100:103]
v_exp_f32 v22, v22
v_mfma_f32_16x16x32_bf16 v[104:107], a[208:211], v[40:43], v[104:107]
v_mfma_f32_16x16x32_bf16 v[104:107], a[212:215], v[44:47], v[104:107]
v_exp_f32 v23, v23
v_mfma_f32_16x16x32_bf16 v[108:111], a[216:219], v[44:47], v[108:111]
v_cvt_pk_bf16_f32 v35, v22, v23
v_mfma_f32_16x16x32_bf16 v[108:111], a[220:223], v[40:43], v[108:111]
v_exp_f32 v24, v24
v_mfma_f32_16x16x32_bf16 v[112:115], a[224:227], v[40:43], v[112:115]
buffer_store_dwordx4 v[224:227], v0, s[20:23], s33 offen offset:0 sc1
v_mfma_f32_16x16x32_bf16 v[112:115], a[228:231], v[44:47], v[112:115]
v_exp_f32 v25, v25
v_mfma_f32_16x16x32_bf16 v[116:119], a[232:235], v[44:47], v[116:119]
v_cvt_pk_bf16_f32 v36, v24, v25
v_mfma_f32_16x16x32_bf16 v[116:119], a[236:239], v[40:43], v[116:119]
v_exp_f32 v26, v26
v_mfma_f32_16x16x32_bf16 v[120:123], a[240:243], v[40:43], v[120:123]
v_mfma_f32_16x16x32_bf16 v[120:123], a[244:247], v[44:47], v[120:123]
v_exp_f32 v27, v27
v_mfma_f32_16x16x32_bf16 v[124:127], a[248:251], v[44:47], v[124:127]
v_cvt_pk_bf16_f32 v37, v26, v27
v_mfma_f32_16x16x32_bf16 v[124:127], a[252:255], v[40:43], v[124:127]
v_exp_f32 v28, v28
v_mfma_f32_16x16x32_bf16 v[16:19], a[128:131], a[112:115], -4.0
buffer_load_dwordx4 v2, s[16:19], s69 offen offset:0 lds
v_mfma_f32_16x16x32_bf16 v[16:19], a[132:135], a[116:119], v[16:19]
v_exp_f32 v29, v29
v_mfma_f32_16x16x32_bf16 v[16:19], a[136:139], a[120:123], v[16:19]
L_pg8:
s_cbranch_vccnz L_pg12
ds_read_b128 a[128:131], v4 offset:16384
v_mfma_f32_16x16x32_bf16 v[16:19], a[140:143], a[124:127], v[16:19]
v_exp_f32 v30, v30
v_mfma_f32_16x16x32_bf16 v[20:23], a[144:147], a[124:127], -4.0
ds_read_b128 a[132:135], v5 offset:16384
v_cvt_pk_bf16_f32 v38, v28, v29
v_mfma_f32_16x16x32_bf16 v[20:23], a[148:151], a[120:123], v[20:23]
v_exp_f32 v31, v31
v_mfma_f32_16x16x32_bf16 v[20:23], a[152:155], a[116:119], v[20:23]
buffer_load_dwordx4 v2, s[16:19], s69 offen offset:2048 lds
v_cvt_pk_bf16_f32 v39, v30, v31
v_mfma_f32_16x16x32_bf16 v[20:23], a[156:159], a[112:115], v[20:23]
v_exp_f32 v16, v16
v_mfma_f32_16x16x32_bf16 v[24:27], a[160:163], a[112:115], -4.0
ds_read_b128 a[136:139], v6 offset:16384
v_mfma_f32_16x16x32_bf16 v[24:27], a[164:167], a[116:119], v[24:27]
v_exp_f32 v17, v17
v_mfma_f32_16x16x32_bf16 v[24:27], a[168:171], a[120:123], v[24:27]
ds_read_b128 a[140:143], v7 offset:16384
v_cvt_pk_bf16_f32 v40, v16, v17
v_mfma_f32_16x16x32_bf16 v[24:27], a[172:175], a[124:127], v[24:27]
v_exp_f32 v18, v18
v_mfma_f32_16x16x32_bf16 v[28:31], a[176:179], a[124:127], -4.0
buffer_store_dwordx4 v[228:231], v0, s[20:23], s33 offen offset:64 sc1
v_mfma_f32_16x16x32_bf16 v[28:31], a[180:183], a[120:123], v[28:31]
v_exp_f32 v19, v19
v_mfma_f32_16x16x32_bf16 v[28:31], a[184:187], a[116:119], v[28:31]
ds_read_b128 a[144:147], v7 offset:20480
v_cvt_pk_bf16_f32 v41, v18, v19
v_mfma_f32_16x16x32_bf16 v[28:31], a[188:191], a[112:115], v[28:31]
v_exp_f32 v20, v20
v_smfmac_f32_16x16x64_bf16 v[56:59], v[12:15], v[32:39], v1
ds_read_b128 a[148:151], v6 offset:20480
v_mfma_f32_16x16x32_bf16 v[128:131], a[192:195], v[32:35], v[128:131]
ds_read_b128 a[152:155], v5 offset:20480
v_mfma_f32_16x16x32_bf16 v[128:131], a[196:199], v[36:39], v[128:131]
v_exp_f32 v21, v21
v_mfma_f32_16x16x32_bf16 v[132:135], a[200:203], v[36:39], v[132:135]
ds_read_b128 a[156:159], v4 offset:20480
v_cvt_pk_bf16_f32 v42, v20, v21
v_mfma_f32_16x16x32_bf16 v[132:135], a[204:207], v[32:35], v[132:135]
v_exp_f32 v22, v22
v_mfma_f32_16x16x32_bf16 v[136:139], a[208:211], v[32:35], v[136:139]
ds_read_b128 a[160:163], v4 offset:24576
v_mfma_f32_16x16x32_bf16 v[136:139], a[212:215], v[36:39], v[136:139]
v_exp_f32 v23, v23
v_mfma_f32_16x16x32_bf16 v[140:143], a[216:219], v[36:39], v[140:143]
ds_read_b128 a[164:167], v5 offset:24576
v_cvt_pk_bf16_f32 v43, v22, v23
v_mfma_f32_16x16x32_bf16 v[140:143], a[220:223], v[32:35], v[140:143]
v_exp_f32 v24, v24
v_mfma_f32_16x16x32_bf16 v[144:147], a[224:227], v[32:35], v[144:147]
ds_read_b128 a[168:171], v6 offset:24576
v_mfma_f32_16x16x32_bf16 v[144:147], a[228:231], v[36:39], v[144:147]
v_exp_f32 v25, v25
v_mfma_f32_16x16x32_bf16 v[148:151], a[232:235], v[36:39], v[148:151]
ds_read_b128 a[172:175], v7 offset:24576
v_cvt_pk_bf16_f32 v44, v24, v25
v_mfma_f32_16x16x32_bf16 v[148:151], a[236:239], v[32:35], v[148:151]
v_exp_f32 v26, v26
v_mfma_f32_16x16x32_bf16 v[152:155], a[240:243], v[32:35], v[152:155]
ds_read_b128 a[176:179], v7 offset:28672
v_mfma_f32_16x16x32_bf16 v[152:155], a[244:247], v[36:39], v[152:155]
v_exp_f32 v27, v27
v_mfma_f32_16x16x32_bf16 v[156:159], a[248:251], v[36:39], v[156:159]
ds_read_b128 a[180:183], v6 offset:28672
v_cvt_pk_bf16_f32 v45, v26, v27
v_mfma_f32_16x16x32_bf16 v[156:159], a[252:255], v[32:35], v[156:159]
s_waitcnt lgkmcnt(10)
v_exp_f32 v28, v28
v_mfma_f32_16x16x32_bf16 v[16:19], a[128:131], a[64:67], -4.0
ds_read_b128 a[184:187], v5 offset:28672
v_mfma_f32_16x16x32_bf16 v[16:19], a[132:135], a[68:71], v[16:19]
v_exp_f32 v29, v29
v_mfma_f32_16x16x32_bf16 v[16:19], a[136:139], a[72:75], v[16:19]
ds_read_b128 a[188:191], v4 offset:28672
v_mfma_f32_16x16x32_bf16 v[16:19], a[140:143], a[76:79], v[16:19]
s_waitcnt lgkmcnt(8)
v_exp_f32 v30, v30
v_mfma_f32_16x16x32_bf16 v[20:23], a[144:147], a[76:79], -4.0
v_cvt_pk_bf16_f32 v46, v28, v29
v_mfma_f32_16x16x32_bf16 v[20:23], a[148:151], a[72:75], v[20:23]
v_exp_f32 v31, v31
v_mfma_f32_16x16x32_bf16 v[20:23], a[152:155], a[68:71], v[20:23]
v_cvt_pk_bf16_f32 v47, v30, v31
v_mfma_f32_16x16x32_bf16 v[20:23], a[156:159], a[64:67], v[20:23]
s_waitcnt lgkmcnt(4)
v_exp_f32 v16, v16
v_mfma_f32_16x16x32_bf16 v[24:27], a[160:163], a[64:67], -4.0
buffer_store_dwordx4 v[232:235], v0, s[20:23], s33 offen offset:128 sc1
v_mfma_f32_16x16x32_bf16 v[24:27], a[164:167], a[68:71], v[24:27]
v_exp_f32 v17, v17
v_mfma_f32_16x16x32_bf16 v[24:27], a[168:171], a[72:75], v[24:27]
v_cvt_pk_bf16_f32 v32, v16, v17
v_mfma_f32_16x16x32_bf16 v[24:27], a[172:175], a[76:79], v[24:27]
s_waitcnt lgkmcnt(0)
v_exp_f32 v18, v18
v_mfma_f32_16x16x32_bf16 v[28:31], a[176:179], a[76:79], -4.0
v_mfma_f32_16x16x32_bf16 v[28:31], a[180:183], a[72:75], v[28:31]
v_exp_f32 v19, v19
v_mfma_f32_16x16x32_bf16 v[28:31], a[184:187], a[68:71], v[28:31]
v_cvt_pk_bf16_f32 v33, v18, v19
v_mfma_f32_16x16x32_bf16 v[28:31], a[188:191], a[64:67], v[28:31]
s_waitcnt vmcnt(11)
v_exp_f32 v20, v20
v_smfmac_f32_16x16x64_bf16 v[60:63], v[12:15], v[40:47], v1
s_barrier
v_mfma_f32_16x16x32_bf16 v[160:163], a[192:195], v[40:43], v[160:163]
ds_read_b64_tr_b16 a[192:193], v8 offset:16384
ds_read_b64_tr_b16 a[194:195], v8 offset:20480
v_mfma_f32_16x16x32_bf16 v[160:163], a[196:199], v[44:47], v[160:163]
v_exp_f32 v21, v21
v_mfma_f32_16x16x32_bf16 v[164:167], a[200:203], v[44:47], v[164:167]
ds_read_b64_tr_b16 a[196:197], v8 offset:24576
v_cvt_pk_bf16_f32 v34, v20, v21
v_mfma_f32_16x16x32_bf16 v[164:167], a[204:207], v[40:43], v[164:167]
v_exp_f32 v22, v22
v_mfma_f32_16x16x32_bf16 v[168:171], a[208:211], v[40:43], v[168:171]
ds_read_b64_tr_b16 a[198:199], v8 offset:28672
ds_read_b64_tr_b16 a[200:201], v9 offset:24576
v_mfma_f32_16x16x32_bf16 v[168:171], a[212:215], v[44:47], v[168:171]
v_exp_f32 v23, v23
v_mfma_f32_16x16x32_bf16 v[172:175], a[216:219], v[44:47], v[172:175]
ds_read_b64_tr_b16 a[202:203], v9 offset:28672
v_cvt_pk_bf16_f32 v35, v22, v23
v_mfma_f32_16x16x32_bf16 v[172:175], a[220:223], v[40:43], v[172:175]
v_exp_f32 v24, v24
v_mfma_f32_16x16x32_bf16 v[176:179], a[224:227], v[40:43], v[176:179]
ds_read_b64_tr_b16 a[204:205], v9 offset:16384
ds_read_b64_tr_b16 a[206:207], v9 offset:20480
v_mfma_f32_16x16x32_bf16 v[176:179], a[228:231], v[44:47], v[176:179]
v_exp_f32 v25, v25
v_mfma_f32_16x16x32_bf16 v[180:183], a[232:235], v[44:47], v[180:183]
ds_read_b64_tr_b16 a[208:209], v10 offset:16384
v_cvt_pk_bf16_f32 v36, v24, v25
v_mfma_f32_16x16x32_bf16 v[180:183], a[236:239], v[40:43], v[180:183]
v_exp_f32 v26, v26
v_mfma_f32_16x16x32_bf16 v[184:187], a[240:243], v[40:43], v[184:187]
buffer_store_dwordx4 v[236:239], v0, s[20:23], s33 offen offset:192 sc1
v_mfma_f32_16x16x32_bf16 v[184:187], a[244:247], v[44:47], v[184:187]
v_exp_f32 v27, v27
v_mfma_f32_16x16x32_bf16 v[188:191], a[248:251], v[44:47], v[188:191]
ds_read_b64_tr_b16 a[210:211], v10 offset:20480
v_cvt_pk_bf16_f32 v37, v26, v27
v_mfma_f32_16x16x32_bf16 v[188:191], a[252:255], v[40:43], v[188:191]
v_exp_f32 v28, v28
v_mfma_f32_16x16x32_bf16 v[16:19], a[128:131], a[80:83], -4.0
ds_read_b64_tr_b16 a[212:213], v10 offset:24576
ds_read_b64_tr_b16 a[214:215], v10 offset:28672
v_mfma_f32_16x16x32_bf16 v[16:19], a[132:135], a[84:87], v[16:19]
v_exp_f32 v29, v29
v_mfma_f32_16x16x32_bf16 v[16:19], a[136:139], a[88:91], v[16:19]
ds_read_b64_tr_b16 a[216:217], v11 offset:24576
ds_read_b64_tr_b16 a[218:219], v11 offset:28672
v_mfma_f32_16x16x32_bf16 v[16:19], a[140:143], a[92:95], v[16:19]
v_exp_f32 v30, v30
v_mfma_f32_16x16x32_bf16 v[20:23], a[144:147], a[92:95], -4.0
ds_read_b64_tr_b16 a[220:221], v11 offset:16384
v_cvt_pk_bf16_f32 v38, v28, v29
v_mfma_f32_16x16x32_bf16 v[20:23], a[148:151], a[88:91], v[20:23]
v_exp_f32 v31, v31
v_mfma_f32_16x16x32_bf16 v[20:23], a[152:155], a[84:87], v[20:23]
ds_read_b64_tr_b16 a[222:223], v11 offset:20480
v_cvt_pk_bf16_f32 v39, v30, v31
v_mfma_f32_16x16x32_bf16 v[20:23], a[156:159], a[80:83], v[20:23]
v_exp_f32 v16, v16
v_mfma_f32_16x16x32_bf16 v[24:27], a[160:163], a[80:83], -4.0
ds_read_b64_tr_b16 a[224:225], v8 offset:17408
ds_read_b64_tr_b16 a[226:227], v8 offset:21504
v_mfma_f32_16x16x32_bf16 v[24:27], a[164:167], a[84:87], v[24:27]
v_exp_f32 v17, v17
v_mfma_f32_16x16x32_bf16 v[24:27], a[168:171], a[88:91], v[24:27]
ds_read_b64_tr_b16 a[228:229], v8 offset:25600
v_cvt_pk_bf16_f32 v40, v16, v17
v_mfma_f32_16x16x32_bf16 v[24:27], a[172:175], a[92:95], v[24:27]
v_exp_f32 v18, v18
v_mfma_f32_16x16x32_bf16 v[28:31], a[176:179], a[92:95], -4.0
ds_read_b64_tr_b16 a[230:231], v8 offset:29696
ds_read_b64_tr_b16 a[232:233], v9 offset:25600
v_mfma_f32_16x16x32_bf16 v[28:31], a[180:183], a[88:91], v[28:31]
v_exp_f32 v19, v19
v_mfma_f32_16x16x32_bf16 v[28:31], a[184:187], a[84:87], v[28:31]
ds_read_b64_tr_b16 a[234:235], v9 offset:29696
v_cvt_pk_bf16_f32 v41, v18, v19
v_mfma_f32_16x16x32_bf16 v[28:31], a[188:191], a[80:83], v[28:31]
v_exp_f32 v20, v20
v_smfmac_f32_16x16x64_bf16 v[48:51], v[12:15], v[32:39], v1
s_waitcnt lgkmcnt(15)
ds_read_b64_tr_b16 a[236:237], v9 offset:17408
v_mfma_f32_16x16x32_bf16 v[64:67], a[192:195], v[32:35], v[64:67]
ds_read_b64_tr_b16 a[238:239], v9 offset:21504
ds_read_b64_tr_b16 a[240:241], v10 offset:17408
v_mfma_f32_16x16x32_bf16 v[64:67], a[196:199], v[36:39], v[64:67]
v_exp_f32 v21, v21
v_mfma_f32_16x16x32_bf16 v[68:71], a[200:203], v[36:39], v[68:71]
s_waitcnt lgkmcnt(15)
ds_read_b64_tr_b16 a[242:243], v10 offset:21504
v_cvt_pk_bf16_f32 v42, v20, v21
v_mfma_f32_16x16x32_bf16 v[68:71], a[204:207], v[32:35], v[68:71]
v_exp_f32 v22, v22
v_mfma_f32_16x16x32_bf16 v[72:75], a[208:211], v[32:35], v[72:75]
s_waitcnt lgkmcnt(14)
ds_read_b64_tr_b16 a[244:245], v10 offset:25600
ds_read_b64_tr_b16 a[246:247], v10 offset:29696
v_mfma_f32_16x16x32_bf16 v[72:75], a[212:215], v[36:39], v[72:75]
s_waitcnt lgkmcnt(12)
v_exp_f32 v23, v23
v_mfma_f32_16x16x32_bf16 v[76:79], a[216:219], v[36:39], v[76:79]
ds_read_b64_tr_b16 a[248:249], v11 offset:25600
ds_read_b64_tr_b16 a[250:251], v11 offset:29696
v_cvt_pk_bf16_f32 v43, v22, v23
v_mfma_f32_16x16x32_bf16 v[76:79], a[220:223], v[32:35], v[76:79]
s_waitcnt lgkmcnt(10)
ds_read_b64_tr_b16 a[252:253], v11 offset:17408
ds_read_b64_tr_b16 a[254:255], v11 offset:21504
v_exp_f32 v24, v24
v_mfma_f32_16x16x32_bf16 v[80:83], a[224:227], v[32:35], v[80:83]
buffer_store_dwordx4 v[240:243], v0, s[20:23], s34 offen offset:0 sc1
v_mfma_f32_16x16x32_bf16 v[80:83], a[228:231], v[36:39], v[80:83]
s_waitcnt lgkmcnt(8)
v_exp_f32 v25, v25
v_mfma_f32_16x16x32_bf16 v[84:87], a[232:235], v[36:39], v[84:87]
v_cvt_pk_bf16_f32 v44, v24, v25
v_mfma_f32_16x16x32_bf16 v[84:87], a[236:239], v[32:35], v[84:87]
s_waitcnt lgkmcnt(4)
v_exp_f32 v26, v26
v_mfma_f32_16x16x32_bf16 v[88:91], a[240:243], v[32:35], v[88:91]
v_mfma_f32_16x16x32_bf16 v[88:91], a[244:247], v[36:39], v[88:91]
s_waitcnt lgkmcnt(0)
v_exp_f32 v27, v27
v_mfma_f32_16x16x32_bf16 v[92:95], a[248:251], v[36:39], v[92:95]
v_cvt_pk_bf16_f32 v45, v26, v27
v_mfma_f32_16x16x32_bf16 v[92:95], a[252:255], v[32:35], v[92:95]
v_exp_f32 v28, v28
v_mfma_f32_16x16x32_bf16 v[16:19], a[128:131], a[96:99], -4.0
v_mfma_f32_16x16x32_bf16 v[16:19], a[132:135], a[100:103], v[16:19]
v_exp_f32 v29, v29
v_mfma_f32_16x16x32_bf16 v[16:19], a[136:139], a[104:107], v[16:19]
v_mfma_f32_16x16x32_bf16 v[16:19], a[140:143], a[108:111], v[16:19]
v_exp_f32 v30, v30
v_mfma_f32_16x16x32_bf16 v[20:23], a[144:147], a[108:111], -4.0
v_cvt_pk_bf16_f32 v46, v28, v29
v_mfma_f32_16x16x32_bf16 v[20:23], a[148:151], a[104:107], v[20:23]
v_exp_f32 v31, v31
v_mfma_f32_16x16x32_bf16 v[20:23], a[152:155], a[100:103], v[20:23]
v_cvt_pk_bf16_f32 v47, v30, v31
v_mfma_f32_16x16x32_bf16 v[20:23], a[156:159], a[96:99], v[20:23]
v_exp_f32 v16, v16
v_mfma_f32_16x16x32_bf16 v[24:27], a[160:163], a[96:99], -4.0
v_mfma_f32_16x16x32_bf16 v[24:27], a[164:167], a[100:103], v[24:27]
v_exp_f32 v17, v17
v_mfma_f32_16x16x32_bf16 v[24:27], a[168:171], a[104:107], v[24:27]
v_cvt_pk_bf16_f32 v32, v16, v17
v_mfma_f32_16x16x32_bf16 v[24:27], a[172:175], a[108:111], v[24:27]
v_exp_f32 v18, v18
v_mfma_f32_16x16x32_bf16 v[28:31], a[176:179], a[108:111], -4.0
buffer_store_dwordx4 v[244:247], v0, s[20:23], s34 offen offset:64 sc1
v_mfma_f32_16x16x32_bf16 v[28:31], a[180:183], a[104:107], v[28:31]
v_exp_f32 v19, v19
v_mfma_f32_16x16x32_bf16 v[28:31], a[184:187], a[100:103], v[28:31]
v_cvt_pk_bf16_f32 v33, v18, v19
v_mfma_f32_16x16x32_bf16 v[28:31], a[188:191], a[96:99], v[28:31]
v_exp_f32 v20, v20
v_smfmac_f32_16x16x64_bf16 v[52:55], v[12:15], v[40:47], v1
v_mfma_f32_16x16x32_bf16 v[96:99], a[192:195], v[40:43], v[96:99]
v_mfma_f32_16x16x32_bf16 v[96:99], a[196:199], v[44:47], v[96:99]
v_exp_f32 v21, v21
v_mfma_f32_16x16x32_bf16 v[100:103], a[200:203], v[44:47], v[100:103]
v_cvt_pk_bf16_f32 v34, v20, v21
v_mfma_f32_16x16x32_bf16 v[100:103], a[204:207], v[40:43], v[100:103]
v_exp_f32 v22, v22
v_mfma_f32_16x16x32_bf16 v[104:107], a[208:211], v[40:43], v[104:107]
v_mfma_f32_16x16x32_bf16 v[104:107], a[212:215], v[44:47], v[104:107]
v_exp_f32 v23, v23
v_mfma_f32_16x16x32_bf16 v[108:111], a[216:219], v[44:47], v[108:111]
v_cvt_pk_bf16_f32 v35, v22, v23
v_mfma_f32_16x16x32_bf16 v[108:111], a[220:223], v[40:43], v[108:111]
v_exp_f32 v24, v24
v_mfma_f32_16x16x32_bf16 v[112:115], a[224:227], v[40:43], v[112:115]
v_mfma_f32_16x16x32_bf16 v[112:115], a[228:231], v[44:47], v[112:115]
v_exp_f32 v25, v25
v_mfma_f32_16x16x32_bf16 v[116:119], a[232:235], v[44:47], v[116:119]
v_cvt_pk_bf16_f32 v36, v24, v25
v_mfma_f32_16x16x32_bf16 v[116:119], a[236:239], v[40:43], v[116:119]
v_exp_f32 v26, v26
v_mfma_f32_16x16x32_bf16 v[120:123], a[240:243], v[40:43], v[120:123]
buffer_store_dwordx4 v[248:251], v0, s[20:23], s34 offen offset:128 sc1
v_mfma_f32_16x16x32_bf16 v[120:123], a[244:247], v[44:47], v[120:123]
v_exp_f32 v27, v27
v_mfma_f32_16x16x32_bf16 v[124:127], a[248:251], v[44:47], v[124:127]
v_cvt_pk_bf16_f32 v37, v26, v27
v_mfma_f32_16x16x32_bf16 v[124:127], a[252:255], v[40:43], v[124:127]
v_exp_f32 v28, v28
v_mfma_f32_16x16x32_bf16 v[16:19], a[128:131], a[112:115], -4.0
ds_read_b128 a[128:131], v4 offset:0
v_mfma_f32_16x16x32_bf16 v[16:19], a[132:135], a[116:119], v[16:19]
v_exp_f32 v29, v29
v_mfma_f32_16x16x32_bf16 v[16:19], a[136:139], a[120:123], v[16:19]
ds_read_b128 a[132:135], v5 offset:0
v_mfma_f32_16x16x32_bf16 v[16:19], a[140:143], a[124:127], v[16:19]
v_exp_f32 v30, v30
v_mfma_f32_16x16x32_bf16 v[20:23], a[144:147], a[124:127], -4.0
ds_read_b128 a[136:139], v6 offset:0
v_cvt_pk_bf16_f32 v38, v28, v29
v_mfma_f32_16x16x32_bf16 v[20:23], a[148:151], a[120:123], v[20:23]
v_exp_f32 v31, v31
v_mfma_f32_16x16x32_bf16 v[20:23], a[152:155], a[116:119], v[20:23]
ds_read_b128 a[140:143], v7 offset:0
v_cvt_pk_bf16_f32 v39, v30, v31
v_mfma_f32_16x16x32_bf16 v[20:23], a[156:159], a[112:115], v[20:23]
v_exp_f32 v16, v16
v_mfma_f32_16x16x32_bf16 v[24:27], a[160:163], a[112:115], -4.0
ds_read_b128 a[144:147], v7 offset:4096
v_mfma_f32_16x16x32_bf16 v[24:27], a[164:167], a[116:119], v[24:27]
v_exp_f32 v17, v17
v_mfma_f32_16x16x32_bf16 v[24:27], a[168:171], a[120:123], v[24:27]
ds_read_b128 a[148:151], v6 offset:4096
v_cvt_pk_bf16_f32 v40, v16, v17
v_mfma_f32_16x16x32_bf16 v[24:27], a[172:175], a[124:127], v[24:27]
v_exp_f32 v18, v18
v_mfma_f32_16x16x32_bf16 v[28:31], a[176:179], a[124:127], -4.0
ds_read_b128 a[152:155], v5 offset:4096
v_mfma_f32_16x16x32_bf16 v[28:31], a[180:183], a[120:123], v[28:31]
v_exp_f32 v19, v19
v_mfma_f32_16x16x32_bf16 v[28:31], a[184:187], a[116:119], v[28:31]
ds_read_b128 a[156:159], v4 offset:4096
v_cvt_pk_bf16_f32 v41, v18, v19
v_mfma_f32_16x16x32_bf16 v[28:31], a[188:191], a[112:115], v[28:31]
v_exp_f32 v20, v20
v_smfmac_f32_16x16x64_bf16 v[56:59], v[12:15], v[32:39], v1
ds_read_b128 a[160:163], v4 offset:8192
v_mfma_f32_16x16x32_bf16 v[128:131], a[192:195], v[32:35], v[128:131]
ds_read_b128 a[164:167], v5 offset:8192
v_mfma_f32_16x16x32_bf16 v[128:131], a[196:199], v[36:39], v[128:131]
v_exp_f32 v21, v21
v_mfma_f32_16x16x32_bf16 v[132:135], a[200:203], v[36:39], v[132:135]
ds_read_b128 a[168:171], v6 offset:8192
v_cvt_pk_bf16_f32 v42, v20, v21
v_mfma_f32_16x16x32_bf16 v[132:135], a[204:207], v[32:35], v[132:135]
v_exp_f32 v22, v22
v_mfma_f32_16x16x32_bf16 v[136:139], a[208:211], v[32:35], v[136:139]
ds_read_b128 a[172:175], v7 offset:8192
v_mfma_f32_16x16x32_bf16 v[136:139], a[212:215], v[36:39], v[136:139]
v_exp_f32 v23, v23
v_mfma_f32_16x16x32_bf16 v[140:143], a[216:219], v[36:39], v[140:143]
ds_read_b128 a[176:179], v7 offset:12288
v_cvt_pk_bf16_f32 v43, v22, v23
v_mfma_f32_16x16x32_bf16 v[140:143], a[220:223], v[32:35], v[140:143]
v_exp_f32 v24, v24
v_mfma_f32_16x16x32_bf16 v[144:147], a[224:227], v[32:35], v[144:147]
ds_read_b128 a[180:183], v6 offset:12288
v_mfma_f32_16x16x32_bf16 v[144:147], a[228:231], v[36:39], v[144:147]
v_exp_f32 v25, v25
v_mfma_f32_16x16x32_bf16 v[148:151], a[232:235], v[36:39], v[148:151]
ds_read_b128 a[184:187], v5 offset:12288
v_cvt_pk_bf16_f32 v44, v24, v25
v_mfma_f32_16x16x32_bf16 v[148:151], a[236:239], v[32:35], v[148:151]
v_exp_f32 v26, v26
v_mfma_f32_16x16x32_bf16 v[152:155], a[240:243], v[32:35], v[152:155]
ds_read_b128 a[188:191], v4 offset:12288
v_mfma_f32_16x16x32_bf16 v[152:155], a[244:247], v[36:39], v[152:155]
v_exp_f32 v27, v27
v_mfma_f32_16x16x32_bf16 v[156:159], a[248:251], v[36:39], v[156:159]
v_cvt_pk_bf16_f32 v45, v26, v27
v_mfma_f32_16x16x32_bf16 v[156:159], a[252:255], v[32:35], v[156:159]
s_waitcnt lgkmcnt(12)
v_exp_f32 v28, v28
v_mfma_f32_16x16x32_bf16 v[16:19], a[128:131], a[64:67], -4.0
buffer_store_dwordx4 v[252:255], v0, s[20:23], s34 offen offset:192 sc1
v_mfma_f32_16x16x32_bf16 v[16:19], a[132:135], a[68:71], v[16:19]
v_exp_f32 v29, v29
v_mfma_f32_16x16x32_bf16 v[16:19], a[136:139], a[72:75], v[16:19]
v_mfma_f32_16x16x32_bf16 v[16:19], a[140:143], a[76:79], v[16:19]
s_waitcnt lgkmcnt(8)
v_exp_f32 v30, v30
v_mfma_f32_16x16x32_bf16 v[20:23], a[144:147], a[76:79], -4.0
v_cvt_pk_bf16_f32 v46, v28, v29
v_mfma_f32_16x16x32_bf16 v[20:23], a[148:151], a[72:75], v[20:23]
v_exp_f32 v31, v31
v_mfma_f32_16x16x32_bf16 v[20:23], a[152:155], a[68:71], v[20:23]
v_cvt_pk_bf16_f32 v47, v30, v31
v_mfma_f32_16x16x32_bf16 v[20:23], a[156:159], a[64:67], v[20:23]
s_waitcnt lgkmcnt(4)
v_exp_f32 v16, v16
v_mfma_f32_16x16x32_bf16 v[24:27], a[160:163], a[64:67], -4.0
v_mfma_f32_16x16x32_bf16 v[24:27], a[164:167], a[68:71], v[24:27]
v_exp_f32 v17, v17
v_mfma_f32_16x16x32_bf16 v[24:27], a[168:171], a[72:75], v[24:27]
v_cvt_pk_bf16_f32 v32, v16, v17
v_mfma_f32_16x16x32_bf16 v[24:27], a[172:175], a[76:79], v[24:27]
s_waitcnt lgkmcnt(0)
v_exp_f32 v18, v18
v_mfma_f32_16x16x32_bf16 v[28:31], a[176:179], a[76:79], -4.0
v_mfma_f32_16x16x32_bf16 v[28:31], a[180:183], a[72:75], v[28:31]
v_exp_f32 v19, v19
v_mfma_f32_16x16x32_bf16 v[28:31], a[184:187], a[68:71], v[28:31]
v_cvt_pk_bf16_f32 v33, v18, v19
v_mfma_f32_16x16x32_bf16 v[28:31], a[188:191], a[64:67], v[28:31]
s_waitcnt vmcnt(7)
v_exp_f32 v20, v20
v_smfmac_f32_16x16x64_bf16 v[60:63], v[12:15], v[40:47], v1
s_barrier
v_mfma_f32_16x16x32_bf16 v[160:163], a[192:195], v[40:43], v[160:163]
buffer_store_dwordx4 v[192:195], v0, s[20:23], s35 offen offset:0 sc1
v_mfma_f32_16x16x32_bf16 v[160:163], a[196:199], v[44:47], v[160:163]
v_exp_f32 v21, v21
v_mfma_f32_16x16x32_bf16 v[164:167], a[200:203], v[44:47], v[164:167]
ds_read_b64_tr_b16 a[192:193], v8 offset:0
v_cvt_pk_bf16_f32 v34, v20, v21
v_mfma_f32_16x16x32_bf16 v[164:167], a[204:207], v[40:43], v[164:167]
v_exp_f32 v22, v22
v_mfma_f32_16x16x32_bf16 v[168:171], a[208:211], v[40:43], v[168:171]
ds_read_b64_tr_b16 a[194:195], v8 offset:4096
ds_read_b64_tr_b16 a[196:197], v8 offset:8192
v_mfma_f32_16x16x32_bf16 v[168:171], a[212:215], v[44:47], v[168:171]
v_exp_f32 v23, v23
v_mfma_f32_16x16x32_bf16 v[172:175], a[216:219], v[44:47], v[172:175]
ds_read_b64_tr_b16 a[198:199], v8 offset:12288
v_cvt_pk_bf16_f32 v35, v22, v23
v_mfma_f32_16x16x32_bf16 v[172:175], a[220:223], v[40:43], v[172:175]
v_exp_f32 v24, v24
v_mfma_f32_16x16x32_bf16 v[176:179], a[224:227], v[40:43], v[176:179]
ds_read_b64_tr_b16 a[200:201], v9 offset:8192
ds_read_b64_tr_b16 a[202:203], v9 offset:12288
v_mfma_f32_16x16x32_bf16 v[176:179], a[228:231], v[44:47], v[176:179]
v_exp_f32 v25, v25
v_mfma_f32_16x16x32_bf16 v[180:183], a[232:235], v[44:47], v[180:183]
ds_read_b64_tr_b16 a[204:205], v9 offset:0
v_cvt_pk_bf16_f32 v36, v24, v25
v_mfma_f32_16x16x32_bf16 v[180:183], a[236:239], v[40:43], v[180:183]
v_exp_f32 v26, v26
v_mfma_f32_16x16x32_bf16 v[184:187], a[240:243], v[40:43], v[184:187]
ds_read_b64_tr_b16 a[206:207], v9 offset:4096
ds_read_b64_tr_b16 a[208:209], v10 offset:0
v_mfma_f32_16x16x32_bf16 v[184:187], a[244:247], v[44:47], v[184:187]
v_exp_f32 v27, v27
v_mfma_f32_16x16x32_bf16 v[188:191], a[248:251], v[44:47], v[188:191]
ds_read_b64_tr_b16 a[210:211], v10 offset:4096
v_cvt_pk_bf16_f32 v37, v26, v27
v_mfma_f32_16x16x32_bf16 v[188:191], a[252:255], v[40:43], v[188:191]
v_exp_f32 v28, v28
v_mfma_f32_16x16x32_bf16 v[16:19], a[128:131], a[80:83], -4.0
ds_read_b64_tr_b16 a[212:213], v10 offset:8192
ds_read_b64_tr_b16 a[214:215], v10 offset:12288
v_mfma_f32_16x16x32_bf16 v[16:19], a[132:135], a[84:87], v[16:19]
v_exp_f32 v29, v29
v_mfma_f32_16x16x32_bf16 v[16:19], a[136:139], a[88:91], v[16:19]
ds_read_b64_tr_b16 a[216:217], v11 offset:8192
ds_read_b64_tr_b16 a[218:219], v11 offset:12288
v_mfma_f32_16x16x32_bf16 v[16:19], a[140:143], a[92:95], v[16:19]
v_exp_f32 v30, v30
v_mfma_f32_16x16x32_bf16 v[20:23], a[144:147], a[92:95], -4.0
ds_read_b64_tr_b16 a[220:221], v11 offset:0
v_cvt_pk_bf16_f32 v38, v28, v29
v_mfma_f32_16x16x32_bf16 v[20:23], a[148:151], a[88:91], v[20:23]
v_exp_f32 v31, v31
v_mfma_f32_16x16x32_bf16 v[20:23], a[152:155], a[84:87], v[20:23]
ds_read_b64_tr_b16 a[222:223], v11 offset:4096
v_cvt_pk_bf16_f32 v39, v30, v31
v_mfma_f32_16x16x32_bf16 v[20:23], a[156:159], a[80:83], v[20:23]
v_exp_f32 v16, v16
v_mfma_f32_16x16x32_bf16 v[24:27], a[160:163], a[80:83], -4.0
ds_read_b64_tr_b16 a[224:225], v8 offset:1024
ds_read_b64_tr_b16 a[226:227], v8 offset:5120
v_mfma_f32_16x16x32_bf16 v[24:27], a[164:167], a[84:87], v[24:27]
v_exp_f32 v17, v17
v_mfma_f32_16x16x32_bf16 v[24:27], a[168:171], a[88:91], v[24:27]
ds_read_b64_tr_b16 a[228:229], v8 offset:9216
v_cvt_pk_bf16_f32 v40, v16, v17
v_mfma_f32_16x16x32_bf16 v[24:27], a[172:175], a[92:95], v[24:27]
v_exp_f32 v18, v18
v_mfma_f32_16x16x32_bf16 v[28:31], a[176:179], a[92:95], -4.0
ds_read_b64_tr_b16 a[230:231], v8 offset:13312
ds_read_b64_tr_b16 a[232:233], v9 offset:9216
v_mfma_f32_16x16x32_bf16 v[28:31], a[180:183], a[88:91], v[28:31]
v_exp_f32 v19, v19
v_mfma_f32_16x16x32_bf16 v[28:31], a[184:187], a[84:87], v[28:31]
ds_read_b64_tr_b16 a[234:235], v9 offset:13312
v_cvt_pk_bf16_f32 v41, v18, v19
v_mfma_f32_16x16x32_bf16 v[28:31], a[188:191], a[80:83], v[28:31]
v_exp_f32 v20, v20
v_smfmac_f32_16x16x64_bf16 v[48:51], v[12:15], v[32:39], v1
s_waitcnt lgkmcnt(15)
ds_read_b64_tr_b16 a[236:237], v9 offset:1024
v_mfma_f32_16x16x32_bf16 v[64:67], a[192:195], v[32:35], v[64:67]
ds_read_b64_tr_b16 a[238:239], v9 offset:5120
ds_read_b64_tr_b16 a[240:241], v10 offset:1024
v_mfma_f32_16x16x32_bf16 v[64:67], a[196:199], v[36:39], v[64:67]
v_exp_f32 v21, v21
v_mfma_f32_16x16x32_bf16 v[68:71], a[200:203], v[36:39], v[68:71]
s_waitcnt lgkmcnt(15)
ds_read_b64_tr_b16 a[242:243], v10 offset:5120
v_cvt_pk_bf16_f32 v42, v20, v21
v_mfma_f32_16x16x32_bf16 v[68:71], a[204:207], v[32:35], v[68:71]
v_exp_f32 v22, v22
v_mfma_f32_16x16x32_bf16 v[72:75], a[208:211], v[32:35], v[72:75]
s_waitcnt lgkmcnt(14)
ds_read_b64_tr_b16 a[244:245], v10 offset:9216
ds_read_b64_tr_b16 a[246:247], v10 offset:13312
v_mfma_f32_16x16x32_bf16 v[72:75], a[212:215], v[36:39], v[72:75]
s_waitcnt lgkmcnt(12)
v_exp_f32 v23, v23
v_mfma_f32_16x16x32_bf16 v[76:79], a[216:219], v[36:39], v[76:79]
ds_read_b64_tr_b16 a[248:249], v11 offset:9216
ds_read_b64_tr_b16 a[250:251], v11 offset:13312
v_cvt_pk_bf16_f32 v43, v22, v23
v_mfma_f32_16x16x32_bf16 v[76:79], a[220:223], v[32:35], v[76:79]
s_waitcnt lgkmcnt(10)
ds_read_b64_tr_b16 a[252:253], v11 offset:1024
ds_read_b64_tr_b16 a[254:255], v11 offset:5120
v_exp_f32 v24, v24
v_mfma_f32_16x16x32_bf16 v[80:83], a[224:227], v[32:35], v[80:83]
buffer_store_dwordx4 v[196:199], v0, s[20:23], s35 offen offset:64 sc1
v_mfma_f32_16x16x32_bf16 v[80:83], a[228:231], v[36:39], v[80:83]
s_waitcnt lgkmcnt(8)
v_exp_f32 v25, v25
v_mfma_f32_16x16x32_bf16 v[84:87], a[232:235], v[36:39], v[84:87]
v_cvt_pk_bf16_f32 v44, v24, v25
v_add_f32 v51, v48, v49
v_mfma_f32_16x16x32_bf16 v[84:87], a[236:239], v[32:35], v[84:87]
s_waitcnt lgkmcnt(4)
v_exp_f32 v26, v26
v_mfma_f32_16x16x32_bf16 v[88:91], a[240:243], v[32:35], v[88:91]
v_rcp_f32 v50, v51
v_mfma_f32_16x16x32_bf16 v[88:91], a[244:247], v[36:39], v[88:91]
s_waitcnt lgkmcnt(0)
v_exp_f32 v27, v27
v_mfma_f32_16x16x32_bf16 v[92:95], a[248:251], v[36:39], v[92:95]
v_cvt_pk_bf16_f32 v45, v26, v27
v_subrev_u32 v51, 0x2f800000, v51
v_mfma_f32_16x16x32_bf16 v[92:95], a[252:255], v[32:35], v[92:95]
v_exp_f32 v28, v28
v_mfma_f32_16x16x32_bf16 v[16:19], a[128:131], a[96:99], -4.0
s_barrier
v_mfma_f32_16x16x32_bf16 v[16:19], a[132:135], a[100:103], v[16:19]
s_add_u32 m0, s24, 0x0
v_exp_f32 v29, v29
v_mfma_f32_16x16x32_bf16 v[16:19], a[136:139], a[104:107], v[16:19]
buffer_load_dwordx4 v2, s[16:19], s72 offen offset:0 lds
v_mfma_f32_16x16x32_bf16 v[16:19], a[140:143], a[108:111], v[16:19]
v_exp_f32 v30, v30
v_pk_mul_f32 v[64:65], v[64:65], v[50:51] op_sel_hi:[1,0]
v_pk_mul_f32 v[66:67], v[66:67], v[50:51] op_sel_hi:[1,0]
v_pk_mul_f32 v[68:69], v[68:69], v[50:51] op_sel_hi:[1,0]
v_pk_mul_f32 v[70:71], v[70:71], v[50:51] op_sel_hi:[1,0]
v_pk_mul_f32 v[72:73], v[72:73], v[50:51] op_sel_hi:[1,0]
v_pk_mul_f32 v[74:75], v[74:75], v[50:51] op_sel_hi:[1,0]
v_pk_mul_f32 v[76:77], v[76:77], v[50:51] op_sel_hi:[1,0]
v_pk_mul_f32 v[78:79], v[78:79], v[50:51] op_sel_hi:[1,0]
v_pk_mul_f32 v[80:81], v[80:81], v[50:51] op_sel_hi:[1,0]
v_pk_mul_f32 v[82:83], v[82:83], v[50:51] op_sel_hi:[1,0]
v_pk_mul_f32 v[84:85], v[84:85], v[50:51] op_sel_hi:[1,0]
v_pk_mul_f32 v[86:87], v[86:87], v[50:51] op_sel_hi:[1,0]
v_pk_mul_f32 v[88:89], v[88:89], v[50:51] op_sel_hi:[1,0]
v_pk_mul_f32 v[90:91], v[90:91], v[50:51] op_sel_hi:[1,0]
v_pk_mul_f32 v[92:93], v[92:93], v[50:51] op_sel_hi:[1,0]
v_pk_mul_f32 v[94:95], v[94:95], v[50:51] op_sel_hi:[1,0]
v_mfma_f32_16x16x32_bf16 v[20:23], a[144:147], a[108:111], -4.0
v_cvt_pk_bf16_f32 v46, v28, v29
v_max_u32 v3, v3, v51
v_mfma_f32_16x16x32_bf16 v[20:23], a[148:151], a[104:107], v[20:23]
v_exp_f32 v31, v31
v_mfma_f32_16x16x32_bf16 v[20:23], a[152:155], a[100:103], v[20:23]
v_cvt_pk_bf16_f32 v47, v30, v31
v_mov_b32 v48, 0
v_mfma_f32_16x16x32_bf16 v[20:23], a[156:159], a[96:99], v[20:23]
v_exp_f32 v16, v16
v_mfma_f32_16x16x32_bf16 v[24:27], a[160:163], a[96:99], -4.0
buffer_load_dwordx4 v2, s[16:19], s72 offen offset:2048 lds
v_mfma_f32_16x16x32_bf16 v[24:27], a[164:167], a[100:103], v[24:27]
s_add_u32 m0, s24, 0x2000
v_exp_f32 v17, v17
v_mfma_f32_16x16x32_bf16 v[24:27], a[168:171], a[104:107], v[24:27]
v_cvt_pk_bf16_f32 v32, v16, v17
v_mov_b32 v49, 0
v_mfma_f32_16x16x32_bf16 v[24:27], a[172:175], a[108:111], v[24:27]
v_exp_f32 v18, v18
v_mfma_f32_16x16x32_bf16 v[28:31], a[176:179], a[108:111], -4.0
v_mov_b32 v51, 0
v_cvt_pk_bf16_f32 v208, v64, v65
v_mfma_f32_16x16x32_bf16 v[28:31], a[180:183], a[104:107], v[28:31]
v_exp_f32 v19, v19
v_mfma_f32_16x16x32_bf16 v[28:31], a[184:187], a[100:103], v[28:31]
buffer_store_dwordx4 v[200:203], v0, s[20:23], s35 offen offset:128 sc1
v_cvt_pk_bf16_f32 v33, v18, v19
v_mfma_f32_16x16x32_bf16 v[28:31], a[188:191], a[96:99], v[28:31]
v_exp_f32 v20, v20
v_smfmac_f32_16x16x64_bf16 v[52:55], v[12:15], v[40:47], v1
v_cvt_pk_bf16_f32 v209, v66, v67
v_mfma_f32_16x16x32_bf16 v[96:99], a[192:195], v[40:43], v[96:99]
L_pg9:
s_cbranch_vccnz L_pg13
v_cvt_pk_bf16_f32 v210, v68, v69
v_cvt_pk_bf16_f32 v211, v70, v71
v_mfma_f32_16x16x32_bf16 v[96:99], a[196:199], v[44:47], v[96:99]
v_exp_f32 v21, v21
v_mfma_f32_16x16x32_bf16 v[100:103], a[200:203], v[44:47], v[100:103]
v_cvt_pk_bf16_f32 v34, v20, v21
v_cvt_pk_bf16_f32 v212, v72, v73
v_mfma_f32_16x16x32_bf16 v[100:103], a[204:207], v[40:43], v[100:103]
v_exp_f32 v22, v22
v_mfma_f32_16x16x32_bf16 v[104:107], a[208:211], v[40:43], v[104:107]
buffer_load_dwordx4 v2, s[16:19], s73 offen offset:0 lds
v_mfma_f32_16x16x32_bf16 v[104:107], a[212:215], v[44:47], v[104:107]
v_exp_f32 v23, v23
v_mfma_f32_16x16x32_bf16 v[108:111], a[216:219], v[44:47], v[108:111]
v_cvt_pk_bf16_f32 v35, v22, v23
v_add_f32 v55, v52, v53
v_mfma_f32_16x16x32_bf16 v[108:111], a[220:223], v[40:43], v[108:111]
v_exp_f32 v24, v24
v_mfma_f32_16x16x32_bf16 v[112:115], a[224:227], v[40:43], v[112:115]
v_rcp_f32 v54, v55
v_mfma_f32_16x16x32_bf16 v[112:115], a[228:231], v[44:47], v[112:115]
v_exp_f32 v25, v25
v_mfma_f32_16x16x32_bf16 v[116:119], a[232:235], v[44:47], v[116:119]
v_cvt_pk_bf16_f32 v36, v24, v25
v_cvt_pk_bf16_f32 v213, v74, v75
v_mfma_f32_16x16x32_bf16 v[116:119], a[236:239], v[40:43], v[116:119]
v_exp_f32 v26, v26
v_mfma_f32_16x16x32_bf16 v[120:123], a[240:243], v[40:43], v[120:123]
buffer_load_dwordx4 v2, s[16:19], s73 offen offset:2048 lds
v_mfma_f32_16x16x32_bf16 v[120:123], a[244:247], v[44:47], v[120:123]
v_exp_f32 v27, v27
v_mfma_f32_16x16x32_bf16 v[124:127], a[248:251], v[44:47], v[124:127]
v_cvt_pk_bf16_f32 v37, v26, v27
v_cvt_pk_bf16_f32 v214, v76, v77
v_mfma_f32_16x16x32_bf16 v[124:127], a[252:255], v[40:43], v[124:127]
v_exp_f32 v28, v28
v_mfma_f32_16x16x32_bf16 v[16:19], a[128:131], a[112:115], -4.0
v_cvt_pk_bf16_f32 v215, v78, v79
v_cvt_pk_bf16_f32 v216, v80, v81
v_mfma_f32_16x16x32_bf16 v[16:19], a[132:135], a[116:119], v[16:19]
v_exp_f32 v29, v29
v_mfma_f32_16x16x32_bf16 v[16:19], a[136:139], a[120:123], v[16:19]
buffer_store_dwordx4 v[204:207], v0, s[20:23], s35 offen offset:192 sc1
v_mfma_f32_16x16x32_bf16 v[16:19], a[140:143], a[124:127], v[16:19]
v_exp_f32 v30, v30
v_mfma_f32_16x16x32_bf16 v[20:23], a[144:147], a[124:127], -4.0
v_cvt_pk_bf16_f32 v38, v28, v29
v_cvt_pk_bf16_f32 v217, v82, v83
v_mfma_f32_16x16x32_bf16 v[20:23], a[148:151], a[120:123], v[20:23]
v_exp_f32 v31, v31
v_mfma_f32_16x16x32_bf16 v[20:23], a[152:155], a[116:119], v[20:23]
v_cvt_pk_bf16_f32 v39, v30, v31
v_cvt_pk_bf16_f32 v218, v84, v85
v_mfma_f32_16x16x32_bf16 v[20:23], a[156:159], a[112:115], v[20:23]
v_exp_f32 v16, v16
v_mfma_f32_16x16x32_bf16 v[24:27], a[160:163], a[112:115], -4.0
v_cvt_pk_bf16_f32 v219, v86, v87
v_cvt_pk_bf16_f32 v220, v88, v89
v_mfma_f32_16x16x32_bf16 v[24:27], a[164:167], a[116:119], v[24:27]
v_exp_f32 v17, v17
v_mfma_f32_16x16x32_bf16 v[24:27], a[168:171], a[120:123], v[24:27]
v_cvt_pk_bf16_f32 v40, v16, v17
v_cvt_pk_bf16_f32 v221, v90, v91
v_mfma_f32_16x16x32_bf16 v[24:27], a[172:175], a[124:127], v[24:27]
v_exp_f32 v18, v18
v_mfma_f32_16x16x32_bf16 v[28:31], a[176:179], a[124:127], -4.0
v_cvt_pk_bf16_f32 v222, v92, v93
v_cvt_pk_bf16_f32 v223, v94, v95
v_mfma_f32_16x16x32_bf16 v[28:31], a[180:183], a[120:123], v[28:31]
v_exp_f32 v19, v19
v_mfma_f32_16x16x32_bf16 v[28:31], a[184:187], a[116:119], v[28:31]
v_cvt_pk_bf16_f32 v41, v18, v19
v_subrev_u32 v55, 0x2f800000, v55
v_mfma_f32_16x16x32_bf16 v[28:31], a[188:191], a[112:115], v[28:31]
v_exp_f32 v20, v20
v_smfmac_f32_16x16x64_bf16 v[56:59], v[12:15], v[32:39], v1
v_max_u32 v3, v3, v55
v_mfma_f32_16x16x32_bf16 v[128:131], a[192:195], v[32:35], v[128:131]
v_mov_b32 v52, 0
v_mov_b32 v53, 0
v_mfma_f32_16x16x32_bf16 v[128:131], a[196:199], v[36:39], v[128:131]
v_exp_f32 v21, v21
v_mfma_f32_16x16x32_bf16 v[132:135], a[200:203], v[36:39], v[132:135]
v_cvt_pk_bf16_f32 v42, v20, v21
v_mov_b32 v55, 0
v_mfma_f32_16x16x32_bf16 v[132:135], a[204:207], v[32:35], v[132:135]
v_exp_f32 v22, v22
v_mfma_f32_16x16x32_bf16 v[136:139], a[208:211], v[32:35], v[136:139]
v_add_f32 v59, v56, v57
v_rcp_f32 v58, v59
v_mfma_f32_16x16x32_bf16 v[136:139], a[212:215], v[36:39], v[136:139]
v_exp_f32 v23, v23
v_mfma_f32_16x16x32_bf16 v[140:143], a[216:219], v[36:39], v[140:143]
v_cvt_pk_bf16_f32 v43, v22, v23
v_mul_f32 v96, v54, v96
v_mfma_f32_16x16x32_bf16 v[140:143], a[220:223], v[32:35], v[140:143]
v_exp_f32 v24, v24
v_mfma_f32_16x16x32_bf16 v[144:147], a[224:227], v[32:35], v[144:147]
v_mul_f32 v97, v54, v97
v_mul_f32 v98, v54, v98
v_mfma_f32_16x16x32_bf16 v[144:147], a[228:231], v[36:39], v[144:147]
v_exp_f32 v25, v25
v_mfma_f32_16x16x32_bf16 v[148:151], a[232:235], v[36:39], v[148:151]
v_cvt_pk_bf16_f32 v44, v24, v25
v_mul_f32 v99, v54, v99
v_mfma_f32_16x16x32_bf16 v[148:151], a[236:239], v[32:35], v[148:151]
v_exp_f32 v26, v26
v_mfma_f32_16x16x32_bf16 v[152:155], a[240:243], v[32:35], v[152:155]
v_cvt_pk_bf16_f32 v224, v96, v97
v_cvt_pk_bf16_f32 v225, v98, v99
v_mfma_f32_16x16x32_bf16 v[152:155], a[244:247], v[36:39], v[152:155]
v_exp_f32 v27, v27
v_mfma_f32_16x16x32_bf16 v[156:159], a[248:251], v[36:39], v[156:159]
v_cvt_pk_bf16_f32 v45, v26, v27
v_mul_f32 v100, v54, v100
v_mfma_f32_16x16x32_bf16 v[156:159], a[252:255], v[32:35], v[156:159]
v_exp_f32 v28, v28
v_mfma_f32_16x16x32_bf16 v[16:19], a[128:131], a[0:3], -4.0
v_mul_f32 v101, v54, v101
v_mul_f32 v102, v54, v102
v_mfma_f32_16x16x32_bf16 v[16:19], a[132:135], a[4:7], v[16:19]
v_exp_f32 v29, v29
v_mfma_f32_16x16x32_bf16 v[16:19], a[136:139], a[8:11], v[16:19]
v_mul_f32 v103, v54, v103
v_cvt_pk_bf16_f32 v226, v100, v101
v_mfma_f32_16x16x32_bf16 v[16:19], a[140:143], a[12:15], v[16:19]
v_exp_f32 v30, v30
v_pk_mul_f32 v[128:129], v[128:129], v[58:59] op_sel_hi:[1,0]
v_pk_mul_f32 v[130:131], v[130:131], v[58:59] op_sel_hi:[1,0]
v_pk_mul_f32 v[132:133], v[132:133], v[58:59] op_sel_hi:[1,0]
v_pk_mul_f32 v[134:135], v[134:135], v[58:59] op_sel_hi:[1,0]
v_pk_mul_f32 v[136:137], v[136:137], v[58:59] op_sel_hi:[1,0]
v_pk_mul_f32 v[138:139], v[138:139], v[58:59] op_sel_hi:[1,0]
v_pk_mul_f32 v[140:141], v[140:141], v[58:59] op_sel_hi:[1,0]
v_pk_mul_f32 v[142:143], v[142:143], v[58:59] op_sel_hi:[1,0]
v_pk_mul_f32 v[144:145], v[144:145], v[58:59] op_sel_hi:[1,0]
v_pk_mul_f32 v[146:147], v[146:147], v[58:59] op_sel_hi:[1,0]
v_pk_mul_f32 v[148:149], v[148:149], v[58:59] op_sel_hi:[1,0]
v_pk_mul_f32 v[150:151], v[150:151], v[58:59] op_sel_hi:[1,0]
v_pk_mul_f32 v[152:153], v[152:153], v[58:59] op_sel_hi:[1,0]
v_pk_mul_f32 v[154:155], v[154:155], v[58:59] op_sel_hi:[1,0]
v_pk_mul_f32 v[156:157], v[156:157], v[58:59] op_sel_hi:[1,0]
v_pk_mul_f32 v[158:159], v[158:159], v[58:59] op_sel_hi:[1,0]
v_mfma_f32_16x16x32_bf16 v[20:23], a[144:147], a[12:15], -4.0
v_cvt_pk_bf16_f32 v46, v28, v29
v_cvt_pk_bf16_f32 v227, v102, v103
v_mfma_f32_16x16x32_bf16 v[20:23], a[148:151], a[8:11], v[20:23]
v_exp_f32 v31, v31
v_mfma_f32_16x16x32_bf16 v[20:23], a[152:155], a[4:7], v[20:23]
v_cvt_pk_bf16_f32 v47, v30, v31
v_mul_f32 v104, v54, v104
v_mfma_f32_16x16x32_bf16 v[20:23], a[156:159], a[0:3], v[20:23]
v_exp_f32 v16, v16
v_mfma_f32_16x16x32_bf16 v[24:27], a[160:163], a[0:3], -4.0
v_mul_f32 v105, v54, v105
v_mul_f32 v106, v54, v106
v_mfma_f32_16x16x32_bf16 v[24:27], a[164:167], a[4:7], v[24:27]
v_exp_f32 v17, v17
v_mfma_f32_16x16x32_bf16 v[24:27], a[168:171], a[8:11], v[24:27]
v_cvt_pk_bf16_f32 v32, v16, v17
v_mul_f32 v107, v54, v107
v_mfma_f32_16x16x32_bf16 v[24:27], a[172:175], a[12:15], v[24:27]
v_exp_f32 v18, v18
v_mfma_f32_16x16x32_bf16 v[28:31], a[176:179], a[12:15], -4.0
v_cvt_pk_bf16_f32 v228, v104, v105
v_cvt_pk_bf16_f32 v229, v106, v107
v_mfma_f32_16x16x32_bf16 v[28:31], a[180:183], a[8:11], v[28:31]
v_exp_f32 v19, v19
v_mfma_f32_16x16x32_bf16 v[28:31], a[184:187], a[4:7], v[28:31]
v_cvt_pk_bf16_f32 v33, v18, v19
v_mul_f32 v108, v54, v108
v_mfma_f32_16x16x32_bf16 v[28:31], a[188:191], a[0:3], v[28:31]
v_exp_f32 v20, v20
v_smfmac_f32_16x16x64_bf16 v[60:63], v[12:15], v[40:47], v1
v_mul_f32 v109, v54, v109
v_mfma_f32_16x16x32_bf16 v[160:163], a[192:195], v[40:43], v[160:163]
v_mul_f32 v110, v54, v110
v_mul_f32 v111, v54, v111
v_mfma_f32_16x16x32_bf16 v[160:163], a[196:199], v[44:47], v[160:163]
v_exp_f32 v21, v21
v_mfma_f32_16x16x32_bf16 v[164:167], a[200:203], v[44:47], v[164:167]
v_cvt_pk_bf16_f32 v34, v20, v21
v_cvt_pk_bf16_f32 v230, v108, v109
v_mfma_f32_16x16x32_bf16 v[164:167], a[204:207], v[40:43], v[164:167]
v_exp_f32 v22, v22
v_mfma_f32_16x16x32_bf16 v[168:171], a[208:211], v[40:43], v[168:171]
v_add_f32 v63, v60, v61
v_rcp_f32 v62, v63
v_mfma_f32_16x16x32_bf16 v[168:171], a[212:215], v[44:47], v[168:171]
v_exp_f32 v23, v23
v_mfma_f32_16x16x32_bf16 v[172:175], a[216:219], v[44:47], v[172:175]
v_cvt_pk_bf16_f32 v35, v22, v23
v_cvt_pk_bf16_f32 v231, v110, v111
v_mfma_f32_16x16x32_bf16 v[172:175], a[220:223], v[40:43], v[172:175]
v_exp_f32 v24, v24
v_mfma_f32_16x16x32_bf16 v[176:179], a[224:227], v[40:43], v[176:179]
v_mul_f32 v112, v54, v112
v_mul_f32 v113, v54, v113
v_mfma_f32_16x16x32_bf16 v[176:179], a[228:231], v[44:47], v[176:179]
v_exp_f32 v25, v25
v_mfma_f32_16x16x32_bf16 v[180:183], a[232:235], v[44:47], v[180:183]
v_cvt_pk_bf16_f32 v36, v24, v25
v_mul_f32 v114, v54, v114
v_mfma_f32_16x16x32_bf16 v[180:183], a[236:239], v[40:43], v[180:183]
v_exp_f32 v26, v26
v_mfma_f32_16x16x32_bf16 v[184:187], a[240:243], v[40:43], v[184:187]
v_mul_f32 v115, v54, v115
v_cvt_pk_bf16_f32 v232, v112, v113
v_mfma_f32_16x16x32_bf16 v[184:187], a[244:247], v[44:47], v[184:187]
v_exp_f32 v27, v27
v_mfma_f32_16x16x32_bf16 v[188:191], a[248:251], v[44:47], v[188:191]
v_cvt_pk_bf16_f32 v37, v26, v27
v_cvt_pk_bf16_f32 v233, v114, v115
v_mfma_f32_16x16x32_bf16 v[188:191], a[252:255], v[40:43], v[188:191]
v_exp_f32 v28, v28
v_mfma_f32_16x16x32_bf16 v[16:19], a[128:131], a[16:19], -4.0
v_mul_f32 v116, v54, v116
v_mul_f32 v117, v54, v117
v_mfma_f32_16x16x32_bf16 v[16:19], a[132:135], a[20:23], v[16:19]
v_exp_f32 v29, v29
v_mfma_f32_16x16x32_bf16 v[16:19], a[136:139], a[24:27], v[16:19]
v_mul_f32 v118, v54, v118
v_mul_f32 v119, v54, v119
v_mfma_f32_16x16x32_bf16 v[16:19], a[140:143], a[28:31], v[16:19]
v_exp_f32 v30, v30
v_mfma_f32_16x16x32_bf16 v[20:23], a[144:147], a[28:31], -4.0
v_cvt_pk_bf16_f32 v38, v28, v29
v_cvt_pk_bf16_f32 v234, v116, v117
v_mfma_f32_16x16x32_bf16 v[20:23], a[148:151], a[24:27], v[20:23]
v_exp_f32 v31, v31
v_mfma_f32_16x16x32_bf16 v[20:23], a[152:155], a[20:23], v[20:23]
v_cvt_pk_bf16_f32 v39, v30, v31
v_cvt_pk_bf16_f32 v235, v118, v119
v_mfma_f32_16x16x32_bf16 v[20:23], a[156:159], a[16:19], v[20:23]
v_exp_f32 v16, v16
v_mfma_f32_16x16x32_bf16 v[24:27], a[160:163], a[16:19], -4.0
v_mul_f32 v120, v54, v120
v_mul_f32 v121, v54, v121
v_mfma_f32_16x16x32_bf16 v[24:27], a[164:167], a[20:23], v[24:27]
v_exp_f32 v17, v17
v_mfma_f32_16x16x32_bf16 v[24:27], a[168:171], a[24:27], v[24:27]
v_cvt_pk_bf16_f32 v40, v16, v17
v_mul_f32 v122, v54, v122
v_mfma_f32_16x16x32_bf16 v[24:27], a[172:175], a[28:31], v[24:27]
v_exp_f32 v18, v18
v_mfma_f32_16x16x32_bf16 v[28:31], a[176:179], a[28:31], -4.0
v_mul_f32 v123, v54, v123
v_cvt_pk_bf16_f32 v236, v120, v121
v_mfma_f32_16x16x32_bf16 v[28:31], a[180:183], a[24:27], v[28:31]
v_exp_f32 v19, v19
v_mfma_f32_16x16x32_bf16 v[28:31], a[184:187], a[20:23], v[28:31]
v_cvt_pk_bf16_f32 v41, v18, v19
v_cvt_pk_bf16_f32 v237, v122, v123
v_mfma_f32_16x16x32_bf16 v[28:31], a[188:191], a[16:19], v[28:31]
v_exp_f32 v20, v20
v_smfmac_f32_16x16x64_bf16 v[48:51], v[12:15], v[32:39], v1
v_mul_f32 v124, v54, v124
v_mfma_f32_16x16x32_bf16 v[64:67], a[192:195], v[32:35], 0
v_mul_f32 v125, v54, v125
v_mul_f32 v126, v54, v126
v_mfma_f32_16x16x32_bf16 v[64:67], a[196:199], v[36:39], v[64:67]
v_exp_f32 v21, v21
v_mfma_f32_16x16x32_bf16 v[68:71], a[200:203], v[36:39], 0
v_cvt_pk_bf16_f32 v42, v20, v21
v_mul_f32 v127, v54, v127
v_mfma_f32_16x16x32_bf16 v[68:71], a[204:207], v[32:35], v[68:71]
v_exp_f32 v22, v22
v_mfma_f32_16x16x32_bf16 v[72:75], a[208:211], v[32:35], 0
v_cvt_pk_bf16_f32 v238, v124, v125
v_cvt_pk_bf16_f32 v239, v126, v127
v_mfma_f32_16x16x32_bf16 v[72:75], a[212:215], v[36:39], v[72:75]
v_exp_f32 v23, v23
v_mfma_f32_16x16x32_bf16 v[76:79], a[216:219], v[36:39], 0
v_cvt_pk_bf16_f32 v43, v22, v23
v_subrev_u32 v59, 0x2f800000, v59
v_mfma_f32_16x16x32_bf16 v[76:79], a[220:223], v[32:35], v[76:79]
v_exp_f32 v24, v24
v_mfma_f32_16x16x32_bf16 v[80:83], a[224:227], v[32:35], 0
v_max_u32 v3, v3, v59
v_mov_b32 v56, 0
v_mfma_f32_16x16x32_bf16 v[80:83], a[228:231], v[36:39], v[80:83]
v_exp_f32 v25, v25
v_mfma_f32_16x16x32_bf16 v[84:87], a[232:235], v[36:39], 0
v_cvt_pk_bf16_f32 v44, v24, v25
v_mov_b32 v57, 0
v_mfma_f32_16x16x32_bf16 v[84:87], a[236:239], v[32:35], v[84:87]
v_exp_f32 v26, v26
v_mfma_f32_16x16x32_bf16 v[88:91], a[240:243], v[32:35], 0
v_mov_b32 v59, 0
v_cvt_pk_bf16_f32 v240, v128, v129
v_mfma_f32_16x16x32_bf16 v[88:91], a[244:247], v[36:39], v[88:91]
v_exp_f32 v27, v27
v_mfma_f32_16x16x32_bf16 v[92:95], a[248:251], v[36:39], 0
v_cvt_pk_bf16_f32 v45, v26, v27
v_cvt_pk_bf16_f32 v241, v130, v131
v_mfma_f32_16x16x32_bf16 v[92:95], a[252:255], v[32:35], v[92:95]
v_exp_f32 v28, v28
v_mfma_f32_16x16x32_bf16 v[16:19], a[128:131], a[32:35], -4.0
v_cvt_pk_bf16_f32 v242, v132, v133
v_cvt_pk_bf16_f32 v243, v134, v135
v_mfma_f32_16x16x32_bf16 v[16:19], a[132:135], a[36:39], v[16:19]
v_exp_f32 v29, v29
v_mfma_f32_16x16x32_bf16 v[16:19], a[136:139], a[40:43], v[16:19]
v_cvt_pk_bf16_f32 v244, v136, v137
v_cvt_pk_bf16_f32 v245, v138, v139
v_mfma_f32_16x16x32_bf16 v[16:19], a[140:143], a[44:47], v[16:19]
v_exp_f32 v30, v30
v_mfma_f32_16x16x32_bf16 v[20:23], a[144:147], a[44:47], -4.0
v_cvt_pk_bf16_f32 v46, v28, v29
v_cvt_pk_bf16_f32 v246, v140, v141
v_mfma_f32_16x16x32_bf16 v[20:23], a[148:151], a[40:43], v[20:23]
v_exp_f32 v31, v31
v_mfma_f32_16x16x32_bf16 v[20:23], a[152:155], a[36:39], v[20:23]
v_cvt_pk_bf16_f32 v47, v30, v31
v_cvt_pk_bf16_f32 v247, v142, v143
v_mfma_f32_16x16x32_bf16 v[20:23], a[156:159], a[32:35], v[20:23]
v_exp_f32 v16, v16
v_mfma_f32_16x16x32_bf16 v[24:27], a[160:163], a[32:35], -4.0
v_cvt_pk_bf16_f32 v248, v144, v145
v_cvt_pk_bf16_f32 v249, v146, v147
v_mfma_f32_16x16x32_bf16 v[24:27], a[164:167], a[36:39], v[24:27]
v_exp_f32 v17, v17
v_mfma_f32_16x16x32_bf16 v[24:27], a[168:171], a[40:43], v[24:27]
v_cvt_pk_bf16_f32 v32, v16, v17
v_cvt_pk_bf16_f32 v250, v148, v149
v_mfma_f32_16x16x32_bf16 v[24:27], a[172:175], a[44:47], v[24:27]
v_exp_f32 v18, v18
v_mfma_f32_16x16x32_bf16 v[28:31], a[176:179], a[44:47], -4.0
v_cvt_pk_bf16_f32 v251, v150, v151
v_cvt_pk_bf16_f32 v252, v152, v153
v_mfma_f32_16x16x32_bf16 v[28:31], a[180:183], a[40:43], v[28:31]
v_exp_f32 v19, v19
v_mfma_f32_16x16x32_bf16 v[28:31], a[184:187], a[36:39], v[28:31]
v_cvt_pk_bf16_f32 v33, v18, v19
v_cvt_pk_bf16_f32 v253, v154, v155
v_mfma_f32_16x16x32_bf16 v[28:31], a[188:191], a[32:35], v[28:31]
v_exp_f32 v20, v20
v_smfmac_f32_16x16x64_bf16 v[52:55], v[12:15], v[40:47], v1
v_cvt_pk_bf16_f32 v254, v156, v157
v_mfma_f32_16x16x32_bf16 v[96:99], a[192:195], v[40:43], 0
v_cvt_pk_bf16_f32 v255, v158, v159
v_subrev_u32 v63, 0x2f800000, v63
v_mfma_f32_16x16x32_bf16 v[96:99], a[196:199], v[44:47], v[96:99]
v_exp_f32 v21, v21
v_mfma_f32_16x16x32_bf16 v[100:103], a[200:203], v[44:47], 0
v_cvt_pk_bf16_f32 v34, v20, v21
v_max_u32 v3, v3, v63
v_mfma_f32_16x16x32_bf16 v[100:103], a[204:207], v[40:43], v[100:103]
v_exp_f32 v22, v22
v_mfma_f32_16x16x32_bf16 v[104:107], a[208:211], v[40:43], 0
v_mov_b32 v60, 0
v_mov_b32 v61, 0
v_mfma_f32_16x16x32_bf16 v[104:107], a[212:215], v[44:47], v[104:107]
v_exp_f32 v23, v23
v_mfma_f32_16x16x32_bf16 v[108:111], a[216:219], v[44:47], 0
v_cvt_pk_bf16_f32 v35, v22, v23
v_mov_b32 v63, 0
v_mfma_f32_16x16x32_bf16 v[108:111], a[220:223], v[40:43], v[108:111]
v_exp_f32 v24, v24
v_mfma_f32_16x16x32_bf16 v[112:115], a[224:227], v[40:43], 0
v_mul_f32 v160, v62, v160
v_mul_f32 v161, v62, v161
v_mfma_f32_16x16x32_bf16 v[112:115], a[228:231], v[44:47], v[112:115]
v_exp_f32 v25, v25
v_mfma_f32_16x16x32_bf16 v[116:119], a[232:235], v[44:47], 0
v_cvt_pk_bf16_f32 v36, v24, v25
v_mul_f32 v162, v62, v162
v_mfma_f32_16x16x32_bf16 v[116:119], a[236:239], v[40:43], v[116:119]
v_exp_f32 v26, v26
v_mfma_f32_16x16x32_bf16 v[120:123], a[240:243], v[40:43], 0
v_mul_f32 v163, v62, v163
v_cvt_pk_bf16_f32 v192, v160, v161
v_mfma_f32_16x16x32_bf16 v[120:123], a[244:247], v[44:47], v[120:123]
v_exp_f32 v27, v27
v_mfma_f32_16x16x32_bf16 v[124:127], a[248:251], v[44:47], 0
v_cvt_pk_bf16_f32 v37, v26, v27
v_cvt_pk_bf16_f32 v193, v162, v163
v_mfma_f32_16x16x32_bf16 v[124:127], a[252:255], v[40:43], v[124:127]
v_exp_f32 v28, v28
v_mfma_f32_16x16x32_bf16 v[16:19], a[128:131], a[48:51], -4.0
ds_read_b128 a[128:131], v4 offset:16384
v_mul_f32 v164, v62, v164
v_mfma_f32_16x16x32_bf16 v[16:19], a[132:135], a[52:55], v[16:19]
v_exp_f32 v29, v29
v_mfma_f32_16x16x32_bf16 v[16:19], a[136:139], a[56:59], v[16:19]
ds_read_b128 a[132:135], v5 offset:16384
v_mul_f32 v165, v62, v165
v_mfma_f32_16x16x32_bf16 v[16:19], a[140:143], a[60:63], v[16:19]
v_exp_f32 v30, v30
v_mfma_f32_16x16x32_bf16 v[20:23], a[144:147], a[60:63], -4.0
ds_read_b128 a[136:139], v6 offset:16384
v_cvt_pk_bf16_f32 v38, v28, v29
v_mfma_f32_16x16x32_bf16 v[20:23], a[148:151], a[56:59], v[20:23]
v_exp_f32 v31, v31
v_mfma_f32_16x16x32_bf16 v[20:23], a[152:155], a[52:55], v[20:23]
ds_read_b128 a[140:143], v7 offset:16384
v_cvt_pk_bf16_f32 v39, v30, v31
v_mfma_f32_16x16x32_bf16 v[20:23], a[156:159], a[48:51], v[20:23]
v_exp_f32 v16, v16
v_mfma_f32_16x16x32_bf16 v[24:27], a[160:163], a[48:51], -4.0
ds_read_b128 a[144:147], v7 offset:20480
v_mul_f32 v166, v62, v166
v_mfma_f32_16x16x32_bf16 v[24:27], a[164:167], a[52:55], v[24:27]
v_exp_f32 v17, v17
v_mfma_f32_16x16x32_bf16 v[24:27], a[168:171], a[56:59], v[24:27]
ds_read_b128 a[148:151], v6 offset:20480
v_cvt_pk_bf16_f32 v40, v16, v17
v_mfma_f32_16x16x32_bf16 v[24:27], a[172:175], a[60:63], v[24:27]
v_exp_f32 v18, v18
v_mfma_f32_16x16x32_bf16 v[28:31], a[176:179], a[60:63], -4.0
ds_read_b128 a[152:155], v5 offset:20480
v_mul_f32 v167, v62, v167
v_mfma_f32_16x16x32_bf16 v[28:31], a[180:183], a[56:59], v[28:31]
v_exp_f32 v19, v19
v_mfma_f32_16x16x32_bf16 v[28:31], a[184:187], a[52:55], v[28:31]
ds_read_b128 a[156:159], v4 offset:20480
v_cvt_pk_bf16_f32 v41, v18, v19
v_mfma_f32_16x16x32_bf16 v[28:31], a[188:191], a[48:51], v[28:31]
v_exp_f32 v20, v20
v_smfmac_f32_16x16x64_bf16 v[56:59], v[12:15], v[32:39], v1
ds_read_b128 a[160:163], v4 offset:24576
v_mfma_f32_16x16x32_bf16 v[128:131], a[192:195], v[32:35], 0
ds_read_b128 a[164:167], v5 offset:24576
v_cvt_pk_bf16_f32 v194, v164, v165
v_mfma_f32_16x16x32_bf16 v[128:131], a[196:199], v[36:39], v[128:131]
v_exp_f32 v21, v21
v_mfma_f32_16x16x32_bf16 v[132:135], a[200:203], v[36:39], 0
ds_read_b128 a[168:171], v6 offset:24576
v_cvt_pk_bf16_f32 v42, v20, v21
v_mfma_f32_16x16x32_bf16 v[132:135], a[204:207], v[32:35], v[132:135]
v_exp_f32 v22, v22
v_mfma_f32_16x16x32_bf16 v[136:139], a[208:211], v[32:35], 0
ds_read_b128 a[172:175], v7 offset:24576
v_cvt_pk_bf16_f32 v195, v166, v167
v_mfma_f32_16x16x32_bf16 v[136:139], a[212:215], v[36:39], v[136:139]
v_exp_f32 v23, v23
v_mfma_f32_16x16x32_bf16 v[140:143], a[216:219], v[36:39], 0
ds_read_b128 a[176:179], v7 offset:28672
v_cvt_pk_bf16_f32 v43, v22, v23
v_mfma_f32_16x16x32_bf16 v[140:143], a[220:223], v[32:35], v[140:143]
v_exp_f32 v24, v24
v_mfma_f32_16x16x32_bf16 v[144:147], a[224:227], v[32:35], 0
ds_read_b128 a[180:183], v6 offset:28672
v_mul_f32 v168, v62, v168
v_mfma_f32_16x16x32_bf16 v[144:147], a[228:231], v[36:39], v[144:147]
v_exp_f32 v25, v25
v_mfma_f32_16x16x32_bf16 v[148:151], a[232:235], v[36:39], 0
ds_read_b128 a[184:187], v5 offset:28672
v_cvt_pk_bf16_f32 v44, v24, v25
v_mfma_f32_16x16x32_bf16 v[148:151], a[236:239], v[32:35], v[148:151]
v_exp_f32 v26, v26
v_mfma_f32_16x16x32_bf16 v[152:155], a[240:243], v[32:35], 0
ds_read_b128 a[188:191], v4 offset:28672
v_mul_f32 v169, v62, v169
v_mfma_f32_16x16x32_bf16 v[152:155], a[244:247], v[36:39], v[152:155]
v_exp_f32 v27, v27
v_mfma_f32_16x16x32_bf16 v[156:159], a[248:251], v[36:39], 0
v_cvt_pk_bf16_f32 v45, v26, v27
v_mul_f32 v170, v62, v170
v_mfma_f32_16x16x32_bf16 v[156:159], a[252:255], v[32:35], v[156:159]
s_waitcnt lgkmcnt(12)
v_exp_f32 v28, v28
v_mfma_f32_16x16x32_bf16 v[16:19], a[128:131], a[0:3], -4.0
v_mul_f32 v171, v62, v171
v_cvt_pk_bf16_f32 v196, v168, v169
v_mfma_f32_16x16x32_bf16 v[16:19], a[132:135], a[4:7], v[16:19]
v_exp_f32 v29, v29
v_mfma_f32_16x16x32_bf16 v[16:19], a[136:139], a[8:11], v[16:19]
v_cvt_pk_bf16_f32 v197, v170, v171
v_mul_f32 v172, v62, v172
v_mfma_f32_16x16x32_bf16 v[16:19], a[140:143], a[12:15], v[16:19]
s_waitcnt lgkmcnt(8)
v_exp_f32 v30, v30
v_mfma_f32_16x16x32_bf16 v[20:23], a[144:147], a[12:15], -4.0
v_cvt_pk_bf16_f32 v46, v28, v29
v_mul_f32 v173, v62, v173
v_mfma_f32_16x16x32_bf16 v[20:23], a[148:151], a[8:11], v[20:23]
v_exp_f32 v31, v31
v_mfma_f32_16x16x32_bf16 v[20:23], a[152:155], a[4:7], v[20:23]
v_cvt_pk_bf16_f32 v47, v30, v31
v_mul_f32 v174, v62, v174
v_mfma_f32_16x16x32_bf16 v[20:23], a[156:159], a[0:3], v[20:23]
s_waitcnt lgkmcnt(4)
v_exp_f32 v16, v16
v_mfma_f32_16x16x32_bf16 v[24:27], a[160:163], a[0:3], -4.0
v_mul_f32 v175, v62, v175
v_cvt_pk_bf16_f32 v198, v172, v173
v_mfma_f32_16x16x32_bf16 v[24:27], a[164:167], a[4:7], v[24:27]
v_exp_f32 v17, v17
v_mfma_f32_16x16x32_bf16 v[24:27], a[168:171], a[8:11], v[24:27]
v_cvt_pk_bf16_f32 v32, v16, v17
v_cvt_pk_bf16_f32 v199, v174, v175
v_mfma_f32_16x16x32_bf16 v[24:27], a[172:175], a[12:15], v[24:27]
s_waitcnt lgkmcnt(0)
v_exp_f32 v18, v18
v_mfma_f32_16x16x32_bf16 v[28:31], a[176:179], a[12:15], -4.0
v_mul_f32 v176, v62, v176
v_mul_f32 v177, v62, v177
v_mfma_f32_16x16x32_bf16 v[28:31], a[180:183], a[8:11], v[28:31]
v_exp_f32 v19, v19
v_mfma_f32_16x16x32_bf16 v[28:31], a[184:187], a[4:7], v[28:31]
v_cvt_pk_bf16_f32 v33, v18, v19
v_mul_f32 v178, v62, v178
v_mfma_f32_16x16x32_bf16 v[28:31], a[188:191], a[0:3], v[28:31]
v_exp_f32 v20, v20
v_smfmac_f32_16x16x64_bf16 v[60:63], v[12:15], v[40:47], v1
s_nop 7
v_mul_f32 v179, v62, v179
v_mfma_f32_16x16x32_bf16 v[160:163], a[192:195], v[40:43], 0
ds_read_b64_tr_b16 a[192:193], v8 offset:16384
ds_read_b64_tr_b16 a[194:195], v8 offset:20480
v_mfma_f32_16x16x32_bf16 v[160:163], a[196:199], v[44:47], v[160:163]
v_exp_f32 v21, v21
v_mfma_f32_16x16x32_bf16 v[164:167], a[200:203], v[44:47], 0
ds_read_b64_tr_b16 a[196:197], v8 offset:24576
v_cvt_pk_bf16_f32 v34, v20, v21
v_mfma_f32_16x16x32_bf16 v[164:167], a[204:207], v[40:43], v[164:167]
v_exp_f32 v22, v22
v_mfma_f32_16x16x32_bf16 v[168:171], a[208:211], v[40:43], 0
ds_read_b64_tr_b16 a[198:199], v8 offset:28672
ds_read_b64_tr_b16 a[200:201], v9 offset:24576
v_mfma_f32_16x16x32_bf16 v[168:171], a[212:215], v[44:47], v[168:171]
v_exp_f32 v23, v23
v_cvt_pk_bf16_f32 v200, v176, v177
v_cvt_pk_bf16_f32 v201, v178, v179
v_mfma_f32_16x16x32_bf16 v[172:175], a[216:219], v[44:47], 0
ds_read_b64_tr_b16 a[202:203], v9 offset:28672
v_cvt_pk_bf16_f32 v35, v22, v23
v_mfma_f32_16x16x32_bf16 v[172:175], a[220:223], v[40:43], v[172:175]
v_exp_f32 v24, v24
v_mul_f32 v180, v62, v180
v_mul_f32 v181, v62, v181
v_mul_f32 v182, v62, v182
v_mul_f32 v183, v62, v183
v_cvt_pk_bf16_f32 v202, v180, v181
v_cvt_pk_bf16_f32 v203, v182, v183
v_mfma_f32_16x16x32_bf16 v[176:179], a[224:227], v[40:43], 0
ds_read_b64_tr_b16 a[204:205], v9 offset:16384
ds_read_b64_tr_b16 a[206:207], v9 offset:20480
v_mfma_f32_16x16x32_bf16 v[176:179], a[228:231], v[44:47], v[176:179]
v_exp_f32 v25, v25
v_mul_f32 v184, v62, v184
v_mul_f32 v185, v62, v185
v_mul_f32 v186, v62, v186
v_mul_f32 v187, v62, v187
v_cvt_pk_bf16_f32 v204, v184, v185
v_cvt_pk_bf16_f32 v205, v186, v187
v_mfma_f32_16x16x32_bf16 v[180:183], a[232:235], v[44:47], 0
ds_read_b64_tr_b16 a[208:209], v10 offset:16384
v_cvt_pk_bf16_f32 v36, v24, v25
v_mfma_f32_16x16x32_bf16 v[180:183], a[236:239], v[40:43], v[180:183]
v_exp_f32 v26, v26
v_mul_f32 v188, v62, v188
v_mul_f32 v189, v62, v189
v_mul_f32 v190, v62, v190
v_mul_f32 v191, v62, v191
v_cvt_pk_bf16_f32 v206, v188, v189
v_cvt_pk_bf16_f32 v207, v190, v191
v_mfma_f32_16x16x32_bf16 v[184:187], a[240:243], v[40:43], 0
ds_read_b64_tr_b16 a[210:211], v10 offset:20480
ds_read_b64_tr_b16 a[212:213], v10 offset:24576
v_mfma_f32_16x16x32_bf16 v[184:187], a[244:247], v[44:47], v[184:187]
v_exp_f32 v27, v27
v_mfma_f32_16x16x32_bf16 v[188:191], a[248:251], v[44:47], 0
ds_read_b64_tr_b16 a[214:215], v10 offset:28672
v_cvt_pk_bf16_f32 v37, v26, v27
v_mfma_f32_16x16x32_bf16 v[188:191], a[252:255], v[40:43], v[188:191]
v_exp_f32 v28, v28
v_mfma_f32_16x16x32_bf16 v[16:19], a[128:131], a[16:19], -4.0
ds_read_b64_tr_b16 a[216:217], v11 offset:24576
ds_read_b64_tr_b16 a[218:219], v11 offset:28672
v_mfma_f32_16x16x32_bf16 v[16:19], a[132:135], a[20:23], v[16:19]
v_exp_f32 v29, v29
v_mfma_f32_16x16x32_bf16 v[16:19], a[136:139], a[24:27], v[16:19]
ds_read_b64_tr_b16 a[220:221], v11 offset:16384
ds_read_b64_tr_b16 a[222:223], v11 offset:20480
v_mfma_f32_16x16x32_bf16 v[16:19], a[140:143], a[28:31], v[16:19]
v_exp_f32 v30, v30
v_mfma_f32_16x16x32_bf16 v[20:23], a[144:147], a[28:31], -4.0
ds_read_b64_tr_b16 a[224:225], v8 offset:17408
v_cvt_pk_bf16_f32 v38, v28, v29
v_mfma_f32_16x16x32_bf16 v[20:23], a[148:151], a[24:27], v[20:23]
v_exp_f32 v31, v31
v_mfma_f32_16x16x32_bf16 v[20:23], a[152:155], a[20:23], v[20:23]
ds_read_b64_tr_b16 a[226:227], v8 offset:21504
v_cvt_pk_bf16_f32 v39, v30, v31
v_mfma_f32_16x16x32_bf16 v[20:23], a[156:159], a[16:19], v[20:23]
v_exp_f32 v16, v16
v_mfma_f32_16x16x32_bf16 v[24:27], a[160:163], a[16:19], -4.0
ds_read_b64_tr_b16 a[228:229], v8 offset:25600
ds_read_b64_tr_b16 a[230:231], v8 offset:29696
v_mfma_f32_16x16x32_bf16 v[24:27], a[164:167], a[20:23], v[24:27]
v_exp_f32 v17, v17
v_mfma_f32_16x16x32_bf16 v[24:27], a[168:171], a[24:27], v[24:27]
ds_read_b64_tr_b16 a[232:233], v9 offset:25600
v_cvt_pk_bf16_f32 v40, v16, v17
v_mfma_f32_16x16x32_bf16 v[24:27], a[172:175], a[28:31], v[24:27]
v_exp_f32 v18, v18
v_mfma_f32_16x16x32_bf16 v[28:31], a[176:179], a[28:31], -4.0
ds_read_b64_tr_b16 a[234:235], v9 offset:29696
ds_read_b64_tr_b16 a[236:237], v9 offset:17408
v_mfma_f32_16x16x32_bf16 v[28:31], a[180:183], a[24:27], v[28:31]
v_exp_f32 v19, v19
v_mfma_f32_16x16x32_bf16 v[28:31], a[184:187], a[20:23], v[28:31]
ds_read_b64_tr_b16 a[238:239], v9 offset:21504
v_cvt_pk_bf16_f32 v41, v18, v19
v_mfma_f32_16x16x32_bf16 v[28:31], a[188:191], a[16:19], v[28:31]
v_exp_f32 v20, v20
v_smfmac_f32_16x16x64_bf16 v[48:51], v[12:15], v[32:39], v1
s_waitcnt lgkmcnt(15)
ds_read_b64_tr_b16 a[240:241], v10 offset:17408
v_mfma_f32_16x16x32_bf16 v[64:67], a[192:195], v[32:35], v[64:67]
L_pg10:
s_cbranch_vccnz L_ret
ds_read_b64_tr_b16 a[242:243], v10 offset:21504
ds_read_b64_tr_b16 a[244:245], v10 offset:25600
v_mfma_f32_16x16x32_bf16 v[64:67], a[196:199], v[36:39], v[64:67]
v_exp_f32 v21, v21
v_mfma_f32_16x16x32_bf16 v[68:71], a[200:203], v[36:39], v[68:71]
ds_read_b64_tr_b16 a[246:247], v10 offset:29696
v_cvt_pk_bf16_f32 v42, v20, v21
v_mfma_f32_16x16x32_bf16 v[68:71], a[204:207], v[32:35], v[68:71]
s_waitcnt lgkmcnt(15)
v_exp_f32 v22, v22
v_mfma_f32_16x16x32_bf16 v[72:75], a[208:211], v[32:35], v[72:75]
ds_read_b64_tr_b16 a[248:249], v11 offset:25600
ds_read_b64_tr_b16 a[250:251], v11 offset:29696
v_mfma_f32_16x16x32_bf16 v[72:75], a[212:215], v[36:39], v[72:75]
s_waitcnt lgkmcnt(14)
v_exp_f32 v23, v23
v_mfma_f32_16x16x32_bf16 v[76:79], a[216:219], v[36:39], v[76:79]
ds_read_b64_tr_b16 a[252:253], v11 offset:17408
v_cvt_pk_bf16_f32 v43, v22, v23
v_mfma_f32_16x16x32_bf16 v[76:79], a[220:223], v[32:35], v[76:79]
s_waitcnt lgkmcnt(11)
ds_read_b64_tr_b16 a[254:255], v11 offset:21504
v_exp_f32 v24, v24
v_mfma_f32_16x16x32_bf16 v[80:83], a[224:227], v[32:35], v[80:83]
v_permlane16_swap_b32 v208, v210
v_mfma_f32_16x16x32_bf16 v[80:83], a[228:231], v[36:39], v[80:83]
s_waitcnt lgkmcnt(8)
v_exp_f32 v25, v25
v_mfma_f32_16x16x32_bf16 v[84:87], a[232:235], v[36:39], v[84:87]
v_cvt_pk_bf16_f32 v44, v24, v25
v_mfma_f32_16x16x32_bf16 v[84:87], a[236:239], v[32:35], v[84:87]
s_waitcnt lgkmcnt(4)
v_exp_f32 v26, v26
v_mfma_f32_16x16x32_bf16 v[88:91], a[240:243], v[32:35], v[88:91]
v_permlane16_swap_b32 v209, v211
v_mfma_f32_16x16x32_bf16 v[88:91], a[244:247], v[36:39], v[88:91]
s_waitcnt lgkmcnt(0)
v_exp_f32 v27, v27
v_mfma_f32_16x16x32_bf16 v[92:95], a[248:251], v[36:39], v[92:95]
v_cvt_pk_bf16_f32 v45, v26, v27
v_mfma_f32_16x16x32_bf16 v[92:95], a[252:255], v[32:35], v[92:95]
v_exp_f32 v28, v28
v_mfma_f32_16x16x32_bf16 v[16:19], a[128:131], a[32:35], -4.0
s_barrier
v_mfma_f32_16x16x32_bf16 v[16:19], a[132:135], a[36:39], v[16:19]
s_add_u32 m0, s24, 0x4000
v_exp_f32 v29, v29
v_mfma_f32_16x16x32_bf16 v[16:19], a[136:139], a[40:43], v[16:19]
buffer_load_dwordx4 v2, s[16:19], s74 offen offset:0 lds
v_mfma_f32_16x16x32_bf16 v[16:19], a[140:143], a[44:47], v[16:19]
v_exp_f32 v30, v30
v_mfma_f32_16x16x32_bf16 v[20:23], a[144:147], a[44:47], -4.0
v_cvt_pk_bf16_f32 v46, v28, v29
v_mfma_f32_16x16x32_bf16 v[20:23], a[148:151], a[40:43], v[20:23]
v_exp_f32 v31, v31
v_mfma_f32_16x16x32_bf16 v[20:23], a[152:155], a[36:39], v[20:23]
v_cvt_pk_bf16_f32 v47, v30, v31
v_mfma_f32_16x16x32_bf16 v[20:23], a[156:159], a[32:35], v[20:23]
v_exp_f32 v16, v16
v_mfma_f32_16x16x32_bf16 v[24:27], a[160:163], a[32:35], -4.0
buffer_load_dwordx4 v2, s[16:19], s74 offen offset:2048 lds
v_mfma_f32_16x16x32_bf16 v[24:27], a[164:167], a[36:39], v[24:27]
s_add_u32 m0, s24, 0x6000
v_exp_f32 v17, v17
v_mfma_f32_16x16x32_bf16 v[24:27], a[168:171], a[40:43], v[24:27]
v_cvt_pk_bf16_f32 v32, v16, v17
v_mfma_f32_16x16x32_bf16 v[24:27], a[172:175], a[44:47], v[24:27]
v_exp_f32 v18, v18
v_mfma_f32_16x16x32_bf16 v[28:31], a[176:179], a[44:47], -4.0
v_permlane16_swap_b32 v212, v214
v_mfma_f32_16x16x32_bf16 v[28:31], a[180:183], a[40:43], v[28:31]
v_exp_f32 v19, v19
v_mfma_f32_16x16x32_bf16 v[28:31], a[184:187], a[36:39], v[28:31]
v_cvt_pk_bf16_f32 v33, v18, v19
v_mfma_f32_16x16x32_bf16 v[28:31], a[188:191], a[32:35], v[28:31]
v_exp_f32 v20, v20
v_smfmac_f32_16x16x64_bf16 v[52:55], v[12:15], v[40:47], v1
v_mfma_f32_16x16x32_bf16 v[96:99], a[192:195], v[40:43], v[96:99]
buffer_load_dwordx4 v2, s[16:19], s75 offen offset:0 lds
v_mfma_f32_16x16x32_bf16 v[96:99], a[196:199], v[44:47], v[96:99]
v_exp_f32 v21, v21
v_mfma_f32_16x16x32_bf16 v[100:103], a[200:203], v[44:47], v[100:103]
v_cvt_pk_bf16_f32 v34, v20, v21
v_mfma_f32_16x16x32_bf16 v[100:103], a[204:207], v[40:43], v[100:103]
v_exp_f32 v22, v22
v_mfma_f32_16x16x32_bf16 v[104:107], a[208:211], v[40:43], v[104:107]
v_permlane16_swap_b32 v213, v215
v_mfma_f32_16x16x32_bf16 v[104:107], a[212:215], v[44:47], v[104:107]
v_exp_f32 v23, v23
v_mfma_f32_16x16x32_bf16 v[108:111], a[216:219], v[44:47], v[108:111]
v_cvt_pk_bf16_f32 v35, v22, v23
v_mfma_f32_16x16x32_bf16 v[108:111], a[220:223], v[40:43], v[108:111]
v_exp_f32 v24, v24
v_mfma_f32_16x16x32_bf16 v[112:115], a[224:227], v[40:43], v[112:115]
buffer_load_dwordx4 v2, s[16:19], s75 offen offset:2048 lds
v_mfma_f32_16x16x32_bf16 v[112:115], a[228:231], v[44:47], v[112:115]
v_exp_f32 v25, v25
v_mfma_f32_16x16x32_bf16 v[116:119], a[232:235], v[44:47], v[116:119]
v_cvt_pk_bf16_f32 v36, v24, v25
v_mfma_f32_16x16x32_bf16 v[116:119], a[236:239], v[40:43], v[116:119]
v_exp_f32 v26, v26
v_mfma_f32_16x16x32_bf16 v[120:123], a[240:243], v[40:43], v[120:123]
v_permlane16_swap_b32 v216, v218
v_mfma_f32_16x16x32_bf16 v[120:123], a[244:247], v[44:47], v[120:123]
v_exp_f32 v27, v27
v_mfma_f32_16x16x32_bf16 v[124:127], a[248:251], v[44:47], v[124:127]
v_cvt_pk_bf16_f32 v37, v26, v27
v_mfma_f32_16x16x32_bf16 v[124:127], a[252:255], v[40:43], v[124:127]
v_exp_f32 v28, v28
v_mfma_f32_16x16x32_bf16 v[16:19], a[128:131], a[48:51], -4.0
ds_read_b128 a[128:131], v4 offset:32768
v_mfma_f32_16x16x32_bf16 v[16:19], a[132:135], a[52:55], v[16:19]
v_exp_f32 v29, v29
v_mfma_f32_16x16x32_bf16 v[16:19], a[136:139], a[56:59], v[16:19]
ds_read_b128 a[132:135], v5 offset:32768
v_mfma_f32_16x16x32_bf16 v[16:19], a[140:143], a[60:63], v[16:19]
v_exp_f32 v30, v30
v_mfma_f32_16x16x32_bf16 v[20:23], a[144:147], a[60:63], -4.0
ds_read_b128 a[136:139], v6 offset:32768
v_cvt_pk_bf16_f32 v38, v28, v29
v_mfma_f32_16x16x32_bf16 v[20:23], a[148:151], a[56:59], v[20:23]
v_exp_f32 v31, v31
v_mfma_f32_16x16x32_bf16 v[20:23], a[152:155], a[52:55], v[20:23]
ds_read_b128 a[140:143], v7 offset:32768
v_cvt_pk_bf16_f32 v39, v30, v31
v_mfma_f32_16x16x32_bf16 v[20:23], a[156:159], a[48:51], v[20:23]
v_exp_f32 v16, v16
v_mfma_f32_16x16x32_bf16 v[24:27], a[160:163], a[48:51], -4.0
ds_read_b128 a[144:147], v7 offset:36864
v_mfma_f32_16x16x32_bf16 v[24:27], a[164:167], a[52:55], v[24:27]
v_exp_f32 v17, v17
v_mfma_f32_16x16x32_bf16 v[24:27], a[168:171], a[56:59], v[24:27]
ds_read_b128 a[148:151], v6 offset:36864
v_cvt_pk_bf16_f32 v40, v16, v17
v_mfma_f32_16x16x32_bf16 v[24:27], a[172:175], a[60:63], v[24:27]
v_exp_f32 v18, v18
v_mfma_f32_16x16x32_bf16 v[28:31], a[176:179], a[60:63], -4.0
ds_read_b128 a[152:155], v5 offset:36864
v_mfma_f32_16x16x32_bf16 v[28:31], a[180:183], a[56:59], v[28:31]
v_exp_f32 v19, v19
v_mfma_f32_16x16x32_bf16 v[28:31], a[184:187], a[52:55], v[28:31]
ds_read_b128 a[156:159], v4 offset:36864
v_cvt_pk_bf16_f32 v41, v18, v19
v_mfma_f32_16x16x32_bf16 v[28:31], a[188:191], a[48:51], v[28:31]
v_exp_f32 v20, v20
v_smfmac_f32_16x16x64_bf16 v[56:59], v[12:15], v[32:39], v1
ds_read_b128 a[160:163], v4 offset:40960
v_mfma_f32_16x16x32_bf16 v[128:131], a[192:195], v[32:35], v[128:131]
ds_read_b128 a[164:167], v5 offset:40960
v_mfma_f32_16x16x32_bf16 v[128:131], a[196:199], v[36:39], v[128:131]
v_exp_f32 v21, v21
v_mfma_f32_16x16x32_bf16 v[132:135], a[200:203], v[36:39], v[132:135]
ds_read_b128 a[168:171], v6 offset:40960
v_cvt_pk_bf16_f32 v42, v20, v21
v_mfma_f32_16x16x32_bf16 v[132:135], a[204:207], v[32:35], v[132:135]
v_exp_f32 v22, v22
v_mfma_f32_16x16x32_bf16 v[136:139], a[208:211], v[32:35], v[136:139]
ds_read_b128 a[172:175], v7 offset:40960
v_mfma_f32_16x16x32_bf16 v[136:139], a[212:215], v[36:39], v[136:139]
v_exp_f32 v23, v23
v_mfma_f32_16x16x32_bf16 v[140:143], a[216:219], v[36:39], v[140:143]
ds_read_b128 a[176:179], v7 offset:45056
v_cvt_pk_bf16_f32 v43, v22, v23
v_mfma_f32_16x16x32_bf16 v[140:143], a[220:223], v[32:35], v[140:143]
v_exp_f32 v24, v24
v_mfma_f32_16x16x32_bf16 v[144:147], a[224:227], v[32:35], v[144:147]
buffer_store_dwordx4 v[208:211], v0, s[20:23], s36 offen offset:0 sc1
v_mfma_f32_16x16x32_bf16 v[144:147], a[228:231], v[36:39], v[144:147]
v_exp_f32 v25, v25
v_mfma_f32_16x16x32_bf16 v[148:151], a[232:235], v[36:39], v[148:151]
ds_read_b128 a[180:183], v6 offset:45056
v_cvt_pk_bf16_f32 v44, v24, v25
v_mfma_f32_16x16x32_bf16 v[148:151], a[236:239], v[32:35], v[148:151]
v_exp_f32 v26, v26
v_mfma_f32_16x16x32_bf16 v[152:155], a[240:243], v[32:35], v[152:155]
ds_read_b128 a[184:187], v5 offset:45056
v_mfma_f32_16x16x32_bf16 v[152:155], a[244:247], v[36:39], v[152:155]
v_exp_f32 v27, v27
v_mfma_f32_16x16x32_bf16 v[156:159], a[248:251], v[36:39], v[156:159]
ds_read_b128 a[188:191], v4 offset:45056
v_cvt_pk_bf16_f32 v45, v26, v27
v_mfma_f32_16x16x32_bf16 v[156:159], a[252:255], v[32:35], v[156:159]
s_waitcnt lgkmcnt(12)
v_exp_f32 v28, v28
v_mfma_f32_16x16x32_bf16 v[16:19], a[128:131], a[0:3], -4.0
v_permlane16_swap_b32 v217, v219
v_mfma_f32_16x16x32_bf16 v[16:19], a[132:135], a[4:7], v[16:19]
v_exp_f32 v29, v29
v_mfma_f32_16x16x32_bf16 v[16:19], a[136:139], a[8:11], v[16:19]
v_permlane16_swap_b32 v220, v222
v_mfma_f32_16x16x32_bf16 v[16:19], a[140:143], a[12:15], v[16:19]
s_waitcnt lgkmcnt(8)
v_exp_f32 v30, v30
v_mfma_f32_16x16x32_bf16 v[20:23], a[144:147], a[12:15], -4.0
v_cvt_pk_bf16_f32 v46, v28, v29
v_mfma_f32_16x16x32_bf16 v[20:23], a[148:151], a[8:11], v[20:23]
v_exp_f32 v31, v31
v_mfma_f32_16x16x32_bf16 v[20:23], a[152:155], a[4:7], v[20:23]
v_cvt_pk_bf16_f32 v47, v30, v31
v_mfma_f32_16x16x32_bf16 v[20:23], a[156:159], a[0:3], v[20:23]
s_waitcnt lgkmcnt(4)
v_exp_f32 v16, v16
v_mfma_f32_16x16x32_bf16 v[24:27], a[160:163], a[0:3], -4.0
v_permlane16_swap_b32 v221, v223
v_mfma_f32_16x16x32_bf16 v[24:27], a[164:167], a[4:7], v[24:27]
v_exp_f32 v17, v17
v_mfma_f32_16x16x32_bf16 v[24:27], a[168:171], a[8:11], v[24:27]
v_cvt_pk_bf16_f32 v32, v16, v17
v_mfma_f32_16x16x32_bf16 v[24:27], a[172:175], a[12:15], v[24:27]
s_waitcnt lgkmcnt(0)
v_exp_f32 v18, v18
v_mfma_f32_16x16x32_bf16 v[28:31], a[176:179], a[12:15], -4.0
buffer_store_dwordx4 v[212:215], v0, s[20:23], s36 offen offset:64 sc1
v_mfma_f32_16x16x32_bf16 v[28:31], a[180:183], a[8:11], v[28:31]
v_exp_f32 v19, v19
v_mfma_f32_16x16x32_bf16 v[28:31], a[184:187], a[4:7], v[28:31]
v_cvt_pk_bf16_f32 v33, v18, v19
v_mfma_f32_16x16x32_bf16 v[28:31], a[188:191], a[0:3], v[28:31]
s_waitcnt vmcnt(7)
v_exp_f32 v20, v20
v_smfmac_f32_16x16x64_bf16 v[60:63], v[12:15], v[40:47], v1
s_barrier
v_mfma_f32_16x16x32_bf16 v[160:163], a[192:195], v[40:43], v[160:163]
ds_read_b64_tr_b16 a[192:193], v8 offset:0
ds_read_b64_tr_b16 a[194:195], v8 offset:4096
v_mfma_f32_16x16x32_bf16 v[160:163], a[196:199], v[44:47], v[160:163]
v_exp_f32 v21, v21
v_mfma_f32_16x16x32_bf16 v[164:167], a[200:203], v[44:47], v[164:167]
ds_read_b64_tr_b16 a[196:197], v8 offset:8192
v_cvt_pk_bf16_f32 v34, v20, v21
v_mfma_f32_16x16x32_bf16 v[164:167], a[204:207], v[40:43], v[164:167]
v_exp_f32 v22, v22
v_mfma_f32_16x16x32_bf16 v[168:171], a[208:211], v[40:43], v[168:171]
ds_read_b64_tr_b16 a[198:199], v8 offset:12288
ds_read_b64_tr_b16 a[200:201], v9 offset:8192
v_mfma_f32_16x16x32_bf16 v[168:171], a[212:215], v[44:47], v[168:171]
v_exp_f32 v23, v23
v_mfma_f32_16x16x32_bf16 v[172:175], a[216:219], v[44:47], v[172:175]
ds_read_b64_tr_b16 a[202:203], v9 offset:12288
v_cvt_pk_bf16_f32 v35, v22, v23
v_mfma_f32_16x16x32_bf16 v[172:175], a[220:223], v[40:43], v[172:175]
v_exp_f32 v24, v24
v_mfma_f32_16x16x32_bf16 v[176:179], a[224:227], v[40:43], v[176:179]
ds_read_b64_tr_b16 a[204:205], v9 offset:0
ds_read_b64_tr_b16 a[206:207], v9 offset:4096
v_mfma_f32_16x16x32_bf16 v[176:179], a[228:231], v[44:47], v[176:179]
v_exp_f32 v25, v25
v_mfma_f32_16x16x32_bf16 v[180:183], a[232:235], v[44:47], v[180:183]
ds_read_b64_tr_b16 a[208:209], v10 offset:0
v_cvt_pk_bf16_f32 v36, v24, v25
v_mfma_f32_16x16x32_bf16 v[180:183], a[236:239], v[40:43], v[180:183]
v_exp_f32 v26, v26
v_mfma_f32_16x16x32_bf16 v[184:187], a[240:243], v[40:43], v[184:187]
ds_read_b64_tr_b16 a[210:211], v10 offset:4096
ds_read_b64_tr_b16 a[212:213], v10 offset:8192
v_mfma_f32_16x16x32_bf16 v[184:187], a[244:247], v[44:47], v[184:187]
v_exp_f32 v27, v27
v_mfma_f32_16x16x32_bf16 v[188:191], a[248:251], v[44:47], v[188:191]
ds_read_b64_tr_b16 a[214:215], v10 offset:12288
v_cvt_pk_bf16_f32 v37, v26, v27
v_mfma_f32_16x16x32_bf16 v[188:191], a[252:255], v[40:43], v[188:191]
v_exp_f32 v28, v28
v_mfma_f32_16x16x32_bf16 v[16:19], a[128:131], a[16:19], -4.0
ds_read_b64_tr_b16 a[216:217], v11 offset:8192
ds_read_b64_tr_b16 a[218:219], v11 offset:12288
v_mfma_f32_16x16x32_bf16 v[16:19], a[132:135], a[20:23], v[16:19]
v_exp_f32 v29, v29
v_mfma_f32_16x16x32_bf16 v[16:19], a[136:139], a[24:27], v[16:19]
ds_read_b64_tr_b16 a[220:221], v11 offset:0
ds_read_b64_tr_b16 a[222:223], v11 offset:4096
v_mfma_f32_16x16x32_bf16 v[16:19], a[140:143], a[28:31], v[16:19]
v_exp_f32 v30, v30
v_mfma_f32_16x16x32_bf16 v[20:23], a[144:147], a[28:31], -4.0
ds_read_b64_tr_b16 a[224:225], v8 offset:1024
v_cvt_pk_bf16_f32 v38, v28, v29
v_mfma_f32_16x16x32_bf16 v[20:23], a[148:151], a[24:27], v[20:23]
v_exp_f32 v31, v31
v_mfma_f32_16x16x32_bf16 v[20:23], a[152:155], a[20:23], v[20:23]
ds_read_b64_tr_b16 a[226:227], v8 offset:5120
v_cvt_pk_bf16_f32 v39, v30, v31
v_mfma_f32_16x16x32_bf16 v[20:23], a[156:159], a[16:19], v[20:23]
v_exp_f32 v16, v16
v_mfma_f32_16x16x32_bf16 v[24:27], a[160:163], a[16:19], -4.0
ds_read_b64_tr_b16 a[228:229], v8 offset:9216
ds_read_b64_tr_b16 a[230:231], v8 offset:13312
v_mfma_f32_16x16x32_bf16 v[24:27], a[164:167], a[20:23], v[24:27]
v_exp_f32 v17, v17
v_mfma_f32_16x16x32_bf16 v[24:27], a[168:171], a[24:27], v[24:27]
ds_read_b64_tr_b16 a[232:233], v9 offset:9216
v_cvt_pk_bf16_f32 v40, v16, v17
v_mfma_f32_16x16x32_bf16 v[24:27], a[172:175], a[28:31], v[24:27]
v_exp_f32 v18, v18
v_mfma_f32_16x16x32_bf16 v[28:31], a[176:179], a[28:31], -4.0
ds_read_b64_tr_b16 a[234:235], v9 offset:13312
ds_read_b64_tr_b16 a[236:237], v9 offset:1024
v_mfma_f32_16x16x32_bf16 v[28:31], a[180:183], a[24:27], v[28:31]
v_exp_f32 v19, v19
v_mfma_f32_16x16x32_bf16 v[28:31], a[184:187], a[20:23], v[28:31]
ds_read_b64_tr_b16 a[238:239], v9 offset:5120
v_cvt_pk_bf16_f32 v41, v18, v19
v_mfma_f32_16x16x32_bf16 v[28:31], a[188:191], a[16:19], v[28:31]
v_exp_f32 v20, v20
v_smfmac_f32_16x16x64_bf16 v[48:51], v[12:15], v[32:39], v1
s_waitcnt lgkmcnt(15)
ds_read_b64_tr_b16 a[240:241], v10 offset:1024
v_mfma_f32_16x16x32_bf16 v[64:67], a[192:195], v[32:35], v[64:67]
ds_read_b64_tr_b16 a[242:243], v10 offset:5120
ds_read_b64_tr_b16 a[244:245], v10 offset:9216
v_mfma_f32_16x16x32_bf16 v[64:67], a[196:199], v[36:39], v[64:67]
v_exp_f32 v21, v21
v_mfma_f32_16x16x32_bf16 v[68:71], a[200:203], v[36:39], v[68:71]
ds_read_b64_tr_b16 a[246:247], v10 offset:13312
v_cvt_pk_bf16_f32 v42, v20, v21
v_mfma_f32_16x16x32_bf16 v[68:71], a[204:207], v[32:35], v[68:71]
s_waitcnt lgkmcnt(15)
v_exp_f32 v22, v22
v_mfma_f32_16x16x32_bf16 v[72:75], a[208:211], v[32:35], v[72:75]
ds_read_b64_tr_b16 a[248:249], v11 offset:9216
ds_read_b64_tr_b16 a[250:251], v11 offset:13312
v_mfma_f32_16x16x32_bf16 v[72:75], a[212:215], v[36:39], v[72:75]
s_waitcnt lgkmcnt(14)
v_exp_f32 v23, v23
v_mfma_f32_16x16x32_bf16 v[76:79], a[216:219], v[36:39], v[76:79]
ds_read_b64_tr_b16 a[252:253], v11 offset:1024
v_cvt_pk_bf16_f32 v43, v22, v23
v_mfma_f32_16x16x32_bf16 v[76:79], a[220:223], v[32:35], v[76:79]
s_waitcnt lgkmcnt(11)
ds_read_b64_tr_b16 a[254:255], v11 offset:5120
v_exp_f32 v24, v24
v_mfma_f32_16x16x32_bf16 v[80:83], a[224:227], v[32:35], v[80:83]
buffer_store_dwordx4 v[216:219], v0, s[20:23], s36 offen offset:128 sc1
v_mfma_f32_16x16x32_bf16 v[80:83], a[228:231], v[36:39], v[80:83]
s_waitcnt lgkmcnt(8)
v_exp_f32 v25, v25
v_mfma_f32_16x16x32_bf16 v[84:87], a[232:235], v[36:39], v[84:87]
v_cvt_pk_bf16_f32 v44, v24, v25
v_mfma_f32_16x16x32_bf16 v[84:87], a[236:239], v[32:35], v[84:87]
s_waitcnt lgkmcnt(4)
v_exp_f32 v26, v26
v_mfma_f32_16x16x32_bf16 v[88:91], a[240:243], v[32:35], v[88:91]
v_permlane16_swap_b32 v224, v226
v_mfma_f32_16x16x32_bf16 v[88:91], a[244:247], v[36:39], v[88:91]
s_waitcnt lgkmcnt(0)
v_exp_f32 v27, v27
v_mfma_f32_16x16x32_bf16 v[92:95], a[248:251], v[36:39], v[92:95]
v_cvt_pk_bf16_f32 v45, v26, v27
v_mfma_f32_16x16x32_bf16 v[92:95], a[252:255], v[32:35], v[92:95]
v_exp_f32 v28, v28
v_mfma_f32_16x16x32_bf16 v[16:19], a[128:131], a[32:35], -4.0
s_barrier
v_mfma_f32_16x16x32_bf16 v[16:19], a[132:135], a[36:39], v[16:19]
s_add_u32 m0, s24, 0x0
v_exp_f32 v29, v29
v_mfma_f32_16x16x32_bf16 v[16:19], a[136:139], a[40:43], v[16:19]
buffer_load_dwordx4 v2, s[16:19], s76 offen offset:0 lds
v_mfma_f32_16x16x32_bf16 v[16:19], a[140:143], a[44:47], v[16:19]
v_exp_f32 v30, v30
v_mfma_f32_16x16x32_bf16 v[20:23], a[144:147], a[44:47], -4.0
v_cvt_pk_bf16_f32 v46, v28, v29
v_mfma_f32_16x16x32_bf16 v[20:23], a[148:151], a[40:43], v[20:23]
v_exp_f32 v31, v31
v_mfma_f32_16x16x32_bf16 v[20:23], a[152:155], a[36:39], v[20:23]
v_cvt_pk_bf16_f32 v47, v30, v31
v_mfma_f32_16x16x32_bf16 v[20:23], a[156:159], a[32:35], v[20:23]
v_exp_f32 v16, v16
v_mfma_f32_16x16x32_bf16 v[24:27], a[160:163], a[32:35], -4.0
buffer_load_dwordx4 v2, s[16:19], s76 offen offset:2048 lds
v_mfma_f32_16x16x32_bf16 v[24:27], a[164:167], a[36:39], v[24:27]
s_add_u32 m0, s24, 0x2000
v_exp_f32 v17, v17
v_mfma_f32_16x16x32_bf16 v[24:27], a[168:171], a[40:43], v[24:27]
v_cvt_pk_bf16_f32 v32, v16, v17
v_mfma_f32_16x16x32_bf16 v[24:27], a[172:175], a[44:47], v[24:27]
v_exp_f32 v18, v18
v_mfma_f32_16x16x32_bf16 v[28:31], a[176:179], a[44:47], -4.0
v_permlane16_swap_b32 v225, v227
v_mfma_f32_16x16x32_bf16 v[28:31], a[180:183], a[40:43], v[28:31]
v_exp_f32 v19, v19
v_mfma_f32_16x16x32_bf16 v[28:31], a[184:187], a[36:39], v[28:31]
v_cvt_pk_bf16_f32 v33, v18, v19
v_mfma_f32_16x16x32_bf16 v[28:31], a[188:191], a[32:35], v[28:31]
v_exp_f32 v20, v20
v_smfmac_f32_16x16x64_bf16 v[52:55], v[12:15], v[40:47], v1
v_mfma_f32_16x16x32_bf16 v[96:99], a[192:195], v[40:43], v[96:99]
buffer_load_dwordx4 v2, s[16:19], s77 offen offset:0 lds
v_mfma_f32_16x16x32_bf16 v[96:99], a[196:199], v[44:47], v[96:99]
v_exp_f32 v21, v21
v_mfma_f32_16x16x32_bf16 v[100:103], a[200:203], v[44:47], v[100:103]
v_cvt_pk_bf16_f32 v34, v20, v21
v_mfma_f32_16x16x32_bf16 v[100:103], a[204:207], v[40:43], v[100:103]
v_exp_f32 v22, v22
v_mfma_f32_16x16x32_bf16 v[104:107], a[208:211], v[40:43], v[104:107]
v_permlane16_swap_b32 v228, v230
v_mfma_f32_16x16x32_bf16 v[104:107], a[212:215], v[44:47], v[104:107]
v_exp_f32 v23, v23
v_mfma_f32_16x16x32_bf16 v[108:111], a[216:219], v[44:47], v[108:111]
v_cvt_pk_bf16_f32 v35, v22, v23
v_mfma_f32_16x16x32_bf16 v[108:111], a[220:223], v[40:43], v[108:111]
v_exp_f32 v24, v24
v_mfma_f32_16x16x32_bf16 v[112:115], a[224:227], v[40:43], v[112:115]
buffer_load_dwordx4 v2, s[16:19], s77 offen offset:2048 lds
v_mfma_f32_16x16x32_bf16 v[112:115], a[228:231], v[44:47], v[112:115]
v_exp_f32 v25, v25
v_mfma_f32_16x16x32_bf16 v[116:119], a[232:235], v[44:47], v[116:119]
v_cvt_pk_bf16_f32 v36, v24, v25
v_mfma_f32_16x16x32_bf16 v[116:119], a[236:239], v[40:43], v[116:119]
v_exp_f32 v26, v26
v_mfma_f32_16x16x32_bf16 v[120:123], a[240:243], v[40:43], v[120:123]
v_permlane16_swap_b32 v229, v231
v_mfma_f32_16x16x32_bf16 v[120:123], a[244:247], v[44:47], v[120:123]
v_exp_f32 v27, v27
v_mfma_f32_16x16x32_bf16 v[124:127], a[248:251], v[44:47], v[124:127]
v_cvt_pk_bf16_f32 v37, v26, v27
v_mfma_f32_16x16x32_bf16 v[124:127], a[252:255], v[40:43], v[124:127]
v_exp_f32 v28, v28
v_mfma_f32_16x16x32_bf16 v[16:19], a[128:131], a[48:51], -4.0
buffer_store_dwordx4 v[220:223], v0, s[20:23], s36 offen offset:192 sc1
v_mfma_f32_16x16x32_bf16 v[16:19], a[132:135], a[52:55], v[16:19]
v_exp_f32 v29, v29
v_mfma_f32_16x16x32_bf16 v[16:19], a[136:139], a[56:59], v[16:19]
ds_read_b128 a[128:131], v4 offset:49152
v_mfma_f32_16x16x32_bf16 v[16:19], a[140:143], a[60:63], v[16:19]
v_exp_f32 v30, v30
v_mfma_f32_16x16x32_bf16 v[20:23], a[144:147], a[60:63], -4.0
ds_read_b128 a[132:135], v5 offset:49152
v_cvt_pk_bf16_f32 v38, v28, v29
v_mfma_f32_16x16x32_bf16 v[20:23], a[148:151], a[56:59], v[20:23]
v_exp_f32 v31, v31
v_mfma_f32_16x16x32_bf16 v[20:23], a[152:155], a[52:55], v[20:23]
ds_read_b128 a[136:139], v6 offset:49152
v_cvt_pk_bf16_f32 v39, v30, v31
v_mfma_f32_16x16x32_bf16 v[20:23], a[156:159], a[48:51], v[20:23]
v_exp_f32 v16, v16
v_mfma_f32_16x16x32_bf16 v[24:27], a[160:163], a[48:51], -4.0
ds_read_b128 a[140:143], v7 offset:49152
v_mfma_f32_16x16x32_bf16 v[24:27], a[164:167], a[52:55], v[24:27]
v_exp_f32 v17, v17
v_mfma_f32_16x16x32_bf16 v[24:27], a[168:171], a[56:59], v[24:27]
ds_read_b128 a[144:147], v7 offset:53248
v_cvt_pk_bf16_f32 v40, v16, v17
v_mfma_f32_16x16x32_bf16 v[24:27], a[172:175], a[60:63], v[24:27]
v_exp_f32 v18, v18
v_mfma_f32_16x16x32_bf16 v[28:31], a[176:179], a[60:63], -4.0
ds_read_b128 a[148:151], v6 offset:53248
v_mfma_f32_16x16x32_bf16 v[28:31], a[180:183], a[56:59], v[28:31]
v_exp_f32 v19, v19
v_mfma_f32_16x16x32_bf16 v[28:31], a[184:187], a[52:55], v[28:31]
ds_read_b128 a[152:155], v5 offset:53248
v_cvt_pk_bf16_f32 v41, v18, v19
v_mfma_f32_16x16x32_bf16 v[28:31], a[188:191], a[48:51], v[28:31]
v_exp_f32 v20, v20
v_smfmac_f32_16x16x64_bf16 v[56:59], v[12:15], v[32:39], v1
ds_read_b128 a[156:159], v4 offset:53248
v_mfma_f32_16x16x32_bf16 v[128:131], a[192:195], v[32:35], v[128:131]
ds_read_b128 a[160:163], v4 offset:57344
v_mfma_f32_16x16x32_bf16 v[128:131], a[196:199], v[36:39], v[128:131]
v_exp_f32 v21, v21
v_mfma_f32_16x16x32_bf16 v[132:135], a[200:203], v[36:39], v[132:135]
ds_read_b128 a[164:167], v5 offset:57344
v_cvt_pk_bf16_f32 v42, v20, v21
v_mfma_f32_16x16x32_bf16 v[132:135], a[204:207], v[32:35], v[132:135]
v_exp_f32 v22, v22
v_mfma_f32_16x16x32_bf16 v[136:139], a[208:211], v[32:35], v[136:139]
ds_read_b128 a[168:171], v6 offset:57344
v_mfma_f32_16x16x32_bf16 v[136:139], a[212:215], v[36:39], v[136:139]
v_exp_f32 v23, v23
v_mfma_f32_16x16x32_bf16 v[140:143], a[216:219], v[36:39], v[140:143]
ds_read_b128 a[172:175], v7 offset:57344
v_cvt_pk_bf16_f32 v43, v22, v23
v_mfma_f32_16x16x32_bf16 v[140:143], a[220:223], v[32:35], v[140:143]
v_exp_f32 v24, v24
v_mfma_f32_16x16x32_bf16 v[144:147], a[224:227], v[32:35], v[144:147]
ds_read_b128 a[176:179], v7 offset:61440
v_mfma_f32_16x16x32_bf16 v[144:147], a[228:231], v[36:39], v[144:147]
v_exp_f32 v25, v25
v_mfma_f32_16x16x32_bf16 v[148:151], a[232:235], v[36:39], v[148:151]
ds_read_b128 a[180:183], v6 offset:61440
v_cvt_pk_bf16_f32 v44, v24, v25
v_mfma_f32_16x16x32_bf16 v[148:151], a[236:239], v[32:35], v[148:151]
v_exp_f32 v26, v26
v_mfma_f32_16x16x32_bf16 v[152:155], a[240:243], v[32:35], v[152:155]
ds_read_b128 a[184:187], v5 offset:61440
v_mfma_f32_16x16x32_bf16 v[152:155], a[244:247], v[36:39], v[152:155]
v_exp_f32 v27, v27
v_mfma_f32_16x16x32_bf16 v[156:159], a[248:251], v[36:39], v[156:159]
ds_read_b128 a[188:191], v4 offset:61440
v_cvt_pk_bf16_f32 v45, v26, v27
v_mfma_f32_16x16x32_bf16 v[156:159], a[252:255], v[32:35], v[156:159]
s_waitcnt lgkmcnt(12)
v_exp_f32 v28, v28
v_mfma_f32_16x16x32_bf16 v[16:19], a[128:131], a[0:3], -4.0
buffer_store_dwordx4 v[224:227], v0, s[20:23], s37 offen offset:0 sc1
v_mfma_f32_16x16x32_bf16 v[16:19], a[132:135], a[4:7], v[16:19]
v_exp_f32 v29, v29
v_mfma_f32_16x16x32_bf16 v[16:19], a[136:139], a[8:11], v[16:19]
v_permlane16_swap_b32 v232, v234
v_mfma_f32_16x16x32_bf16 v[16:19], a[140:143], a[12:15], v[16:19]
s_waitcnt lgkmcnt(8)
v_exp_f32 v30, v30
v_mfma_f32_16x16x32_bf16 v[20:23], a[144:147], a[12:15], -4.0
v_cvt_pk_bf16_f32 v46, v28, v29
v_mfma_f32_16x16x32_bf16 v[20:23], a[148:151], a[8:11], v[20:23]
v_exp_f32 v31, v31
v_mfma_f32_16x16x32_bf16 v[20:23], a[152:155], a[4:7], v[20:23]
v_cvt_pk_bf16_f32 v47, v30, v31
v_mfma_f32_16x16x32_bf16 v[20:23], a[156:159], a[0:3], v[20:23]
s_waitcnt lgkmcnt(4)
v_exp_f32 v16, v16
v_mfma_f32_16x16x32_bf16 v[24:27], a[160:163], a[0:3], -4.0
v_permlane16_swap_b32 v233, v235
v_mfma_f32_16x16x32_bf16 v[24:27], a[164:167], a[4:7], v[24:27]
v_exp_f32 v17, v17
v_mfma_f32_16x16x32_bf16 v[24:27], a[168:171], a[8:11], v[24:27]
v_cvt_pk_bf16_f32 v32, v16, v17
v_mfma_f32_16x16x32_bf16 v[24:27], a[172:175], a[12:15], v[24:27]
s_waitcnt lgkmcnt(0)
v_exp_f32 v18, v18
v_mfma_f32_16x16x32_bf16 v[28:31], a[176:179], a[12:15], -4.0
v_permlane16_swap_b32 v236, v238
v_mfma_f32_16x16x32_bf16 v[28:31], a[180:183], a[8:11], v[28:31]
v_exp_f32 v19, v19
v_mfma_f32_16x16x32_bf16 v[28:31], a[184:187], a[4:7], v[28:31]
v_cvt_pk_bf16_f32 v33, v18, v19
v_mfma_f32_16x16x32_bf16 v[28:31], a[188:191], a[0:3], v[28:31]
s_waitcnt vmcnt(9)
v_exp_f32 v20, v20
v_smfmac_f32_16x16x64_bf16 v[60:63], v[12:15], v[40:47], v1
s_barrier
v_mfma_f32_16x16x32_bf16 v[160:163], a[192:195], v[40:43], v[160:163]
ds_read_b64_tr_b16 a[192:193], v8 offset:16384
ds_read_b64_tr_b16 a[194:195], v8 offset:20480
v_mfma_f32_16x16x32_bf16 v[160:163], a[196:199], v[44:47], v[160:163]
v_exp_f32 v21, v21
v_mfma_f32_16x16x32_bf16 v[164:167], a[200:203], v[44:47], v[164:167]
ds_read_b64_tr_b16 a[196:197], v8 offset:24576
v_cvt_pk_bf16_f32 v34, v20, v21
v_mfma_f32_16x16x32_bf16 v[164:167], a[204:207], v[40:43], v[164:167]
v_exp_f32 v22, v22
v_mfma_f32_16x16x32_bf16 v[168:171], a[208:211], v[40:43], v[168:171]
ds_read_b64_tr_b16 a[198:199], v8 offset:28672
ds_read_b64_tr_b16 a[200:201], v9 offset:24576
v_mfma_f32_16x16x32_bf16 v[168:171], a[212:215], v[44:47], v[168:171]
v_exp_f32 v23, v23
v_mfma_f32_16x16x32_bf16 v[172:175], a[216:219], v[44:47], v[172:175]
ds_read_b64_tr_b16 a[202:203], v9 offset:28672
v_cvt_pk_bf16_f32 v35, v22, v23
v_mfma_f32_16x16x32_bf16 v[172:175], a[220:223], v[40:43], v[172:175]
v_exp_f32 v24, v24
v_mfma_f32_16x16x32_bf16 v[176:179], a[224:227], v[40:43], v[176:179]
ds_read_b64_tr_b16 a[204:205], v9 offset:16384
ds_read_b64_tr_b16 a[206:207], v9 offset:20480
v_mfma_f32_16x16x32_bf16 v[176:179], a[228:231], v[44:47], v[176:179]
v_exp_f32 v25, v25
v_mfma_f32_16x16x32_bf16 v[180:183], a[232:235], v[44:47], v[180:183]
ds_read_b64_tr_b16 a[208:209], v10 offset:16384
v_cvt_pk_bf16_f32 v36, v24, v25
v_mfma_f32_16x16x32_bf16 v[180:183], a[236:239], v[40:43], v[180:183]
v_exp_f32 v26, v26
v_mfma_f32_16x16x32_bf16 v[184:187], a[240:243], v[40:43], v[184:187]
ds_read_b64_tr_b16 a[210:211], v10 offset:20480
ds_read_b64_tr_b16 a[212:213], v10 offset:24576
v_mfma_f32_16x16x32_bf16 v[184:187], a[244:247], v[44:47], v[184:187]
v_exp_f32 v27, v27
v_mfma_f32_16x16x32_bf16 v[188:191], a[248:251], v[44:47], v[188:191]
ds_read_b64_tr_b16 a[214:215], v10 offset:28672
v_cvt_pk_bf16_f32 v37, v26, v27
v_mfma_f32_16x16x32_bf16 v[188:191], a[252:255], v[40:43], v[188:191]
v_exp_f32 v28, v28
v_mfma_f32_16x16x32_bf16 v[16:19], a[128:131], a[16:19], -4.0
ds_read_b64_tr_b16 a[216:217], v11 offset:24576
ds_read_b64_tr_b16 a[218:219], v11 offset:28672
v_mfma_f32_16x16x32_bf16 v[16:19], a[132:135], a[20:23], v[16:19]
v_exp_f32 v29, v29
v_mfma_f32_16x16x32_bf16 v[16:19], a[136:139], a[24:27], v[16:19]
ds_read_b64_tr_b16 a[220:221], v11 offset:16384
ds_read_b64_tr_b16 a[222:223], v11 offset:20480
v_mfma_f32_16x16x32_bf16 v[16:19], a[140:143], a[28:31], v[16:19]
v_exp_f32 v30, v30
v_mfma_f32_16x16x32_bf16 v[20:23], a[144:147], a[28:31], -4.0
ds_read_b64_tr_b16 a[224:225], v8 offset:17408
v_cvt_pk_bf16_f32 v38, v28, v29
v_mfma_f32_16x16x32_bf16 v[20:23], a[148:151], a[24:27], v[20:23]
v_exp_f32 v31, v31
v_mfma_f32_16x16x32_bf16 v[20:23], a[152:155], a[20:23], v[20:23]
ds_read_b64_tr_b16 a[226:227], v8 offset:21504
v_cvt_pk_bf16_f32 v39, v30, v31
v_mfma_f32_16x16x32_bf16 v[20:23], a[156:159], a[16:19], v[20:23]
v_exp_f32 v16, v16
v_mfma_f32_16x16x32_bf16 v[24:27], a[160:163], a[16:19], -4.0
ds_read_b64_tr_b16 a[228:229], v8 offset:25600
ds_read_b64_tr_b16 a[230:231], v8 offset:29696
v_mfma_f32_16x16x32_bf16 v[24:27], a[164:167], a[20:23], v[24:27]
v_exp_f32 v17, v17
v_mfma_f32_16x16x32_bf16 v[24:27], a[168:171], a[24:27], v[24:27]
L_pg11:
s_cbranch_vccnz L_ret
ds_read_b64_tr_b16 a[232:233], v9 offset:25600
v_cvt_pk_bf16_f32 v40, v16, v17
v_mfma_f32_16x16x32_bf16 v[24:27], a[172:175], a[28:31], v[24:27]
v_exp_f32 v18, v18
v_mfma_f32_16x16x32_bf16 v[28:31], a[176:179], a[28:31], -4.0
ds_read_b64_tr_b16 a[234:235], v9 offset:29696
ds_read_b64_tr_b16 a[236:237], v9 offset:17408
v_mfma_f32_16x16x32_bf16 v[28:31], a[180:183], a[24:27], v[28:31]
v_exp_f32 v19, v19
v_mfma_f32_16x16x32_bf16 v[28:31], a[184:187], a[20:23], v[28:31]
ds_read_b64_tr_b16 a[238:239], v9 offset:21504
v_cvt_pk_bf16_f32 v41, v18, v19
v_mfma_f32_16x16x32_bf16 v[28:31], a[188:191], a[16:19], v[28:31]
v_exp_f32 v20, v20
v_smfmac_f32_16x16x64_bf16 v[48:51], v[12:15], v[32:39], v1
s_waitcnt lgkmcnt(15)
ds_read_b64_tr_b16 a[240:241], v10 offset:17408
v_mfma_f32_16x16x32_bf16 v[64:67], a[192:195], v[32:35], v[64:67]
ds_read_b64_tr_b16 a[242:243], v10 offset:21504
ds_read_b64_tr_b16 a[244:245], v10 offset:25600
v_mfma_f32_16x16x32_bf16 v[64:67], a[196:199], v[36:39], v[64:67]
v_exp_f32 v21, v21
v_mfma_f32_16x16x32_bf16 v[68:71], a[200:203], v[36:39], v[68:71]
ds_read_b64_tr_b16 a[246:247], v10 offset:29696
v_cvt_pk_bf16_f32 v42, v20, v21
v_mfma_f32_16x16x32_bf16 v[68:71], a[204:207], v[32:35], v[68:71]
s_waitcnt lgkmcnt(15)
v_exp_f32 v22, v22
v_mfma_f32_16x16x32_bf16 v[72:75], a[208:211], v[32:35], v[72:75]
ds_read_b64_tr_b16 a[248:249], v11 offset:25600
ds_read_b64_tr_b16 a[250:251], v11 offset:29696
v_mfma_f32_16x16x32_bf16 v[72:75], a[212:215], v[36:39], v[72:75]
s_waitcnt lgkmcnt(14)
v_exp_f32 v23, v23
v_mfma_f32_16x16x32_bf16 v[76:79], a[216:219], v[36:39], v[76:79]
ds_read_b64_tr_b16 a[252:253], v11 offset:17408
v_cvt_pk_bf16_f32 v43, v22, v23
v_mfma_f32_16x16x32_bf16 v[76:79], a[220:223], v[32:35], v[76:79]
s_waitcnt lgkmcnt(11)
ds_read_b64_tr_b16 a[254:255], v11 offset:21504
v_exp_f32 v24, v24
v_mfma_f32_16x16x32_bf16 v[80:83], a[224:227], v[32:35], v[80:83]
buffer_store_dwordx4 v[228:231], v0, s[20:23], s37 offen offset:64 sc1
v_mfma_f32_16x16x32_bf16 v[80:83], a[228:231], v[36:39], v[80:83]
s_waitcnt lgkmcnt(8)
v_exp_f32 v25, v25
v_mfma_f32_16x16x32_bf16 v[84:87], a[232:235], v[36:39], v[84:87]
v_cvt_pk_bf16_f32 v44, v24, v25
v_add_u32 v4, 0x10000, v4
v_mfma_f32_16x16x32_bf16 v[84:87], a[236:239], v[32:35], v[84:87]
s_waitcnt lgkmcnt(4)
v_exp_f32 v26, v26
v_mfma_f32_16x16x32_bf16 v[88:91], a[240:243], v[32:35], v[88:91]
v_add_u32 v5, 0x10000, v5
v_add_u32 v6, 0x10000, v6
v_mfma_f32_16x16x32_bf16 v[88:91], a[244:247], v[36:39], v[88:91]
s_waitcnt lgkmcnt(0)
v_exp_f32 v27, v27
v_mfma_f32_16x16x32_bf16 v[92:95], a[248:251], v[36:39], v[92:95]
v_cvt_pk_bf16_f32 v45, v26, v27
v_add_u32 v7, 0x10000, v7
v_mfma_f32_16x16x32_bf16 v[92:95], a[252:255], v[32:35], v[92:95]
v_exp_f32 v28, v28
v_mfma_f32_16x16x32_bf16 v[16:19], a[128:131], a[32:35], -4.0
s_barrier
v_mfma_f32_16x16x32_bf16 v[16:19], a[132:135], a[36:39], v[16:19]
s_add_u32 m0, s24, 0x4000
v_exp_f32 v29, v29
v_mfma_f32_16x16x32_bf16 v[16:19], a[136:139], a[40:43], v[16:19]
buffer_load_dwordx4 v2, s[16:19], s78 offen offset:0 lds
v_mfma_f32_16x16x32_bf16 v[16:19], a[140:143], a[44:47], v[16:19]
v_exp_f32 v30, v30
v_mfma_f32_16x16x32_bf16 v[20:23], a[144:147], a[44:47], -4.0
v_cvt_pk_bf16_f32 v46, v28, v29
v_mfma_f32_16x16x32_bf16 v[20:23], a[148:151], a[40:43], v[20:23]
v_exp_f32 v31, v31
v_mfma_f32_16x16x32_bf16 v[20:23], a[152:155], a[36:39], v[20:23]
v_cvt_pk_bf16_f32 v47, v30, v31
v_mfma_f32_16x16x32_bf16 v[20:23], a[156:159], a[32:35], v[20:23]
v_exp_f32 v16, v16
v_mfma_f32_16x16x32_bf16 v[24:27], a[160:163], a[32:35], -4.0
buffer_load_dwordx4 v2, s[16:19], s78 offen offset:2048 lds
v_mfma_f32_16x16x32_bf16 v[24:27], a[164:167], a[36:39], v[24:27]
s_add_u32 m0, s24, 0x6000
v_exp_f32 v17, v17
v_mfma_f32_16x16x32_bf16 v[24:27], a[168:171], a[40:43], v[24:27]
v_cvt_pk_bf16_f32 v32, v16, v17
v_mfma_f32_16x16x32_bf16 v[24:27], a[172:175], a[44:47], v[24:27]
v_exp_f32 v18, v18
v_mfma_f32_16x16x32_bf16 v[28:31], a[176:179], a[44:47], -4.0
v_permlane16_swap_b32 v237, v239
v_mfma_f32_16x16x32_bf16 v[28:31], a[180:183], a[40:43], v[28:31]
v_exp_f32 v19, v19
v_mfma_f32_16x16x32_bf16 v[28:31], a[184:187], a[36:39], v[28:31]
v_cvt_pk_bf16_f32 v33, v18, v19
v_mfma_f32_16x16x32_bf16 v[28:31], a[188:191], a[32:35], v[28:31]
v_exp_f32 v20, v20
v_smfmac_f32_16x16x64_bf16 v[52:55], v[12:15], v[40:47], v1
v_mfma_f32_16x16x32_bf16 v[96:99], a[192:195], v[40:43], v[96:99]
buffer_store_dwordx4 v[232:235], v0, s[20:23], s37 offen offset:128 sc1
v_mfma_f32_16x16x32_bf16 v[96:99], a[196:199], v[44:47], v[96:99]
v_exp_f32 v21, v21
v_mfma_f32_16x16x32_bf16 v[100:103], a[200:203], v[44:47], v[100:103]
v_cvt_pk_bf16_f32 v34, v20, v21
v_mfma_f32_16x16x32_bf16 v[100:103], a[204:207], v[40:43], v[100:103]
v_exp_f32 v22, v22
v_mfma_f32_16x16x32_bf16 v[104:107], a[208:211], v[40:43], v[104:107]
v_permlane16_swap_b32 v240, v242
v_mfma_f32_16x16x32_bf16 v[104:107], a[212:215], v[44:47], v[104:107]
v_exp_f32 v23, v23
v_mfma_f32_16x16x32_bf16 v[108:111], a[216:219], v[44:47], v[108:111]
v_cvt_pk_bf16_f32 v35, v22, v23
v_mfma_f32_16x16x32_bf16 v[108:111], a[220:223], v[40:43], v[108:111]
v_exp_f32 v24, v24
v_mfma_f32_16x16x32_bf16 v[112:115], a[224:227], v[40:43], v[112:115]
buffer_load_dwordx4 v2, s[16:19], s79 offen offset:0 lds
v_mfma_f32_16x16x32_bf16 v[112:115], a[228:231], v[44:47], v[112:115]
v_exp_f32 v25, v25
v_mfma_f32_16x16x32_bf16 v[116:119], a[232:235], v[44:47], v[116:119]
v_cvt_pk_bf16_f32 v36, v24, v25
v_mfma_f32_16x16x32_bf16 v[116:119], a[236:239], v[40:43], v[116:119]
v_exp_f32 v26, v26
v_mfma_f32_16x16x32_bf16 v[120:123], a[240:243], v[40:43], v[120:123]
v_permlane16_swap_b32 v241, v243
v_mfma_f32_16x16x32_bf16 v[120:123], a[244:247], v[44:47], v[120:123]
v_exp_f32 v27, v27
v_mfma_f32_16x16x32_bf16 v[124:127], a[248:251], v[44:47], v[124:127]
v_cvt_pk_bf16_f32 v37, v26, v27
v_mfma_f32_16x16x32_bf16 v[124:127], a[252:255], v[40:43], v[124:127]
v_exp_f32 v28, v28
v_mfma_f32_16x16x32_bf16 v[16:19], a[128:131], a[48:51], -4.0
buffer_load_dwordx4 v2, s[16:19], s79 offen offset:2048 lds
v_mfma_f32_16x16x32_bf16 v[16:19], a[132:135], a[52:55], v[16:19]
v_exp_f32 v29, v29
v_mfma_f32_16x16x32_bf16 v[16:19], a[136:139], a[56:59], v[16:19]
ds_read_b128 a[128:131], v4 offset:0
v_mfma_f32_16x16x32_bf16 v[16:19], a[140:143], a[60:63], v[16:19]
v_exp_f32 v30, v30
v_mfma_f32_16x16x32_bf16 v[20:23], a[144:147], a[60:63], -4.0
ds_read_b128 a[132:135], v5 offset:0
v_cvt_pk_bf16_f32 v38, v28, v29
v_mfma_f32_16x16x32_bf16 v[20:23], a[148:151], a[56:59], v[20:23]
v_exp_f32 v31, v31
v_mfma_f32_16x16x32_bf16 v[20:23], a[152:155], a[52:55], v[20:23]
ds_read_b128 a[136:139], v6 offset:0
v_cvt_pk_bf16_f32 v39, v30, v31
v_mfma_f32_16x16x32_bf16 v[20:23], a[156:159], a[48:51], v[20:23]
v_exp_f32 v16, v16
v_mfma_f32_16x16x32_bf16 v[24:27], a[160:163], a[48:51], -4.0
ds_read_b128 a[140:143], v7 offset:0
v_mfma_f32_16x16x32_bf16 v[24:27], a[164:167], a[52:55], v[24:27]
v_exp_f32 v17, v17
v_mfma_f32_16x16x32_bf16 v[24:27], a[168:171], a[56:59], v[24:27]
ds_read_b128 a[144:147], v7 offset:4096
v_cvt_pk_bf16_f32 v40, v16, v17
v_mfma_f32_16x16x32_bf16 v[24:27], a[172:175], a[60:63], v[24:27]
v_exp_f32 v18, v18
v_mfma_f32_16x16x32_bf16 v[28:31], a[176:179], a[60:63], -4.0
ds_read_b128 a[148:151], v6 offset:4096
v_mfma_f32_16x16x32_bf16 v[28:31], a[180:183], a[56:59], v[28:31]
v_exp_f32 v19, v19
v_mfma_f32_16x16x32_bf16 v[28:31], a[184:187], a[52:55], v[28:31]
ds_read_b128 a[152:155], v5 offset:4096
v_cvt_pk_bf16_f32 v41, v18, v19
v_mfma_f32_16x16x32_bf16 v[28:31], a[188:191], a[48:51], v[28:31]
v_exp_f32 v20, v20
v_smfmac_f32_16x16x64_bf16 v[56:59], v[12:15], v[32:39], v1
ds_read_b128 a[156:159], v4 offset:4096
v_mfma_f32_16x16x32_bf16 v[128:131], a[192:195], v[32:35], v[128:131]
ds_read_b128 a[160:163], v4 offset:8192
v_mfma_f32_16x16x32_bf16 v[128:131], a[196:199], v[36:39], v[128:131]
v_exp_f32 v21, v21
v_mfma_f32_16x16x32_bf16 v[132:135], a[200:203], v[36:39], v[132:135]
ds_read_b128 a[164:167], v5 offset:8192
v_cvt_pk_bf16_f32 v42, v20, v21
v_mfma_f32_16x16x32_bf16 v[132:135], a[204:207], v[32:35], v[132:135]
v_exp_f32 v22, v22
v_mfma_f32_16x16x32_bf16 v[136:139], a[208:211], v[32:35], v[136:139]
ds_read_b128 a[168:171], v6 offset:8192
v_mfma_f32_16x16x32_bf16 v[136:139], a[212:215], v[36:39], v[136:139]
v_exp_f32 v23, v23
v_mfma_f32_16x16x32_bf16 v[140:143], a[216:219], v[36:39], v[140:143]
ds_read_b128 a[172:175], v7 offset:8192
v_cvt_pk_bf16_f32 v43, v22, v23
v_mfma_f32_16x16x32_bf16 v[140:143], a[220:223], v[32:35], v[140:143]
v_exp_f32 v24, v24
v_mfma_f32_16x16x32_bf16 v[144:147], a[224:227], v[32:35], v[144:147]
ds_read_b128 a[176:179], v7 offset:12288
v_mfma_f32_16x16x32_bf16 v[144:147], a[228:231], v[36:39], v[144:147]
v_exp_f32 v25, v25
v_mfma_f32_16x16x32_bf16 v[148:151], a[232:235], v[36:39], v[148:151]
ds_read_b128 a[180:183], v6 offset:12288
v_cvt_pk_bf16_f32 v44, v24, v25
v_mfma_f32_16x16x32_bf16 v[148:151], a[236:239], v[32:35], v[148:151]
v_exp_f32 v26, v26
v_mfma_f32_16x16x32_bf16 v[152:155], a[240:243], v[32:35], v[152:155]
ds_read_b128 a[184:187], v5 offset:12288
v_mfma_f32_16x16x32_bf16 v[152:155], a[244:247], v[36:39], v[152:155]
v_exp_f32 v27, v27
v_mfma_f32_16x16x32_bf16 v[156:159], a[248:251], v[36:39], v[156:159]
ds_read_b128 a[188:191], v4 offset:12288
v_cvt_pk_bf16_f32 v45, v26, v27
v_mfma_f32_16x16x32_bf16 v[156:159], a[252:255], v[32:35], v[156:159]
s_waitcnt lgkmcnt(12)
v_exp_f32 v28, v28
v_mfma_f32_16x16x32_bf16 v[16:19], a[128:131], a[0:3], -4.0
buffer_store_dwordx4 v[236:239], v0, s[20:23], s37 offen offset:192 sc1
v_mfma_f32_16x16x32_bf16 v[16:19], a[132:135], a[4:7], v[16:19]
v_exp_f32 v29, v29
v_mfma_f32_16x16x32_bf16 v[16:19], a[136:139], a[8:11], v[16:19]
v_permlane16_swap_b32 v244, v246
v_mfma_f32_16x16x32_bf16 v[16:19], a[140:143], a[12:15], v[16:19]
s_waitcnt lgkmcnt(8)
v_exp_f32 v30, v30
v_mfma_f32_16x16x32_bf16 v[20:23], a[144:147], a[12:15], -4.0
v_cvt_pk_bf16_f32 v46, v28, v29
v_mfma_f32_16x16x32_bf16 v[20:23], a[148:151], a[8:11], v[20:23]
v_exp_f32 v31, v31
v_mfma_f32_16x16x32_bf16 v[20:23], a[152:155], a[4:7], v[20:23]
v_cvt_pk_bf16_f32 v47, v30, v31
v_mfma_f32_16x16x32_bf16 v[20:23], a[156:159], a[0:3], v[20:23]
s_waitcnt lgkmcnt(4)
v_exp_f32 v16, v16
v_mfma_f32_16x16x32_bf16 v[24:27], a[160:163], a[0:3], -4.0
v_permlane16_swap_b32 v245, v247
v_mfma_f32_16x16x32_bf16 v[24:27], a[164:167], a[4:7], v[24:27]
v_exp_f32 v17, v17
v_mfma_f32_16x16x32_bf16 v[24:27], a[168:171], a[8:11], v[24:27]
v_cvt_pk_bf16_f32 v32, v16, v17
v_mfma_f32_16x16x32_bf16 v[24:27], a[172:175], a[12:15], v[24:27]
s_waitcnt lgkmcnt(0)
v_exp_f32 v18, v18
v_mfma_f32_16x16x32_bf16 v[28:31], a[176:179], a[12:15], -4.0
v_permlane16_swap_b32 v248, v250
v_mfma_f32_16x16x32_bf16 v[28:31], a[180:183], a[8:11], v[28:31]
v_exp_f32 v19, v19
v_mfma_f32_16x16x32_bf16 v[28:31], a[184:187], a[4:7], v[28:31]
v_cvt_pk_bf16_f32 v33, v18, v19
v_mfma_f32_16x16x32_bf16 v[28:31], a[188:191], a[0:3], v[28:31]
s_waitcnt vmcnt(9)
v_exp_f32 v20, v20
v_smfmac_f32_16x16x64_bf16 v[60:63], v[12:15], v[40:47], v1
s_barrier
v_mfma_f32_16x16x32_bf16 v[160:163], a[192:195], v[40:43], v[160:163]
ds_read_b64_tr_b16 a[192:193], v8 offset:0
ds_read_b64_tr_b16 a[194:195], v8 offset:4096
v_mfma_f32_16x16x32_bf16 v[160:163], a[196:199], v[44:47], v[160:163]
v_exp_f32 v21, v21
v_mfma_f32_16x16x32_bf16 v[164:167], a[200:203], v[44:47], v[164:167]
ds_read_b64_tr_b16 a[196:197], v8 offset:8192
v_cvt_pk_bf16_f32 v34, v20, v21
v_mfma_f32_16x16x32_bf16 v[164:167], a[204:207], v[40:43], v[164:167]
v_exp_f32 v22, v22
v_mfma_f32_16x16x32_bf16 v[168:171], a[208:211], v[40:43], v[168:171]
ds_read_b64_tr_b16 a[198:199], v8 offset:12288
ds_read_b64_tr_b16 a[200:201], v9 offset:8192
v_mfma_f32_16x16x32_bf16 v[168:171], a[212:215], v[44:47], v[168:171]
v_exp_f32 v23, v23
v_mfma_f32_16x16x32_bf16 v[172:175], a[216:219], v[44:47], v[172:175]
ds_read_b64_tr_b16 a[202:203], v9 offset:12288
v_cvt_pk_bf16_f32 v35, v22, v23
v_mfma_f32_16x16x32_bf16 v[172:175], a[220:223], v[40:43], v[172:175]
v_exp_f32 v24, v24
v_mfma_f32_16x16x32_bf16 v[176:179], a[224:227], v[40:43], v[176:179]
ds_read_b64_tr_b16 a[204:205], v9 offset:0
ds_read_b64_tr_b16 a[206:207], v9 offset:4096
v_mfma_f32_16x16x32_bf16 v[176:179], a[228:231], v[44:47], v[176:179]
v_exp_f32 v25, v25
v_mfma_f32_16x16x32_bf16 v[180:183], a[232:235], v[44:47], v[180:183]
ds_read_b64_tr_b16 a[208:209], v10 offset:0
v_cvt_pk_bf16_f32 v36, v24, v25
v_mfma_f32_16x16x32_bf16 v[180:183], a[236:239], v[40:43], v[180:183]
v_exp_f32 v26, v26
v_mfma_f32_16x16x32_bf16 v[184:187], a[240:243], v[40:43], v[184:187]
buffer_store_dwordx4 v[240:243], v0, s[20:23], s38 offen offset:0 sc1
v_mfma_f32_16x16x32_bf16 v[184:187], a[244:247], v[44:47], v[184:187]
v_exp_f32 v27, v27
v_mfma_f32_16x16x32_bf16 v[188:191], a[248:251], v[44:47], v[188:191]
ds_read_b64_tr_b16 a[210:211], v10 offset:4096
v_cvt_pk_bf16_f32 v37, v26, v27
v_mfma_f32_16x16x32_bf16 v[188:191], a[252:255], v[40:43], v[188:191]
v_exp_f32 v28, v28
v_mfma_f32_16x16x32_bf16 v[16:19], a[128:131], a[16:19], -4.0
ds_read_b64_tr_b16 a[212:213], v10 offset:8192
ds_read_b64_tr_b16 a[214:215], v10 offset:12288
v_mfma_f32_16x16x32_bf16 v[16:19], a[132:135], a[20:23], v[16:19]
v_exp_f32 v29, v29
v_mfma_f32_16x16x32_bf16 v[16:19], a[136:139], a[24:27], v[16:19]
ds_read_b64_tr_b16 a[216:217], v11 offset:8192
ds_read_b64_tr_b16 a[218:219], v11 offset:12288
v_mfma_f32_16x16x32_bf16 v[16:19], a[140:143], a[28:31], v[16:19]
v_exp_f32 v30, v30
v_mfma_f32_16x16x32_bf16 v[20:23], a[144:147], a[28:31], -4.0
ds_read_b64_tr_b16 a[220:221], v11 offset:0
v_cvt_pk_bf16_f32 v38, v28, v29
v_mfma_f32_16x16x32_bf16 v[20:23], a[148:151], a[24:27], v[20:23]
v_exp_f32 v31, v31
v_mfma_f32_16x16x32_bf16 v[20:23], a[152:155], a[20:23], v[20:23]
ds_read_b64_tr_b16 a[222:223], v11 offset:4096
v_cvt_pk_bf16_f32 v39, v30, v31
v_mfma_f32_16x16x32_bf16 v[20:23], a[156:159], a[16:19], v[20:23]
v_exp_f32 v16, v16
v_mfma_f32_16x16x32_bf16 v[24:27], a[160:163], a[16:19], -4.0
ds_read_b64_tr_b16 a[224:225], v8 offset:1024
ds_read_b64_tr_b16 a[226:227], v8 offset:5120
v_mfma_f32_16x16x32_bf16 v[24:27], a[164:167], a[20:23], v[24:27]
v_exp_f32 v17, v17
v_mfma_f32_16x16x32_bf16 v[24:27], a[168:171], a[24:27], v[24:27]
ds_read_b64_tr_b16 a[228:229], v8 offset:9216
v_cvt_pk_bf16_f32 v40, v16, v17
v_mfma_f32_16x16x32_bf16 v[24:27], a[172:175], a[28:31], v[24:27]
v_exp_f32 v18, v18
v_mfma_f32_16x16x32_bf16 v[28:31], a[176:179], a[28:31], -4.0
ds_read_b64_tr_b16 a[230:231], v8 offset:13312
ds_read_b64_tr_b16 a[232:233], v9 offset:9216
v_mfma_f32_16x16x32_bf16 v[28:31], a[180:183], a[24:27], v[28:31]
v_exp_f32 v19, v19
v_mfma_f32_16x16x32_bf16 v[28:31], a[184:187], a[20:23], v[28:31]
ds_read_b64_tr_b16 a[234:235], v9 offset:13312
v_cvt_pk_bf16_f32 v41, v18, v19
v_mfma_f32_16x16x32_bf16 v[28:31], a[188:191], a[16:19], v[28:31]
v_exp_f32 v20, v20
v_smfmac_f32_16x16x64_bf16 v[48:51], v[12:15], v[32:39], v1
s_waitcnt lgkmcnt(15)
ds_read_b64_tr_b16 a[236:237], v9 offset:1024
v_mfma_f32_16x16x32_bf16 v[64:67], a[192:195], v[32:35], v[64:67]
ds_read_b64_tr_b16 a[238:239], v9 offset:5120
ds_read_b64_tr_b16 a[240:241], v10 offset:1024
v_mfma_f32_16x16x32_bf16 v[64:67], a[196:199], v[36:39], v[64:67]
v_exp_f32 v21, v21
v_mfma_f32_16x16x32_bf16 v[68:71], a[200:203], v[36:39], v[68:71]
s_waitcnt lgkmcnt(15)
ds_read_b64_tr_b16 a[242:243], v10 offset:5120
v_cvt_pk_bf16_f32 v42, v20, v21
v_mfma_f32_16x16x32_bf16 v[68:71], a[204:207], v[32:35], v[68:71]
v_exp_f32 v22, v22
v_mfma_f32_16x16x32_bf16 v[72:75], a[208:211], v[32:35], v[72:75]
s_waitcnt lgkmcnt(14)
ds_read_b64_tr_b16 a[244:245], v10 offset:9216
ds_read_b64_tr_b16 a[246:247], v10 offset:13312
v_mfma_f32_16x16x32_bf16 v[72:75], a[212:215], v[36:39], v[72:75]
s_waitcnt lgkmcnt(12)
v_exp_f32 v23, v23
v_mfma_f32_16x16x32_bf16 v[76:79], a[216:219], v[36:39], v[76:79]
ds_read_b64_tr_b16 a[248:249], v11 offset:9216
ds_read_b64_tr_b16 a[250:251], v11 offset:13312
v_cvt_pk_bf16_f32 v43, v22, v23
v_mfma_f32_16x16x32_bf16 v[76:79], a[220:223], v[32:35], v[76:79]
s_waitcnt lgkmcnt(10)
ds_read_b64_tr_b16 a[252:253], v11 offset:1024
ds_read_b64_tr_b16 a[254:255], v11 offset:5120
v_exp_f32 v24, v24
v_mfma_f32_16x16x32_bf16 v[80:83], a[224:227], v[32:35], v[80:83]
buffer_store_dwordx4 v[244:247], v0, s[20:23], s38 offen offset:64 sc1
v_mfma_f32_16x16x32_bf16 v[80:83], a[228:231], v[36:39], v[80:83]
s_waitcnt lgkmcnt(8)
v_exp_f32 v25, v25
v_mfma_f32_16x16x32_bf16 v[84:87], a[232:235], v[36:39], v[84:87]
v_cvt_pk_bf16_f32 v44, v24, v25
v_mbcnt_lo_u32_b32 v234, -1, 0
v_mfma_f32_16x16x32_bf16 v[84:87], a[236:239], v[32:35], v[84:87]
s_waitcnt lgkmcnt(4)
v_exp_f32 v26, v26
v_mfma_f32_16x16x32_bf16 v[88:91], a[240:243], v[32:35], v[88:91]
v_permlane16_swap_b32 v249, v251
v_mfma_f32_16x16x32_bf16 v[88:91], a[244:247], v[36:39], v[88:91]
s_waitcnt lgkmcnt(0)
v_exp_f32 v27, v27
v_mfma_f32_16x16x32_bf16 v[92:95], a[248:251], v[36:39], v[92:95]
v_cvt_pk_bf16_f32 v45, v26, v27
v_mbcnt_hi_u32_b32 v234, -1, v234
v_mfma_f32_16x16x32_bf16 v[92:95], a[252:255], v[32:35], v[92:95]
v_exp_f32 v28, v28
v_mfma_f32_16x16x32_bf16 v[16:19], a[128:131], a[32:35], -4.0
s_barrier
v_mfma_f32_16x16x32_bf16 v[16:19], a[132:135], a[36:39], v[16:19]
s_add_u32 m0, s24, 0x0
v_exp_f32 v29, v29
v_mfma_f32_16x16x32_bf16 v[16:19], a[136:139], a[40:43], v[16:19]
buffer_load_dwordx4 v2, s[16:19], s80 offen offset:0 lds
v_mfma_f32_16x16x32_bf16 v[16:19], a[140:143], a[44:47], v[16:19]
v_exp_f32 v30, v30
v_mfma_f32_16x16x32_bf16 v[20:23], a[144:147], a[44:47], -4.0
v_cvt_pk_bf16_f32 v46, v28, v29
v_lshrrev_b32 v232, 4, v234
v_mfma_f32_16x16x32_bf16 v[20:23], a[148:151], a[40:43], v[20:23]
v_exp_f32 v31, v31
v_mfma_f32_16x16x32_bf16 v[20:23], a[152:155], a[36:39], v[20:23]
v_cvt_pk_bf16_f32 v47, v30, v31
v_and_b32 v233, 15, v234
v_mfma_f32_16x16x32_bf16 v[20:23], a[156:159], a[32:35], v[20:23]
v_exp_f32 v16, v16
v_mfma_f32_16x16x32_bf16 v[24:27], a[160:163], a[32:35], -4.0
buffer_load_dwordx4 v2, s[16:19], s80 offen offset:2048 lds
v_mfma_f32_16x16x32_bf16 v[24:27], a[164:167], a[36:39], v[24:27]
s_add_u32 m0, s24, 0x2000
v_exp_f32 v17, v17
v_mfma_f32_16x16x32_bf16 v[24:27], a[168:171], a[40:43], v[24:27]
v_cvt_pk_bf16_f32 v32, v16, v17
v_xor_b32 v235, v232, v233
v_mfma_f32_16x16x32_bf16 v[24:27], a[172:175], a[44:47], v[24:27]
v_exp_f32 v18, v18
v_mfma_f32_16x16x32_bf16 v[28:31], a[176:179], a[44:47], -4.0
v_permlane16_swap_b32 v252, v254
v_mfma_f32_16x16x32_bf16 v[28:31], a[180:183], a[40:43], v[28:31]
v_exp_f32 v19, v19
v_mfma_f32_16x16x32_bf16 v[28:31], a[184:187], a[36:39], v[28:31]
v_cvt_pk_bf16_f32 v33, v18, v19
v_lshlrev_b32 v236, 8, v232
v_mfma_f32_16x16x32_bf16 v[28:31], a[188:191], a[32:35], v[28:31]
v_exp_f32 v20, v20
v_smfmac_f32_16x16x64_bf16 v[52:55], v[12:15], v[40:47], v1
v_xor_b32 v244, 0, v235
v_mfma_f32_16x16x32_bf16 v[96:99], a[192:195], v[40:43], v[96:99]
buffer_load_dwordx4 v2, s[16:19], s81 offen offset:0 lds
v_mfma_f32_16x16x32_bf16 v[96:99], a[196:199], v[44:47], v[96:99]
v_exp_f32 v21, v21
v_mfma_f32_16x16x32_bf16 v[100:103], a[200:203], v[44:47], v[100:103]
v_cvt_pk_bf16_f32 v34, v20, v21
v_lshl_add_u32 v244, v244, 4, v236
v_mfma_f32_16x16x32_bf16 v[100:103], a[204:207], v[40:43], v[100:103]
v_exp_f32 v22, v22
v_mfma_f32_16x16x32_bf16 v[104:107], a[208:211], v[40:43], v[104:107]
v_permlane16_swap_b32 v253, v255
v_mfma_f32_16x16x32_bf16 v[104:107], a[212:215], v[44:47], v[104:107]
v_exp_f32 v23, v23
v_mfma_f32_16x16x32_bf16 v[108:111], a[216:219], v[44:47], v[108:111]
v_cvt_pk_bf16_f32 v35, v22, v23
v_xor_b32 v245, 4, v235
v_mfma_f32_16x16x32_bf16 v[108:111], a[220:223], v[40:43], v[108:111]
v_exp_f32 v24, v24
v_mfma_f32_16x16x32_bf16 v[112:115], a[224:227], v[40:43], v[112:115]
buffer_load_dwordx4 v2, s[16:19], s81 offen offset:2048 lds
v_mfma_f32_16x16x32_bf16 v[112:115], a[228:231], v[44:47], v[112:115]
v_exp_f32 v25, v25
v_mfma_f32_16x16x32_bf16 v[116:119], a[232:235], v[44:47], v[116:119]
v_cvt_pk_bf16_f32 v36, v24, v25
v_lshl_add_u32 v245, v245, 4, v236
v_mfma_f32_16x16x32_bf16 v[116:119], a[236:239], v[40:43], v[116:119]
v_exp_f32 v26, v26
v_mfma_f32_16x16x32_bf16 v[120:123], a[240:243], v[40:43], v[120:123]
v_permlane16_swap_b32 v192, v194
v_mfma_f32_16x16x32_bf16 v[120:123], a[244:247], v[44:47], v[120:123]
v_exp_f32 v27, v27
v_mfma_f32_16x16x32_bf16 v[124:127], a[248:251], v[44:47], v[124:127]
v_cvt_pk_bf16_f32 v37, v26, v27
v_xor_b32 v246, 8, v235
v_mfma_f32_16x16x32_bf16 v[124:127], a[252:255], v[40:43], v[124:127]
v_exp_f32 v28, v28
v_mfma_f32_16x16x32_bf16 v[16:19], a[128:131], a[48:51], -4.0
buffer_store_dwordx4 v[248:251], v0, s[20:23], s38 offen offset:128 sc1
v_mfma_f32_16x16x32_bf16 v[16:19], a[132:135], a[52:55], v[16:19]
v_exp_f32 v29, v29
v_mfma_f32_16x16x32_bf16 v[16:19], a[136:139], a[56:59], v[16:19]
ds_read_b128 a[128:131], v4 offset:16384
v_lshl_add_u32 v248, v234, 4, s47
v_mfma_f32_16x16x32_bf16 v[16:19], a[140:143], a[60:63], v[16:19]
v_exp_f32 v30, v30
v_mfma_f32_16x16x32_bf16 v[20:23], a[144:147], a[60:63], -4.0
ds_read_b128 a[132:135], v5 offset:16384
v_cvt_pk_bf16_f32 v38, v28, v29
v_mfma_f32_16x16x32_bf16 v[20:23], a[148:151], a[56:59], v[20:23]
v_exp_f32 v31, v31
v_mfma_f32_16x16x32_bf16 v[20:23], a[152:155], a[52:55], v[20:23]
ds_read_b128 a[136:139], v6 offset:16384
v_cvt_pk_bf16_f32 v39, v30, v31
v_mfma_f32_16x16x32_bf16 v[20:23], a[156:159], a[48:51], v[20:23]
v_exp_f32 v16, v16
v_mfma_f32_16x16x32_bf16 v[24:27], a[160:163], a[48:51], -4.0
ds_read_b128 a[140:143], v7 offset:16384
v_lshl_add_u32 v246, v246, 4, v236
v_mfma_f32_16x16x32_bf16 v[24:27], a[164:167], a[52:55], v[24:27]
v_exp_f32 v17, v17
v_mfma_f32_16x16x32_bf16 v[24:27], a[168:171], a[56:59], v[24:27]
ds_read_b128 a[144:147], v7 offset:20480
v_cvt_pk_bf16_f32 v40, v16, v17
v_mfma_f32_16x16x32_bf16 v[24:27], a[172:175], a[60:63], v[24:27]
v_exp_f32 v18, v18
v_mfma_f32_16x16x32_bf16 v[28:31], a[176:179], a[60:63], -4.0
ds_read_b128 a[148:151], v6 offset:20480
v_xor_b32 v247, 12, v235
v_mfma_f32_16x16x32_bf16 v[28:31], a[180:183], a[56:59], v[28:31]
v_exp_f32 v19, v19
v_mfma_f32_16x16x32_bf16 v[28:31], a[184:187], a[52:55], v[28:31]
ds_read_b128 a[152:155], v5 offset:20480
v_cvt_pk_bf16_f32 v41, v18, v19
v_mfma_f32_16x16x32_bf16 v[28:31], a[188:191], a[48:51], v[28:31]
v_exp_f32 v20, v20
v_smfmac_f32_16x16x64_bf16 v[56:59], v[12:15], v[32:39], v1
ds_read_b128 a[156:159], v4 offset:20480
v_mfma_f32_16x16x32_bf16 v[128:131], a[192:195], v[32:35], v[128:131]
ds_read_b128 a[160:163], v4 offset:24576
v_lshl_add_u32 v247, v247, 4, v236
v_mfma_f32_16x16x32_bf16 v[128:131], a[196:199], v[36:39], v[128:131]
v_exp_f32 v21, v21
v_mfma_f32_16x16x32_bf16 v[132:135], a[200:203], v[36:39], v[132:135]
ds_read_b128 a[164:167], v5 offset:24576
v_cvt_pk_bf16_f32 v42, v20, v21
v_mfma_f32_16x16x32_bf16 v[132:135], a[204:207], v[32:35], v[132:135]
v_exp_f32 v22, v22
v_mfma_f32_16x16x32_bf16 v[136:139], a[208:211], v[32:35], v[136:139]
ds_read_b128 a[168:171], v6 offset:24576
v_lshrrev_b32 v237, 5, v234
v_mfma_f32_16x16x32_bf16 v[136:139], a[212:215], v[36:39], v[136:139]
v_exp_f32 v23, v23
v_mfma_f32_16x16x32_bf16 v[140:143], a[216:219], v[36:39], v[140:143]
ds_read_b128 a[172:175], v7 offset:24576
v_cvt_pk_bf16_f32 v43, v22, v23
v_mfma_f32_16x16x32_bf16 v[140:143], a[220:223], v[32:35], v[140:143]
v_exp_f32 v24, v24
v_mfma_f32_16x16x32_bf16 v[144:147], a[224:227], v[32:35], v[144:147]
ds_read_b128 a[176:179], v7 offset:28672
v_xor_b32 v237, v237, v233
v_mfma_f32_16x16x32_bf16 v[144:147], a[228:231], v[36:39], v[144:147]
v_exp_f32 v25, v25
v_mfma_f32_16x16x32_bf16 v[148:151], a[232:235], v[36:39], v[148:151]
ds_read_b128 a[180:183], v6 offset:28672
v_cvt_pk_bf16_f32 v44, v24, v25
v_mfma_f32_16x16x32_bf16 v[148:151], a[236:239], v[32:35], v[148:151]
v_exp_f32 v26, v26
v_mfma_f32_16x16x32_bf16 v[152:155], a[240:243], v[32:35], v[152:155]
ds_read_b128 a[184:187], v5 offset:28672
v_and_b32 v238, 1, v232
v_mfma_f32_16x16x32_bf16 v[152:155], a[244:247], v[36:39], v[152:155]
v_exp_f32 v27, v27
v_mfma_f32_16x16x32_bf16 v[156:159], a[248:251], v[36:39], v[156:159]
ds_read_b128 a[188:191], v4 offset:28672
v_cvt_pk_bf16_f32 v45, v26, v27
v_mfma_f32_16x16x32_bf16 v[156:159], a[252:255], v[32:35], v[156:159]
s_waitcnt lgkmcnt(12)
v_exp_f32 v28, v28
v_mfma_f32_16x16x32_bf16 v[16:19], a[128:131], a[0:3], -4.0
buffer_store_dwordx4 v[252:255], v0, s[20:23], s38 offen offset:192 sc1
v_mfma_f32_16x16x32_bf16 v[16:19], a[132:135], a[4:7], v[16:19]
v_exp_f32 v29, v29
v_mfma_f32_16x16x32_bf16 v[16:19], a[136:139], a[8:11], v[16:19]
v_permlane16_swap_b32 v193, v195
v_mfma_f32_16x16x32_bf16 v[16:19], a[140:143], a[12:15], v[16:19]
s_waitcnt lgkmcnt(8)
v_exp_f32 v30, v30
v_mfma_f32_16x16x32_bf16 v[20:23], a[144:147], a[12:15], -4.0
v_cvt_pk_bf16_f32 v46, v28, v29
v_lshl_add_u32 v238, v238, 3, s47
v_mfma_f32_16x16x32_bf16 v[20:23], a[148:151], a[8:11], v[20:23]
v_exp_f32 v31, v31
v_mfma_f32_16x16x32_bf16 v[20:23], a[152:155], a[4:7], v[20:23]
v_cvt_pk_bf16_f32 v47, v30, v31
v_lshl_add_u32 v238, v233, 8, v238
v_mfma_f32_16x16x32_bf16 v[20:23], a[156:159], a[0:3], v[20:23]
s_waitcnt lgkmcnt(4)
v_exp_f32 v16, v16
v_mfma_f32_16x16x32_bf16 v[24:27], a[160:163], a[0:3], -4.0
v_permlane16_swap_b32 v196, v198
v_mfma_f32_16x16x32_bf16 v[24:27], a[164:167], a[4:7], v[24:27]
v_exp_f32 v17, v17
v_mfma_f32_16x16x32_bf16 v[24:27], a[168:171], a[8:11], v[24:27]
v_cvt_pk_bf16_f32 v32, v16, v17
v_xor_b32 v224, 0, v237
v_mfma_f32_16x16x32_bf16 v[24:27], a[172:175], a[12:15], v[24:27]
s_waitcnt lgkmcnt(0)
v_exp_f32 v18, v18
v_mfma_f32_16x16x32_bf16 v[28:31], a[176:179], a[12:15], -4.0
v_permlane16_swap_b32 v197, v199
v_mfma_f32_16x16x32_bf16 v[28:31], a[180:183], a[8:11], v[28:31]
v_exp_f32 v19, v19
v_mfma_f32_16x16x32_bf16 v[28:31], a[184:187], a[4:7], v[28:31]
v_cvt_pk_bf16_f32 v33, v18, v19
v_lshl_add_u32 v224, v224, 4, v238
v_mfma_f32_16x16x32_bf16 v[28:31], a[188:191], a[0:3], v[28:31]
s_waitcnt vmcnt(9)
v_exp_f32 v20, v20
v_smfmac_f32_16x16x64_bf16 v[60:63], v[12:15], v[40:47], v1
s_barrier
v_mfma_f32_16x16x32_bf16 v[160:163], a[192:195], v[40:43], v[160:163]
ds_read_b64_tr_b16 a[192:193], v8 offset:16384
ds_read_b64_tr_b16 a[194:195], v8 offset:20480
v_mfma_f32_16x16x32_bf16 v[160:163], a[196:199], v[44:47], v[160:163]
v_exp_f32 v21, v21
v_mfma_f32_16x16x32_bf16 v[164:167], a[200:203], v[44:47], v[164:167]
ds_read_b64_tr_b16 a[196:197], v8 offset:24576
v_cvt_pk_bf16_f32 v34, v20, v21
v_mfma_f32_16x16x32_bf16 v[164:167], a[204:207], v[40:43], v[164:167]
v_exp_f32 v22, v22
v_mfma_f32_16x16x32_bf16 v[168:171], a[208:211], v[40:43], v[168:171]
ds_read_b64_tr_b16 a[198:199], v8 offset:28672
ds_read_b64_tr_b16 a[200:201], v9 offset:24576
v_mfma_f32_16x16x32_bf16 v[168:171], a[212:215], v[44:47], v[168:171]
v_exp_f32 v23, v23
v_mfma_f32_16x16x32_bf16 v[172:175], a[216:219], v[44:47], v[172:175]
ds_read_b64_tr_b16 a[202:203], v9 offset:28672
v_cvt_pk_bf16_f32 v35, v22, v23
v_mfma_f32_16x16x32_bf16 v[172:175], a[220:223], v[40:43], v[172:175]
v_exp_f32 v24, v24
v_mfma_f32_16x16x32_bf16 v[176:179], a[224:227], v[40:43], v[176:179]
ds_read_b64_tr_b16 a[204:205], v9 offset:16384
ds_read_b64_tr_b16 a[206:207], v9 offset:20480
v_mfma_f32_16x16x32_bf16 v[176:179], a[228:231], v[44:47], v[176:179]
v_exp_f32 v25, v25
v_mfma_f32_16x16x32_bf16 v[180:183], a[232:235], v[44:47], v[180:183]
L_pg12:
s_cbranch_vccnz L_ret
ds_read_b64_tr_b16 a[208:209], v10 offset:16384
v_cvt_pk_bf16_f32 v36, v24, v25
v_mfma_f32_16x16x32_bf16 v[180:183], a[236:239], v[40:43], v[180:183]
v_exp_f32 v26, v26
v_mfma_f32_16x16x32_bf16 v[184:187], a[240:243], v[40:43], v[184:187]
ds_read_b64_tr_b16 a[210:211], v10 offset:20480
ds_read_b64_tr_b16 a[212:213], v10 offset:24576
v_mfma_f32_16x16x32_bf16 v[184:187], a[244:247], v[44:47], v[184:187]
v_exp_f32 v27, v27
v_mfma_f32_16x16x32_bf16 v[188:191], a[248:251], v[44:47], v[188:191]
ds_read_b64_tr_b16 a[214:215], v10 offset:28672
v_cvt_pk_bf16_f32 v37, v26, v27
v_mfma_f32_16x16x32_bf16 v[188:191], a[252:255], v[40:43], v[188:191]
v_exp_f32 v28, v28
v_mfma_f32_16x16x32_bf16 v[16:19], a[128:131], a[16:19], -4.0
ds_read_b64_tr_b16 a[216:217], v11 offset:24576
ds_read_b64_tr_b16 a[218:219], v11 offset:28672
v_mfma_f32_16x16x32_bf16 v[16:19], a[132:135], a[20:23], v[16:19]
v_exp_f32 v29, v29
v_mfma_f32_16x16x32_bf16 v[16:19], a[136:139], a[24:27], v[16:19]
ds_read_b64_tr_b16 a[220:221], v11 offset:16384
ds_read_b64_tr_b16 a[222:223], v11 offset:20480
v_mfma_f32_16x16x32_bf16 v[16:19], a[140:143], a[28:31], v[16:19]
v_exp_f32 v30, v30
v_mfma_f32_16x16x32_bf16 v[20:23], a[144:147], a[28:31], -4.0
ds_read_b64_tr_b16 a[224:225], v8 offset:17408
v_cvt_pk_bf16_f32 v38, v28, v29
v_mfma_f32_16x16x32_bf16 v[20:23], a[148:151], a[24:27], v[20:23]
v_exp_f32 v31, v31
v_mfma_f32_16x16x32_bf16 v[20:23], a[152:155], a[20:23], v[20:23]
ds_read_b64_tr_b16 a[226:227], v8 offset:21504
v_cvt_pk_bf16_f32 v39, v30, v31
v_mfma_f32_16x16x32_bf16 v[20:23], a[156:159], a[16:19], v[20:23]
v_exp_f32 v16, v16
v_mfma_f32_16x16x32_bf16 v[24:27], a[160:163], a[16:19], -4.0
ds_read_b64_tr_b16 a[228:229], v8 offset:25600
ds_read_b64_tr_b16 a[230:231], v8 offset:29696
v_mfma_f32_16x16x32_bf16 v[24:27], a[164:167], a[20:23], v[24:27]
v_exp_f32 v17, v17
v_mfma_f32_16x16x32_bf16 v[24:27], a[168:171], a[24:27], v[24:27]
ds_read_b64_tr_b16 a[232:233], v9 offset:25600
v_cvt_pk_bf16_f32 v40, v16, v17
v_mfma_f32_16x16x32_bf16 v[24:27], a[172:175], a[28:31], v[24:27]
v_exp_f32 v18, v18
v_mfma_f32_16x16x32_bf16 v[28:31], a[176:179], a[28:31], -4.0
ds_read_b64_tr_b16 a[234:235], v9 offset:29696
ds_read_b64_tr_b16 a[236:237], v9 offset:17408
v_mfma_f32_16x16x32_bf16 v[28:31], a[180:183], a[24:27], v[28:31]
v_exp_f32 v19, v19
v_mfma_f32_16x16x32_bf16 v[28:31], a[184:187], a[20:23], v[28:31]
ds_read_b64_tr_b16 a[238:239], v9 offset:21504
v_cvt_pk_bf16_f32 v41, v18, v19
v_mfma_f32_16x16x32_bf16 v[28:31], a[188:191], a[16:19], v[28:31]
v_exp_f32 v20, v20
v_smfmac_f32_16x16x64_bf16 v[48:51], v[12:15], v[32:39], v1
s_waitcnt lgkmcnt(15)
ds_read_b64_tr_b16 a[240:241], v10 offset:17408
v_mfma_f32_16x16x32_bf16 v[64:67], a[192:195], v[32:35], v[64:67]
ds_read_b64_tr_b16 a[242:243], v10 offset:21504
ds_read_b64_tr_b16 a[244:245], v10 offset:25600
v_mfma_f32_16x16x32_bf16 v[64:67], a[196:199], v[36:39], v[64:67]
v_exp_f32 v21, v21
v_mfma_f32_16x16x32_bf16 v[68:71], a[200:203], v[36:39], v[68:71]
ds_read_b64_tr_b16 a[246:247], v10 offset:29696
v_cvt_pk_bf16_f32 v42, v20, v21
v_mfma_f32_16x16x32_bf16 v[68:71], a[204:207], v[32:35], v[68:71]
s_waitcnt lgkmcnt(15)
v_exp_f32 v22, v22
v_mfma_f32_16x16x32_bf16 v[72:75], a[208:211], v[32:35], v[72:75]
ds_read_b64_tr_b16 a[248:249], v11 offset:25600
ds_read_b64_tr_b16 a[250:251], v11 offset:29696
v_mfma_f32_16x16x32_bf16 v[72:75], a[212:215], v[36:39], v[72:75]
s_waitcnt lgkmcnt(14)
v_exp_f32 v23, v23
v_mfma_f32_16x16x32_bf16 v[76:79], a[216:219], v[36:39], v[76:79]
ds_read_b64_tr_b16 a[252:253], v11 offset:17408
v_cvt_pk_bf16_f32 v43, v22, v23
v_mfma_f32_16x16x32_bf16 v[76:79], a[220:223], v[32:35], v[76:79]
s_waitcnt lgkmcnt(11)
ds_read_b64_tr_b16 a[254:255], v11 offset:21504
v_exp_f32 v24, v24
v_mfma_f32_16x16x32_bf16 v[80:83], a[224:227], v[32:35], v[80:83]
buffer_store_dwordx4 v[192:195], v0, s[20:23], s39 offen offset:0 sc1
v_mfma_f32_16x16x32_bf16 v[80:83], a[228:231], v[36:39], v[80:83]
s_waitcnt lgkmcnt(8)
v_exp_f32 v25, v25
v_mfma_f32_16x16x32_bf16 v[84:87], a[232:235], v[36:39], v[84:87]
v_cvt_pk_bf16_f32 v44, v24, v25
v_xor_b32 v225, 2, v237
v_mfma_f32_16x16x32_bf16 v[84:87], a[236:239], v[32:35], v[84:87]
s_waitcnt lgkmcnt(4)
v_exp_f32 v26, v26
v_mfma_f32_16x16x32_bf16 v[88:91], a[240:243], v[32:35], v[88:91]
v_permlane16_swap_b32 v200, v202
v_mfma_f32_16x16x32_bf16 v[88:91], a[244:247], v[36:39], v[88:91]
s_waitcnt lgkmcnt(0)
v_exp_f32 v27, v27
v_mfma_f32_16x16x32_bf16 v[92:95], a[248:251], v[36:39], v[92:95]
v_cvt_pk_bf16_f32 v45, v26, v27
v_lshl_add_u32 v225, v225, 4, v238
v_mfma_f32_16x16x32_bf16 v[92:95], a[252:255], v[32:35], v[92:95]
v_exp_f32 v28, v28
v_mfma_f32_16x16x32_bf16 v[16:19], a[128:131], a[32:35], -4.0
s_barrier
v_mfma_f32_16x16x32_bf16 v[16:19], a[132:135], a[36:39], v[16:19]
s_add_u32 m0, s24, 0x4000
v_exp_f32 v29, v29
v_mfma_f32_16x16x32_bf16 v[16:19], a[136:139], a[40:43], v[16:19]
buffer_load_dwordx4 v2, s[16:19], s82 offen offset:0 lds
v_mfma_f32_16x16x32_bf16 v[16:19], a[140:143], a[44:47], v[16:19]
v_exp_f32 v30, v30
v_mfma_f32_16x16x32_bf16 v[20:23], a[144:147], a[44:47], -4.0
v_cvt_pk_bf16_f32 v46, v28, v29
v_xor_b32 v226, 4, v237
v_mfma_f32_16x16x32_bf16 v[20:23], a[148:151], a[40:43], v[20:23]
v_exp_f32 v31, v31
v_mfma_f32_16x16x32_bf16 v[20:23], a[152:155], a[36:39], v[20:23]
v_cvt_pk_bf16_f32 v47, v30, v31
v_lshl_add_u32 v226, v226, 4, v238
v_mfma_f32_16x16x32_bf16 v[20:23], a[156:159], a[32:35], v[20:23]
v_exp_f32 v16, v16
v_mfma_f32_16x16x32_bf16 v[24:27], a[160:163], a[32:35], -4.0
buffer_load_dwordx4 v2, s[16:19], s82 offen offset:2048 lds
v_mfma_f32_16x16x32_bf16 v[24:27], a[164:167], a[36:39], v[24:27]
s_add_u32 m0, s24, 0x6000
v_exp_f32 v17, v17
v_mfma_f32_16x16x32_bf16 v[24:27], a[168:171], a[40:43], v[24:27]
v_cvt_pk_bf16_f32 v32, v16, v17
v_xor_b32 v227, 6, v237
v_mfma_f32_16x16x32_bf16 v[24:27], a[172:175], a[44:47], v[24:27]
v_exp_f32 v18, v18
v_mfma_f32_16x16x32_bf16 v[28:31], a[176:179], a[44:47], -4.0
v_permlane16_swap_b32 v201, v203
v_mfma_f32_16x16x32_bf16 v[28:31], a[180:183], a[40:43], v[28:31]
v_exp_f32 v19, v19
v_mfma_f32_16x16x32_bf16 v[28:31], a[184:187], a[36:39], v[28:31]
v_cvt_pk_bf16_f32 v33, v18, v19
v_lshl_add_u32 v227, v227, 4, v238
v_mfma_f32_16x16x32_bf16 v[28:31], a[188:191], a[32:35], v[28:31]
v_exp_f32 v20, v20
v_smfmac_f32_16x16x64_bf16 v[52:55], v[12:15], v[40:47], v1
v_xor_b32 v228, 8, v237
v_mfma_f32_16x16x32_bf16 v[96:99], a[192:195], v[40:43], v[96:99]
buffer_store_dwordx4 v[196:199], v0, s[20:23], s39 offen offset:64 sc1
v_mfma_f32_16x16x32_bf16 v[96:99], a[196:199], v[44:47], v[96:99]
v_exp_f32 v21, v21
v_mfma_f32_16x16x32_bf16 v[100:103], a[200:203], v[44:47], v[100:103]
v_cvt_pk_bf16_f32 v34, v20, v21
v_lshl_add_u32 v228, v228, 4, v238
v_mfma_f32_16x16x32_bf16 v[100:103], a[204:207], v[40:43], v[100:103]
v_exp_f32 v22, v22
v_mfma_f32_16x16x32_bf16 v[104:107], a[208:211], v[40:43], v[104:107]
v_permlane16_swap_b32 v204, v206
v_mfma_f32_16x16x32_bf16 v[104:107], a[212:215], v[44:47], v[104:107]
v_exp_f32 v23, v23
v_mfma_f32_16x16x32_bf16 v[108:111], a[216:219], v[44:47], v[108:111]
v_cvt_pk_bf16_f32 v35, v22, v23
v_xor_b32 v229, 10, v237
v_mfma_f32_16x16x32_bf16 v[108:111], a[220:223], v[40:43], v[108:111]
v_exp_f32 v24, v24
v_mfma_f32_16x16x32_bf16 v[112:115], a[224:227], v[40:43], v[112:115]
buffer_load_dwordx4 v2, s[16:19], s83 offen offset:0 lds
v_mfma_f32_16x16x32_bf16 v[112:115], a[228:231], v[44:47], v[112:115]
v_exp_f32 v25, v25
v_mfma_f32_16x16x32_bf16 v[116:119], a[232:235], v[44:47], v[116:119]
v_cvt_pk_bf16_f32 v36, v24, v25
v_lshl_add_u32 v229, v229, 4, v238
v_mfma_f32_16x16x32_bf16 v[116:119], a[236:239], v[40:43], v[116:119]
v_exp_f32 v26, v26
v_mfma_f32_16x16x32_bf16 v[120:123], a[240:243], v[40:43], v[120:123]
v_permlane16_swap_b32 v205, v207
v_mfma_f32_16x16x32_bf16 v[120:123], a[244:247], v[44:47], v[120:123]
v_exp_f32 v27, v27
v_mfma_f32_16x16x32_bf16 v[124:127], a[248:251], v[44:47], v[124:127]
v_cvt_pk_bf16_f32 v37, v26, v27
v_xor_b32 v230, 12, v237
v_mfma_f32_16x16x32_bf16 v[124:127], a[252:255], v[40:43], v[124:127]
v_exp_f32 v28, v28
v_mfma_f32_16x16x32_bf16 v[16:19], a[128:131], a[48:51], -4.0
buffer_load_dwordx4 v2, s[16:19], s83 offen offset:2048 lds
v_mfma_f32_16x16x32_bf16 v[16:19], a[132:135], a[52:55], v[16:19]
v_exp_f32 v29, v29
v_mfma_f32_16x16x32_bf16 v[16:19], a[136:139], a[56:59], v[16:19]
ds_read_b128 a[128:131], v4 offset:32768
v_lshl_add_u32 v230, v230, 4, v238
v_mfma_f32_16x16x32_bf16 v[16:19], a[140:143], a[60:63], v[16:19]
v_exp_f32 v30, v30
v_mfma_f32_16x16x32_bf16 v[20:23], a[144:147], a[60:63], -4.0
ds_read_b128 a[132:135], v5 offset:32768
v_cvt_pk_bf16_f32 v38, v28, v29
v_mfma_f32_16x16x32_bf16 v[20:23], a[148:151], a[56:59], v[20:23]
v_exp_f32 v31, v31
v_mfma_f32_16x16x32_bf16 v[20:23], a[152:155], a[52:55], v[20:23]
ds_read_b128 a[136:139], v6 offset:32768
v_cvt_pk_bf16_f32 v39, v30, v31
v_mfma_f32_16x16x32_bf16 v[20:23], a[156:159], a[48:51], v[20:23]
v_exp_f32 v16, v16
v_mfma_f32_16x16x32_bf16 v[24:27], a[160:163], a[48:51], -4.0
ds_read_b128 a[140:143], v7 offset:32768
v_xor_b32 v231, 14, v237
v_mfma_f32_16x16x32_bf16 v[24:27], a[164:167], a[52:55], v[24:27]
v_exp_f32 v17, v17
v_mfma_f32_16x16x32_bf16 v[24:27], a[168:171], a[56:59], v[24:27]
ds_read_b128 a[144:147], v7 offset:36864
v_cvt_pk_bf16_f32 v40, v16, v17
v_mfma_f32_16x16x32_bf16 v[24:27], a[172:175], a[60:63], v[24:27]
v_exp_f32 v18, v18
v_mfma_f32_16x16x32_bf16 v[28:31], a[176:179], a[60:63], -4.0
ds_read_b128 a[148:151], v6 offset:36864
v_lshl_add_u32 v231, v231, 4, v238
v_mfma_f32_16x16x32_bf16 v[28:31], a[180:183], a[56:59], v[28:31]
v_exp_f32 v19, v19
v_mfma_f32_16x16x32_bf16 v[28:31], a[184:187], a[52:55], v[28:31]
ds_read_b128 a[152:155], v5 offset:36864
v_cvt_pk_bf16_f32 v41, v18, v19
v_mfma_f32_16x16x32_bf16 v[28:31], a[188:191], a[48:51], v[28:31]
v_exp_f32 v20, v20
v_smfmac_f32_16x16x64_bf16 v[56:59], v[12:15], v[32:39], v1
ds_read_b128 a[156:159], v4 offset:36864
v_mfma_f32_16x16x32_bf16 v[128:131], a[192:195], v[32:35], v[128:131]
ds_read_b128 a[160:163], v4 offset:40960
v_mfma_f32_16x16x32_bf16 v[128:131], a[196:199], v[36:39], v[128:131]
v_exp_f32 v21, v21
v_mfma_f32_16x16x32_bf16 v[132:135], a[200:203], v[36:39], v[132:135]
ds_read_b128 a[164:167], v5 offset:40960
v_cvt_pk_bf16_f32 v42, v20, v21
v_mfma_f32_16x16x32_bf16 v[132:135], a[204:207], v[32:35], v[132:135]
v_exp_f32 v22, v22
v_mfma_f32_16x16x32_bf16 v[136:139], a[208:211], v[32:35], v[136:139]
ds_read_b128 a[168:171], v6 offset:40960
v_mfma_f32_16x16x32_bf16 v[136:139], a[212:215], v[36:39], v[136:139]
v_exp_f32 v23, v23
v_mfma_f32_16x16x32_bf16 v[140:143], a[216:219], v[36:39], v[140:143]
ds_read_b128 a[172:175], v7 offset:40960
v_cvt_pk_bf16_f32 v43, v22, v23
v_mfma_f32_16x16x32_bf16 v[140:143], a[220:223], v[32:35], v[140:143]
v_exp_f32 v24, v24
v_mfma_f32_16x16x32_bf16 v[144:147], a[224:227], v[32:35], v[144:147]
ds_read_b128 a[176:179], v7 offset:45056
v_mfma_f32_16x16x32_bf16 v[144:147], a[228:231], v[36:39], v[144:147]
v_exp_f32 v25, v25
v_mfma_f32_16x16x32_bf16 v[148:151], a[232:235], v[36:39], v[148:151]
ds_read_b128 a[180:183], v6 offset:45056
v_cvt_pk_bf16_f32 v44, v24, v25
v_mfma_f32_16x16x32_bf16 v[148:151], a[236:239], v[32:35], v[148:151]
v_exp_f32 v26, v26
v_mfma_f32_16x16x32_bf16 v[152:155], a[240:243], v[32:35], v[152:155]
ds_read_b128 a[184:187], v5 offset:45056
v_mfma_f32_16x16x32_bf16 v[152:155], a[244:247], v[36:39], v[152:155]
v_exp_f32 v27, v27
v_mfma_f32_16x16x32_bf16 v[156:159], a[248:251], v[36:39], v[156:159]
ds_read_b128 a[188:191], v4 offset:45056
v_cvt_pk_bf16_f32 v45, v26, v27
v_mfma_f32_16x16x32_bf16 v[156:159], a[252:255], v[32:35], v[156:159]
s_waitcnt lgkmcnt(12)
v_exp_f32 v28, v28
v_mfma_f32_16x16x32_bf16 v[16:19], a[128:131], a[0:3], -4.0
buffer_store_dwordx4 v[200:203], v0, s[20:23], s39 offen offset:128 sc1
v_mfma_f32_16x16x32_bf16 v[16:19], a[132:135], a[4:7], v[16:19]
v_exp_f32 v29, v29
v_mfma_f32_16x16x32_bf16 v[16:19], a[136:139], a[8:11], v[16:19]
v_mfma_f32_16x16x32_bf16 v[16:19], a[140:143], a[12:15], v[16:19]
s_waitcnt lgkmcnt(8)
v_exp_f32 v30, v30
v_mfma_f32_16x16x32_bf16 v[20:23], a[144:147], a[12:15], -4.0
v_cvt_pk_bf16_f32 v46, v28, v29
v_mfma_f32_16x16x32_bf16 v[20:23], a[148:151], a[8:11], v[20:23]
v_exp_f32 v31, v31
v_mfma_f32_16x16x32_bf16 v[20:23], a[152:155], a[4:7], v[20:23]
v_cvt_pk_bf16_f32 v47, v30, v31
v_mfma_f32_16x16x32_bf16 v[20:23], a[156:159], a[0:3], v[20:23]
s_waitcnt lgkmcnt(4)
v_exp_f32 v16, v16
v_mfma_f32_16x16x32_bf16 v[24:27], a[160:163], a[0:3], -4.0
v_mfma_f32_16x16x32_bf16 v[24:27], a[164:167], a[4:7], v[24:27]
v_exp_f32 v17, v17
v_mfma_f32_16x16x32_bf16 v[24:27], a[168:171], a[8:11], v[24:27]
v_cvt_pk_bf16_f32 v32, v16, v17
v_mfma_f32_16x16x32_bf16 v[24:27], a[172:175], a[12:15], v[24:27]
s_waitcnt lgkmcnt(0)
v_exp_f32 v18, v18
v_mfma_f32_16x16x32_bf16 v[28:31], a[176:179], a[12:15], -4.0
v_mfma_f32_16x16x32_bf16 v[28:31], a[180:183], a[8:11], v[28:31]
v_exp_f32 v19, v19
v_mfma_f32_16x16x32_bf16 v[28:31], a[184:187], a[4:7], v[28:31]
v_cvt_pk_bf16_f32 v33, v18, v19
v_mfma_f32_16x16x32_bf16 v[28:31], a[188:191], a[0:3], v[28:31]
s_waitcnt vmcnt(9)
v_exp_f32 v20, v20
v_smfmac_f32_16x16x64_bf16 v[60:63], v[12:15], v[40:47], v1
s_barrier
v_mfma_f32_16x16x32_bf16 v[160:163], a[192:195], v[40:43], v[160:163]
ds_read_b64_tr_b16 a[192:193], v8 offset:0
ds_read_b64_tr_b16 a[194:195], v8 offset:4096
v_mfma_f32_16x16x32_bf16 v[160:163], a[196:199], v[44:47], v[160:163]
v_exp_f32 v21, v21
v_mfma_f32_16x16x32_bf16 v[164:167], a[200:203], v[44:47], v[164:167]
ds_read_b64_tr_b16 a[196:197], v8 offset:8192
v_cvt_pk_bf16_f32 v34, v20, v21
v_mfma_f32_16x16x32_bf16 v[164:167], a[204:207], v[40:43], v[164:167]
v_exp_f32 v22, v22
v_mfma_f32_16x16x32_bf16 v[168:171], a[208:211], v[40:43], v[168:171]
ds_read_b64_tr_b16 a[198:199], v8 offset:12288
ds_read_b64_tr_b16 a[200:201], v9 offset:8192
v_mfma_f32_16x16x32_bf16 v[168:171], a[212:215], v[44:47], v[168:171]
v_exp_f32 v23, v23
v_mfma_f32_16x16x32_bf16 v[172:175], a[216:219], v[44:47], v[172:175]
ds_read_b64_tr_b16 a[202:203], v9 offset:12288
v_cvt_pk_bf16_f32 v35, v22, v23
v_mfma_f32_16x16x32_bf16 v[172:175], a[220:223], v[40:43], v[172:175]
v_exp_f32 v24, v24
v_mfma_f32_16x16x32_bf16 v[176:179], a[224:227], v[40:43], v[176:179]
ds_read_b64_tr_b16 a[204:205], v9 offset:0
ds_read_b64_tr_b16 a[206:207], v9 offset:4096
v_mfma_f32_16x16x32_bf16 v[176:179], a[228:231], v[44:47], v[176:179]
v_exp_f32 v25, v25
v_mfma_f32_16x16x32_bf16 v[180:183], a[232:235], v[44:47], v[180:183]
ds_read_b64_tr_b16 a[208:209], v10 offset:0
v_cvt_pk_bf16_f32 v36, v24, v25
v_mfma_f32_16x16x32_bf16 v[180:183], a[236:239], v[40:43], v[180:183]
v_exp_f32 v26, v26
v_mfma_f32_16x16x32_bf16 v[184:187], a[240:243], v[40:43], v[184:187]
ds_read_b64_tr_b16 a[210:211], v10 offset:4096
ds_read_b64_tr_b16 a[212:213], v10 offset:8192
v_mfma_f32_16x16x32_bf16 v[184:187], a[244:247], v[44:47], v[184:187]
v_exp_f32 v27, v27
v_mfma_f32_16x16x32_bf16 v[188:191], a[248:251], v[44:47], v[188:191]
ds_read_b64_tr_b16 a[214:215], v10 offset:12288
v_cvt_pk_bf16_f32 v37, v26, v27
v_mfma_f32_16x16x32_bf16 v[188:191], a[252:255], v[40:43], v[188:191]
v_exp_f32 v28, v28
v_mfma_f32_16x16x32_bf16 v[16:19], a[128:131], a[16:19], -4.0
buffer_store_dwordx4 v[204:207], v0, s[20:23], s39 offen offset:192 sc1
v_mfma_f32_16x16x32_bf16 v[16:19], a[132:135], a[20:23], v[16:19]
v_exp_f32 v29, v29
v_mfma_f32_16x16x32_bf16 v[16:19], a[136:139], a[24:27], v[16:19]
ds_read_b64_tr_b16 a[216:217], v11 offset:8192
ds_read_b64_tr_b16 a[218:219], v11 offset:12288
v_mfma_f32_16x16x32_bf16 v[16:19], a[140:143], a[28:31], v[16:19]
v_exp_f32 v30, v30
v_mfma_f32_16x16x32_bf16 v[20:23], a[144:147], a[28:31], -4.0
ds_read_b64_tr_b16 a[220:221], v11 offset:0
v_cvt_pk_bf16_f32 v38, v28, v29
v_mfma_f32_16x16x32_bf16 v[20:23], a[148:151], a[24:27], v[20:23]
v_exp_f32 v31, v31
v_mfma_f32_16x16x32_bf16 v[20:23], a[152:155], a[20:23], v[20:23]
ds_read_b64_tr_b16 a[222:223], v11 offset:4096
v_cvt_pk_bf16_f32 v39, v30, v31
v_mfma_f32_16x16x32_bf16 v[20:23], a[156:159], a[16:19], v[20:23]
v_exp_f32 v16, v16
v_mfma_f32_16x16x32_bf16 v[24:27], a[160:163], a[16:19], -4.0
ds_read_b64_tr_b16 a[224:225], v8 offset:1024
ds_read_b64_tr_b16 a[226:227], v8 offset:5120
v_mfma_f32_16x16x32_bf16 v[24:27], a[164:167], a[20:23], v[24:27]
v_exp_f32 v17, v17
v_mfma_f32_16x16x32_bf16 v[24:27], a[168:171], a[24:27], v[24:27]
ds_read_b64_tr_b16 a[228:229], v8 offset:9216
v_cvt_pk_bf16_f32 v40, v16, v17
v_mfma_f32_16x16x32_bf16 v[24:27], a[172:175], a[28:31], v[24:27]
v_exp_f32 v18, v18
v_mfma_f32_16x16x32_bf16 v[28:31], a[176:179], a[28:31], -4.0
ds_read_b64_tr_b16 a[230:231], v8 offset:13312
ds_read_b64_tr_b16 a[232:233], v9 offset:9216
v_mfma_f32_16x16x32_bf16 v[28:31], a[180:183], a[24:27], v[28:31]
v_exp_f32 v19, v19
v_mfma_f32_16x16x32_bf16 v[28:31], a[184:187], a[20:23], v[28:31]
ds_read_b64_tr_b16 a[234:235], v9 offset:13312
v_cvt_pk_bf16_f32 v41, v18, v19
v_mfma_f32_16x16x32_bf16 v[28:31], a[188:191], a[16:19], v[28:31]
v_exp_f32 v20, v20
v_smfmac_f32_16x16x64_bf16 v[48:51], v[12:15], v[32:39], v1
s_waitcnt lgkmcnt(15)
ds_read_b64_tr_b16 a[236:237], v9 offset:1024
v_mfma_f32_16x16x32_bf16 v[64:67], a[192:195], v[32:35], v[64:67]
ds_read_b64_tr_b16 a[238:239], v9 offset:5120
ds_read_b64_tr_b16 a[240:241], v10 offset:1024
v_mfma_f32_16x16x32_bf16 v[64:67], a[196:199], v[36:39], v[64:67]
v_exp_f32 v21, v21
v_mfma_f32_16x16x32_bf16 v[68:71], a[200:203], v[36:39], v[68:71]
s_waitcnt lgkmcnt(15)
ds_read_b64_tr_b16 a[242:243], v10 offset:5120
v_cvt_pk_bf16_f32 v42, v20, v21
v_mfma_f32_16x16x32_bf16 v[68:71], a[204:207], v[32:35], v[68:71]
v_exp_f32 v22, v22
v_mfma_f32_16x16x32_bf16 v[72:75], a[208:211], v[32:35], v[72:75]
s_waitcnt lgkmcnt(14)
ds_read_b64_tr_b16 a[244:245], v10 offset:9216
ds_read_b64_tr_b16 a[246:247], v10 offset:13312
v_mfma_f32_16x16x32_bf16 v[72:75], a[212:215], v[36:39], v[72:75]
s_waitcnt lgkmcnt(12)
v_exp_f32 v23, v23
v_mfma_f32_16x16x32_bf16 v[76:79], a[216:219], v[36:39], v[76:79]
ds_read_b64_tr_b16 a[248:249], v11 offset:9216
ds_read_b64_tr_b16 a[250:251], v11 offset:13312
v_cvt_pk_bf16_f32 v43, v22, v23
v_mfma_f32_16x16x32_bf16 v[76:79], a[220:223], v[32:35], v[76:79]
s_waitcnt lgkmcnt(10)
ds_read_b64_tr_b16 a[252:253], v11 offset:1024
ds_read_b64_tr_b16 a[254:255], v11 offset:5120
v_exp_f32 v24, v24
v_mfma_f32_16x16x32_bf16 v[80:83], a[224:227], v[32:35], v[80:83]
ds_read_b128 a[128:131], v4 offset:49152
v_mfma_f32_16x16x32_bf16 v[80:83], a[228:231], v[36:39], v[80:83]
s_waitcnt lgkmcnt(9)
ds_read_b128 a[132:135], v5 offset:49152
v_exp_f32 v25, v25
v_mfma_f32_16x16x32_bf16 v[84:87], a[232:235], v[36:39], v[84:87]
ds_read_b128 a[136:139], v6 offset:49152
v_cvt_pk_bf16_f32 v44, v24, v25
v_mfma_f32_16x16x32_bf16 v[84:87], a[236:239], v[32:35], v[84:87]
s_waitcnt lgkmcnt(7)
ds_read_b128 a[140:143], v7 offset:49152
v_exp_f32 v26, v26
v_mfma_f32_16x16x32_bf16 v[88:91], a[240:243], v[32:35], v[88:91]
ds_read_b128 a[144:147], v7 offset:53248
v_mfma_f32_16x16x32_bf16 v[88:91], a[244:247], v[36:39], v[88:91]
s_waitcnt lgkmcnt(5)
ds_read_b128 a[148:151], v6 offset:53248
v_exp_f32 v27, v27
v_mfma_f32_16x16x32_bf16 v[92:95], a[248:251], v[36:39], v[92:95]
ds_read_b128 a[152:155], v5 offset:53248
v_cvt_pk_bf16_f32 v45, v26, v27
v_mfma_f32_16x16x32_bf16 v[92:95], a[252:255], v[32:35], v[92:95]
s_waitcnt lgkmcnt(3)
ds_read_b128 a[156:159], v4 offset:53248
v_exp_f32 v28, v28
v_mfma_f32_16x16x32_bf16 v[16:19], a[128:131], a[0:3], -4.0
ds_read_b128 a[160:163], v4 offset:57344
v_mfma_f32_16x16x32_bf16 v[16:19], a[132:135], a[4:7], v[16:19]
ds_read_b128 a[164:167], v5 offset:57344
v_exp_f32 v29, v29
v_mfma_f32_16x16x32_bf16 v[16:19], a[136:139], a[8:11], v[16:19]
ds_read_b128 a[168:171], v6 offset:57344
v_mfma_f32_16x16x32_bf16 v[16:19], a[140:143], a[12:15], v[16:19]
s_waitcnt lgkmcnt(3)
ds_read_b128 a[172:175], v7 offset:57344
v_exp_f32 v30, v30
v_mfma_f32_16x16x32_bf16 v[20:23], a[144:147], a[12:15], -4.0
ds_read_b128 a[176:179], v7 offset:61440
v_cvt_pk_bf16_f32 v46, v28, v29
v_mfma_f32_16x16x32_bf16 v[20:23], a[148:151], a[8:11], v[20:23]
ds_read_b128 a[180:183], v6 offset:61440
v_exp_f32 v31, v31
v_mfma_f32_16x16x32_bf16 v[20:23], a[152:155], a[4:7], v[20:23]
ds_read_b128 a[184:187], v5 offset:61440
v_cvt_pk_bf16_f32 v47, v30, v31
v_mfma_f32_16x16x32_bf16 v[20:23], a[156:159], a[0:3], v[20:23]
s_waitcnt lgkmcnt(3)
ds_read_b128 a[188:191], v4 offset:61440
v_exp_f32 v16, v16
v_mfma_f32_16x16x32_bf16 v[24:27], a[160:163], a[0:3], -4.0
v_mfma_f32_16x16x32_bf16 v[24:27], a[164:167], a[4:7], v[24:27]
v_exp_f32 v17, v17
v_mfma_f32_16x16x32_bf16 v[24:27], a[168:171], a[8:11], v[24:27]
v_cvt_pk_bf16_f32 v32, v16, v17
v_mfma_f32_16x16x32_bf16 v[24:27], a[172:175], a[12:15], v[24:27]
s_waitcnt lgkmcnt(0)
v_exp_f32 v18, v18
v_mfma_f32_16x16x32_bf16 v[28:31], a[176:179], a[12:15], -4.0
v_mfma_f32_16x16x32_bf16 v[28:31], a[180:183], a[8:11], v[28:31]
v_exp_f32 v19, v19
v_mfma_f32_16x16x32_bf16 v[28:31], a[184:187], a[4:7], v[28:31]
v_cvt_pk_bf16_f32 v33, v18, v19
v_mfma_f32_16x16x32_bf16 v[28:31], a[188:191], a[0:3], v[28:31]
s_waitcnt vmcnt(2)
v_exp_f32 v20, v20
v_smfmac_f32_16x16x64_bf16 v[52:55], v[12:15], v[40:47], v1
s_barrier
v_mfma_f32_16x16x32_bf16 v[96:99], a[192:195], v[40:43], v[96:99]
ds_read_b64_tr_b16 a[192:193], v8 offset:16384
ds_read_b64_tr_b16 a[194:195], v8 offset:20480
v_mfma_f32_16x16x32_bf16 v[96:99], a[196:199], v[44:47], v[96:99]
v_exp_f32 v21, v21
v_mfma_f32_16x16x32_bf16 v[100:103], a[200:203], v[44:47], v[100:103]
ds_read_b64_tr_b16 a[196:197], v8 offset:24576
v_cvt_pk_bf16_f32 v34, v20, v21
v_mfma_f32_16x16x32_bf16 v[100:103], a[204:207], v[40:43], v[100:103]
v_exp_f32 v22, v22
v_mfma_f32_16x16x32_bf16 v[104:107], a[208:211], v[40:43], v[104:107]
ds_read_b64_tr_b16 a[198:199], v8 offset:28672
ds_read_b64_tr_b16 a[200:201], v9 offset:24576
v_mfma_f32_16x16x32_bf16 v[104:107], a[212:215], v[44:47], v[104:107]
v_exp_f32 v23, v23
v_mfma_f32_16x16x32_bf16 v[108:111], a[216:219], v[44:47], v[108:111]
ds_read_b64_tr_b16 a[202:203], v9 offset:28672
v_cvt_pk_bf16_f32 v35, v22, v23
v_mfma_f32_16x16x32_bf16 v[108:111], a[220:223], v[40:43], v[108:111]
v_exp_f32 v24, v24
v_mfma_f32_16x16x32_bf16 v[112:115], a[224:227], v[40:43], v[112:115]
ds_read_b64_tr_b16 a[204:205], v9 offset:16384
ds_read_b64_tr_b16 a[206:207], v9 offset:20480
v_mfma_f32_16x16x32_bf16 v[112:115], a[228:231], v[44:47], v[112:115]
v_exp_f32 v25, v25
v_mfma_f32_16x16x32_bf16 v[116:119], a[232:235], v[44:47], v[116:119]
ds_read_b64_tr_b16 a[208:209], v10 offset:16384
v_cvt_pk_bf16_f32 v36, v24, v25
v_mfma_f32_16x16x32_bf16 v[116:119], a[236:239], v[40:43], v[116:119]
v_exp_f32 v26, v26
v_mfma_f32_16x16x32_bf16 v[120:123], a[240:243], v[40:43], v[120:123]
ds_read_b64_tr_b16 a[210:211], v10 offset:20480
ds_read_b64_tr_b16 a[212:213], v10 offset:24576
v_mfma_f32_16x16x32_bf16 v[120:123], a[244:247], v[44:47], v[120:123]
v_exp_f32 v27, v27
v_mfma_f32_16x16x32_bf16 v[124:127], a[248:251], v[44:47], v[124:127]
ds_read_b64_tr_b16 a[214:215], v10 offset:28672
v_cvt_pk_bf16_f32 v37, v26, v27
v_mfma_f32_16x16x32_bf16 v[124:127], a[252:255], v[40:43], v[124:127]
v_exp_f32 v28, v28
v_mfma_f32_16x16x32_bf16 v[16:19], a[128:131], a[16:19], -4.0
ds_read_b64_tr_b16 a[216:217], v11 offset:24576
ds_read_b64_tr_b16 a[218:219], v11 offset:28672
v_mfma_f32_16x16x32_bf16 v[16:19], a[132:135], a[20:23], v[16:19]
v_exp_f32 v29, v29
v_mfma_f32_16x16x32_bf16 v[16:19], a[136:139], a[24:27], v[16:19]
ds_read_b64_tr_b16 a[220:221], v11 offset:16384
ds_read_b64_tr_b16 a[222:223], v11 offset:20480
v_mfma_f32_16x16x32_bf16 v[16:19], a[140:143], a[28:31], v[16:19]
v_exp_f32 v30, v30
v_mfma_f32_16x16x32_bf16 v[20:23], a[144:147], a[28:31], -4.0
ds_read_b64_tr_b16 a[224:225], v8 offset:17408
v_cvt_pk_bf16_f32 v38, v28, v29
v_mfma_f32_16x16x32_bf16 v[20:23], a[148:151], a[24:27], v[20:23]
v_exp_f32 v31, v31
v_mfma_f32_16x16x32_bf16 v[20:23], a[152:155], a[20:23], v[20:23]
ds_read_b64_tr_b16 a[226:227], v8 offset:21504
v_cvt_pk_bf16_f32 v39, v30, v31
v_mfma_f32_16x16x32_bf16 v[20:23], a[156:159], a[16:19], v[20:23]
v_exp_f32 v16, v16
v_mfma_f32_16x16x32_bf16 v[24:27], a[160:163], a[16:19], -4.0
ds_read_b64_tr_b16 a[228:229], v8 offset:25600
ds_read_b64_tr_b16 a[230:231], v8 offset:29696
v_mfma_f32_16x16x32_bf16 v[24:27], a[164:167], a[20:23], v[24:27]
v_exp_f32 v17, v17
v_mfma_f32_16x16x32_bf16 v[24:27], a[168:171], a[24:27], v[24:27]
ds_read_b64_tr_b16 a[232:233], v9 offset:25600
v_cvt_pk_bf16_f32 v40, v16, v17
v_mfma_f32_16x16x32_bf16 v[24:27], a[172:175], a[28:31], v[24:27]
v_exp_f32 v18, v18
v_mfma_f32_16x16x32_bf16 v[28:31], a[176:179], a[28:31], -4.0
ds_read_b64_tr_b16 a[234:235], v9 offset:29696
ds_read_b64_tr_b16 a[236:237], v9 offset:17408
v_mfma_f32_16x16x32_bf16 v[28:31], a[180:183], a[24:27], v[28:31]
v_exp_f32 v19, v19
v_mfma_f32_16x16x32_bf16 v[28:31], a[184:187], a[20:23], v[28:31]
ds_read_b64_tr_b16 a[238:239], v9 offset:21504
v_cvt_pk_bf16_f32 v41, v18, v19
v_mfma_f32_16x16x32_bf16 v[28:31], a[188:191], a[16:19], v[28:31]
v_exp_f32 v20, v20
v_smfmac_f32_16x16x64_bf16 v[48:51], v[12:15], v[32:39], v1
s_waitcnt lgkmcnt(15)
ds_read_b64_tr_b16 a[240:241], v10 offset:17408
v_mfma_f32_16x16x32_bf16 v[64:67], a[192:195], v[32:35], v[64:67]
ds_read_b64_tr_b16 a[242:243], v10 offset:21504
ds_read_b64_tr_b16 a[244:245], v10 offset:25600
v_mfma_f32_16x16x32_bf16 v[64:67], a[196:199], v[36:39], v[64:67]
v_exp_f32 v21, v21
v_mfma_f32_16x16x32_bf16 v[68:71], a[200:203], v[36:39], v[68:71]
ds_read_b64_tr_b16 a[246:247], v10 offset:29696
v_cvt_pk_bf16_f32 v42, v20, v21
v_mfma_f32_16x16x32_bf16 v[68:71], a[204:207], v[32:35], v[68:71]
s_waitcnt lgkmcnt(15)
v_exp_f32 v22, v22
v_mfma_f32_16x16x32_bf16 v[72:75], a[208:211], v[32:35], v[72:75]
ds_read_b64_tr_b16 a[248:249], v11 offset:25600
ds_read_b64_tr_b16 a[250:251], v11 offset:29696
v_mfma_f32_16x16x32_bf16 v[72:75], a[212:215], v[36:39], v[72:75]
s_waitcnt lgkmcnt(14)
v_exp_f32 v23, v23
v_mfma_f32_16x16x32_bf16 v[76:79], a[216:219], v[36:39], v[76:79]
ds_read_b64_tr_b16 a[252:253], v11 offset:17408
v_cvt_pk_bf16_f32 v43, v22, v23
v_mfma_f32_16x16x32_bf16 v[76:79], a[220:223], v[32:35], v[76:79]
s_waitcnt lgkmcnt(11)
ds_read_b64_tr_b16 a[254:255], v11 offset:21504
v_exp_f32 v24, v24
v_mfma_f32_16x16x32_bf16 v[80:83], a[224:227], v[32:35], v[80:83]
v_add_f32 v51, v48, v49
v_rcp_f32 v50, v51
v_mfma_f32_16x16x32_bf16 v[80:83], a[228:231], v[36:39], v[80:83]
s_waitcnt lgkmcnt(8)
v_exp_f32 v25, v25
v_mfma_f32_16x16x32_bf16 v[84:87], a[232:235], v[36:39], v[84:87]
v_cvt_pk_bf16_f32 v44, v24, v25
v_subrev_u32 v51, 0x2f800000, v51
v_mfma_f32_16x16x32_bf16 v[84:87], a[236:239], v[32:35], v[84:87]
s_waitcnt lgkmcnt(4)
v_exp_f32 v26, v26
v_mfma_f32_16x16x32_bf16 v[88:91], a[240:243], v[32:35], v[88:91]
v_max_u32 v3, v3, v51
v_mfma_f32_16x16x32_bf16 v[88:91], a[244:247], v[36:39], v[88:91]
s_waitcnt lgkmcnt(0)
v_exp_f32 v27, v27
v_mfma_f32_16x16x32_bf16 v[92:95], a[248:251], v[36:39], v[92:95]
L_pg13:
s_cbranch_vccnz L_ret
v_cvt_pk_bf16_f32 v45, v26, v27
v_mfma_f32_16x16x32_bf16 v[92:95], a[252:255], v[32:35], v[92:95]
v_exp_f32 v28, v28
v_mfma_f32_16x16x32_bf16 v[16:19], a[128:131], a[32:35], -4.0
v_mfma_f32_16x16x32_bf16 v[16:19], a[132:135], a[36:39], v[16:19]
v_exp_f32 v29, v29
v_mfma_f32_16x16x32_bf16 v[16:19], a[136:139], a[40:43], v[16:19]
v_mfma_f32_16x16x32_bf16 v[16:19], a[140:143], a[44:47], v[16:19]
v_exp_f32 v30, v30
v_pk_mul_f32 v[64:65], v[64:65], v[50:51] op_sel_hi:[1,0]
v_pk_mul_f32 v[66:67], v[66:67], v[50:51] op_sel_hi:[1,0]
v_pk_mul_f32 v[68:69], v[68:69], v[50:51] op_sel_hi:[1,0]
v_pk_mul_f32 v[70:71], v[70:71], v[50:51] op_sel_hi:[1,0]
v_pk_mul_f32 v[72:73], v[72:73], v[50:51] op_sel_hi:[1,0]
v_pk_mul_f32 v[74:75], v[74:75], v[50:51] op_sel_hi:[1,0]
v_pk_mul_f32 v[76:77], v[76:77], v[50:51] op_sel_hi:[1,0]
v_pk_mul_f32 v[78:79], v[78:79], v[50:51] op_sel_hi:[1,0]
v_pk_mul_f32 v[80:81], v[80:81], v[50:51] op_sel_hi:[1,0]
v_pk_mul_f32 v[82:83], v[82:83], v[50:51] op_sel_hi:[1,0]
v_pk_mul_f32 v[84:85], v[84:85], v[50:51] op_sel_hi:[1,0]
v_pk_mul_f32 v[86:87], v[86:87], v[50:51] op_sel_hi:[1,0]
v_pk_mul_f32 v[88:89], v[88:89], v[50:51] op_sel_hi:[1,0]
v_pk_mul_f32 v[90:91], v[90:91], v[50:51] op_sel_hi:[1,0]
v_pk_mul_f32 v[92:93], v[92:93], v[50:51] op_sel_hi:[1,0]
v_pk_mul_f32 v[94:95], v[94:95], v[50:51] op_sel_hi:[1,0]
v_mfma_f32_16x16x32_bf16 v[20:23], a[144:147], a[44:47], -4.0
v_cvt_pk_bf16_f32 v46, v28, v29
v_cvt_pk_bf16_f32 v64, v64, v65
v_mfma_f32_16x16x32_bf16 v[20:23], a[148:151], a[40:43], v[20:23]
v_exp_f32 v31, v31
v_mfma_f32_16x16x32_bf16 v[20:23], a[152:155], a[36:39], v[20:23]
v_cvt_pk_bf16_f32 v47, v30, v31
v_cvt_pk_bf16_f32 v65, v66, v67
v_mfma_f32_16x16x32_bf16 v[20:23], a[156:159], a[32:35], v[20:23]
v_exp_f32 v16, v16
v_mfma_f32_16x16x32_bf16 v[24:27], a[160:163], a[32:35], -4.0
ds_write_b64 v224, v[64:65] offset:0
v_mfma_f32_16x16x32_bf16 v[24:27], a[164:167], a[36:39], v[24:27]
v_exp_f32 v17, v17
v_mfma_f32_16x16x32_bf16 v[24:27], a[168:171], a[40:43], v[24:27]
v_cvt_pk_bf16_f32 v32, v16, v17
v_cvt_pk_bf16_f32 v68, v68, v69
v_mfma_f32_16x16x32_bf16 v[24:27], a[172:175], a[44:47], v[24:27]
v_exp_f32 v18, v18
v_mfma_f32_16x16x32_bf16 v[28:31], a[176:179], a[44:47], -4.0
v_cvt_pk_bf16_f32 v69, v70, v71
v_cvt_pk_bf16_f32 v72, v72, v73
v_mfma_f32_16x16x32_bf16 v[28:31], a[180:183], a[40:43], v[28:31]
v_exp_f32 v19, v19
v_mfma_f32_16x16x32_bf16 v[28:31], a[184:187], a[36:39], v[28:31]
ds_write_b64 v225, v[68:69] offset:0
v_cvt_pk_bf16_f32 v33, v18, v19
v_mfma_f32_16x16x32_bf16 v[28:31], a[188:191], a[32:35], v[28:31]
v_exp_f32 v20, v20
v_smfmac_f32_16x16x64_bf16 v[52:55], v[12:15], v[40:47], v1
v_cvt_pk_bf16_f32 v73, v74, v75
v_mfma_f32_16x16x32_bf16 v[96:99], a[192:195], v[40:43], v[96:99]
ds_write_b64 v226, v[72:73] offset:0
v_mfma_f32_16x16x32_bf16 v[96:99], a[196:199], v[44:47], v[96:99]
v_exp_f32 v21, v21
v_mfma_f32_16x16x32_bf16 v[100:103], a[200:203], v[44:47], v[100:103]
v_cvt_pk_bf16_f32 v34, v20, v21
v_cvt_pk_bf16_f32 v76, v76, v77
v_mfma_f32_16x16x32_bf16 v[100:103], a[204:207], v[40:43], v[100:103]
v_exp_f32 v22, v22
v_mfma_f32_16x16x32_bf16 v[104:107], a[208:211], v[40:43], v[104:107]
v_cvt_pk_bf16_f32 v77, v78, v79
v_cvt_pk_bf16_f32 v80, v80, v81
v_mfma_f32_16x16x32_bf16 v[104:107], a[212:215], v[44:47], v[104:107]
v_exp_f32 v23, v23
v_mfma_f32_16x16x32_bf16 v[108:111], a[216:219], v[44:47], v[108:111]
ds_write_b64 v227, v[76:77] offset:0
v_cvt_pk_bf16_f32 v35, v22, v23
v_mfma_f32_16x16x32_bf16 v[108:111], a[220:223], v[40:43], v[108:111]
v_exp_f32 v24, v24
v_mfma_f32_16x16x32_bf16 v[112:115], a[224:227], v[40:43], v[112:115]
v_cvt_pk_bf16_f32 v81, v82, v83
v_cvt_pk_bf16_f32 v84, v84, v85
v_mfma_f32_16x16x32_bf16 v[112:115], a[228:231], v[44:47], v[112:115]
v_exp_f32 v25, v25
v_mfma_f32_16x16x32_bf16 v[116:119], a[232:235], v[44:47], v[116:119]
ds_write_b64 v228, v[80:81] offset:0
v_cvt_pk_bf16_f32 v36, v24, v25
v_mfma_f32_16x16x32_bf16 v[116:119], a[236:239], v[40:43], v[116:119]
v_exp_f32 v26, v26
v_cvt_pk_bf16_f32 v85, v86, v87
v_mfma_f32_16x16x32_bf16 v[120:123], a[240:243], v[40:43], v[120:123]
ds_write_b64 v229, v[84:85] offset:0
v_cvt_pk_bf16_f32 v88, v88, v89
v_cvt_pk_bf16_f32 v89, v90, v91
v_mfma_f32_16x16x32_bf16 v[120:123], a[244:247], v[44:47], v[120:123]
ds_write_b64 v230, v[88:89] offset:0
v_exp_f32 v27, v27
v_cvt_pk_bf16_f32 v92, v92, v93
v_cvt_pk_bf16_f32 v93, v94, v95
v_mfma_f32_16x16x32_bf16 v[124:127], a[248:251], v[44:47], v[124:127]
ds_write_b64 v231, v[92:93] offset:0
v_cvt_pk_bf16_f32 v37, v26, v27
v_mfma_f32_16x16x32_bf16 v[124:127], a[252:255], v[40:43], v[124:127]
ds_read_b128 v[64:67], v248 offset:0
v_exp_f32 v28, v28
v_mfma_f32_16x16x32_bf16 v[16:19], a[128:131], a[48:51], -4.0
ds_read_b128 v[72:75], v248 offset:1024
v_add_f32 v55, v52, v53
v_mfma_f32_16x16x32_bf16 v[16:19], a[132:135], a[52:55], v[16:19]
ds_read_b128 v[80:83], v248 offset:2048
v_exp_f32 v29, v29
v_rcp_f32 v54, v55
v_mfma_f32_16x16x32_bf16 v[16:19], a[136:139], a[56:59], v[16:19]
ds_read_b128 v[88:91], v248 offset:3072
v_subrev_u32 v55, 0x2f800000, v55
v_mfma_f32_16x16x32_bf16 v[16:19], a[140:143], a[60:63], v[16:19]
v_exp_f32 v30, v30
v_pk_mul_f32 v[96:97], v[96:97], v[54:55] op_sel_hi:[1,0]
v_pk_mul_f32 v[98:99], v[98:99], v[54:55] op_sel_hi:[1,0]
v_pk_mul_f32 v[100:101], v[100:101], v[54:55] op_sel_hi:[1,0]
v_pk_mul_f32 v[102:103], v[102:103], v[54:55] op_sel_hi:[1,0]
v_pk_mul_f32 v[104:105], v[104:105], v[54:55] op_sel_hi:[1,0]
v_pk_mul_f32 v[106:107], v[106:107], v[54:55] op_sel_hi:[1,0]
v_pk_mul_f32 v[108:109], v[108:109], v[54:55] op_sel_hi:[1,0]
v_pk_mul_f32 v[110:111], v[110:111], v[54:55] op_sel_hi:[1,0]
v_pk_mul_f32 v[112:113], v[112:113], v[54:55] op_sel_hi:[1,0]
v_pk_mul_f32 v[114:115], v[114:115], v[54:55] op_sel_hi:[1,0]
v_pk_mul_f32 v[116:117], v[116:117], v[54:55] op_sel_hi:[1,0]
v_pk_mul_f32 v[118:119], v[118:119], v[54:55] op_sel_hi:[1,0]
v_pk_mul_f32 v[120:121], v[120:121], v[54:55] op_sel_hi:[1,0]
v_pk_mul_f32 v[122:123], v[122:123], v[54:55] op_sel_hi:[1,0]
v_pk_mul_f32 v[124:125], v[124:125], v[54:55] op_sel_hi:[1,0]
v_pk_mul_f32 v[126:127], v[126:127], v[54:55] op_sel_hi:[1,0]
v_mfma_f32_16x16x32_bf16 v[20:23], a[144:147], a[60:63], -4.0
s_waitcnt lgkmcnt(3)
buffer_store_dwordx4 v[64:67], v244, s[20:23], s40 offen offset:0 sc1
v_cvt_pk_bf16_f32 v38, v28, v29
v_mfma_f32_16x16x32_bf16 v[20:23], a[148:151], a[56:59], v[20:23]
v_exp_f32 v31, v31
v_mfma_f32_16x16x32_bf16 v[20:23], a[152:155], a[52:55], v[20:23]
ds_read_b128 a[128:131], v4 offset:32768
v_cvt_pk_bf16_f32 v39, v30, v31
v_mfma_f32_16x16x32_bf16 v[20:23], a[156:159], a[48:51], v[20:23]
s_waitcnt lgkmcnt(3)
buffer_store_dwordx4 v[72:75], v245, s[20:23], s40 offen offset:1024 sc1
v_exp_f32 v16, v16
v_mfma_f32_16x16x32_bf16 v[24:27], a[160:163], a[48:51], -4.0
ds_read_b128 a[132:135], v5 offset:32768
v_cvt_pk_bf16_f32 v96, v96, v97
v_mfma_f32_16x16x32_bf16 v[24:27], a[164:167], a[52:55], v[24:27]
s_waitcnt lgkmcnt(3)
buffer_store_dwordx4 v[80:83], v246, s[20:23], s40 offen offset:2048 sc1
v_exp_f32 v17, v17
v_mfma_f32_16x16x32_bf16 v[24:27], a[168:171], a[56:59], v[24:27]
ds_read_b128 a[136:139], v6 offset:32768
v_cvt_pk_bf16_f32 v40, v16, v17
v_mfma_f32_16x16x32_bf16 v[24:27], a[172:175], a[60:63], v[24:27]
s_waitcnt lgkmcnt(3)
buffer_store_dwordx4 v[88:91], v247, s[20:23], s40 offen offset:3072 sc1
v_exp_f32 v18, v18
v_mfma_f32_16x16x32_bf16 v[28:31], a[176:179], a[60:63], -4.0
ds_read_b128 a[140:143], v7 offset:32768
v_cvt_pk_bf16_f32 v97, v98, v99
v_mfma_f32_16x16x32_bf16 v[28:31], a[180:183], a[56:59], v[28:31]
v_exp_f32 v19, v19
v_mfma_f32_16x16x32_bf16 v[28:31], a[184:187], a[52:55], v[28:31]
ds_read_b128 a[144:147], v7 offset:36864
v_cvt_pk_bf16_f32 v41, v18, v19
v_mfma_f32_16x16x32_bf16 v[28:31], a[188:191], a[48:51], v[28:31]
v_exp_f32 v20, v20
v_smfmac_f32_16x16x64_bf16 v[56:59], v[12:15], v[32:39], v1
ds_read_b128 a[148:151], v6 offset:36864
v_mfma_f32_16x16x32_bf16 v[128:131], a[192:195], v[32:35], v[128:131]
ds_read_b128 a[152:155], v5 offset:36864
v_cvt_pk_bf16_f32 v100, v100, v101
v_mfma_f32_16x16x32_bf16 v[128:131], a[196:199], v[36:39], v[128:131]
v_exp_f32 v21, v21
v_mfma_f32_16x16x32_bf16 v[132:135], a[200:203], v[36:39], v[132:135]
ds_read_b128 a[156:159], v4 offset:36864
v_cvt_pk_bf16_f32 v42, v20, v21
v_mfma_f32_16x16x32_bf16 v[132:135], a[204:207], v[32:35], v[132:135]
v_exp_f32 v22, v22
v_mfma_f32_16x16x32_bf16 v[136:139], a[208:211], v[32:35], v[136:139]
ds_read_b128 a[160:163], v4 offset:40960
v_cvt_pk_bf16_f32 v101, v102, v103
v_mfma_f32_16x16x32_bf16 v[136:139], a[212:215], v[36:39], v[136:139]
v_exp_f32 v23, v23
v_mfma_f32_16x16x32_bf16 v[140:143], a[216:219], v[36:39], v[140:143]
ds_read_b128 a[164:167], v5 offset:40960
v_cvt_pk_bf16_f32 v43, v22, v23
v_mfma_f32_16x16x32_bf16 v[140:143], a[220:223], v[32:35], v[140:143]
v_exp_f32 v24, v24
v_mfma_f32_16x16x32_bf16 v[144:147], a[224:227], v[32:35], v[144:147]
ds_read_b128 a[168:171], v6 offset:40960
v_cvt_pk_bf16_f32 v104, v104, v105
v_mfma_f32_16x16x32_bf16 v[144:147], a[228:231], v[36:39], v[144:147]
v_exp_f32 v25, v25
v_mfma_f32_16x16x32_bf16 v[148:151], a[232:235], v[36:39], v[148:151]
ds_read_b128 a[172:175], v7 offset:40960
v_cvt_pk_bf16_f32 v44, v24, v25
v_mfma_f32_16x16x32_bf16 v[148:151], a[236:239], v[32:35], v[148:151]
v_exp_f32 v26, v26
v_mfma_f32_16x16x32_bf16 v[152:155], a[240:243], v[32:35], v[152:155]
ds_read_b128 a[176:179], v7 offset:45056
v_cvt_pk_bf16_f32 v105, v106, v107
v_mfma_f32_16x16x32_bf16 v[152:155], a[244:247], v[36:39], v[152:155]
v_exp_f32 v27, v27
v_mfma_f32_16x16x32_bf16 v[156:159], a[248:251], v[36:39], v[156:159]
ds_read_b128 a[180:183], v6 offset:45056
v_cvt_pk_bf16_f32 v45, v26, v27
v_mfma_f32_16x16x32_bf16 v[156:159], a[252:255], v[32:35], v[156:159]
s_waitcnt lgkmcnt(10)
v_exp_f32 v28, v28
v_mfma_f32_16x16x32_bf16 v[16:19], a[128:131], a[32:35], -4.0
ds_read_b128 a[184:187], v5 offset:45056
v_cvt_pk_bf16_f32 v108, v108, v109
v_mfma_f32_16x16x32_bf16 v[16:19], a[132:135], a[36:39], v[16:19]
v_exp_f32 v29, v29
v_mfma_f32_16x16x32_bf16 v[16:19], a[136:139], a[40:43], v[16:19]
ds_write_b64 v224, v[96:97] offset:16384
v_mfma_f32_16x16x32_bf16 v[16:19], a[140:143], a[44:47], v[16:19]
s_waitcnt lgkmcnt(8)
v_exp_f32 v30, v30
v_mfma_f32_16x16x32_bf16 v[20:23], a[144:147], a[44:47], -4.0
ds_read_b128 a[188:191], v4 offset:45056
v_cvt_pk_bf16_f32 v46, v28, v29
v_mfma_f32_16x16x32_bf16 v[20:23], a[148:151], a[40:43], v[20:23]
v_exp_f32 v31, v31
v_mfma_f32_16x16x32_bf16 v[20:23], a[152:155], a[36:39], v[20:23]
ds_write_b64 v225, v[100:101] offset:16384
v_cvt_pk_bf16_f32 v47, v30, v31
v_mfma_f32_16x16x32_bf16 v[20:23], a[156:159], a[32:35], v[20:23]
s_waitcnt lgkmcnt(6)
v_exp_f32 v16, v16
v_mfma_f32_16x16x32_bf16 v[24:27], a[160:163], a[32:35], -4.0
ds_write_b64 v226, v[104:105] offset:16384
v_cvt_pk_bf16_f32 v109, v110, v111
v_mfma_f32_16x16x32_bf16 v[24:27], a[164:167], a[36:39], v[24:27]
ds_write_b64 v227, v[108:109] offset:16384
v_exp_f32 v17, v17
v_cvt_pk_bf16_f32 v112, v112, v113
v_cvt_pk_bf16_f32 v113, v114, v115
v_mfma_f32_16x16x32_bf16 v[24:27], a[168:171], a[40:43], v[24:27]
ds_write_b64 v228, v[112:113] offset:16384
v_cvt_pk_bf16_f32 v32, v16, v17
v_cvt_pk_bf16_f32 v116, v116, v117
v_cvt_pk_bf16_f32 v117, v118, v119
v_mfma_f32_16x16x32_bf16 v[24:27], a[172:175], a[44:47], v[24:27]
s_waitcnt lgkmcnt(4)
ds_write_b64 v229, v[116:117] offset:16384
v_exp_f32 v18, v18
v_cvt_pk_bf16_f32 v120, v120, v121
v_cvt_pk_bf16_f32 v121, v122, v123
v_mfma_f32_16x16x32_bf16 v[28:31], a[176:179], a[44:47], -4.0
ds_write_b64 v230, v[120:121] offset:16384
v_cvt_pk_bf16_f32 v124, v124, v125
v_cvt_pk_bf16_f32 v125, v126, v127
v_mfma_f32_16x16x32_bf16 v[28:31], a[180:183], a[40:43], v[28:31]
ds_write_b64 v231, v[124:125] offset:16384
v_exp_f32 v19, v19
v_mfma_f32_16x16x32_bf16 v[28:31], a[184:187], a[36:39], v[28:31]
ds_read_b128 v[96:99], v248 offset:16384
v_cvt_pk_bf16_f32 v33, v18, v19
v_mfma_f32_16x16x32_bf16 v[28:31], a[188:191], a[32:35], v[28:31]
ds_read_b128 v[104:107], v248 offset:17408
v_exp_f32 v20, v20
v_smfmac_f32_16x16x64_bf16 v[60:63], v[12:15], v[40:47], v1
ds_read_b128 v[112:115], v248 offset:18432
v_mfma_f32_16x16x32_bf16 v[160:163], a[192:195], v[40:43], v[160:163]
ds_read_b128 v[120:123], v248 offset:19456
ds_read_b64_tr_b16 a[192:193], v8 offset:0
v_mfma_f32_16x16x32_bf16 v[160:163], a[196:199], v[44:47], v[160:163]
v_exp_f32 v21, v21
v_mfma_f32_16x16x32_bf16 v[164:167], a[200:203], v[44:47], v[164:167]
s_waitcnt lgkmcnt(4)
buffer_store_dwordx4 v[96:99], v244, s[20:23], s41 offen offset:0 sc1
v_cvt_pk_bf16_f32 v34, v20, v21
v_mfma_f32_16x16x32_bf16 v[164:167], a[204:207], v[40:43], v[164:167]
v_exp_f32 v22, v22
v_mfma_f32_16x16x32_bf16 v[168:171], a[208:211], v[40:43], v[168:171]
ds_read_b64_tr_b16 a[194:195], v8 offset:4096
ds_read_b64_tr_b16 a[196:197], v8 offset:8192
v_mfma_f32_16x16x32_bf16 v[168:171], a[212:215], v[44:47], v[168:171]
s_waitcnt lgkmcnt(5)
buffer_store_dwordx4 v[104:107], v245, s[20:23], s41 offen offset:1024 sc1
v_exp_f32 v23, v23
v_mfma_f32_16x16x32_bf16 v[172:175], a[216:219], v[44:47], v[172:175]
ds_read_b64_tr_b16 a[198:199], v8 offset:12288
v_cvt_pk_bf16_f32 v35, v22, v23
v_mfma_f32_16x16x32_bf16 v[172:175], a[220:223], v[40:43], v[172:175]
s_waitcnt lgkmcnt(5)
buffer_store_dwordx4 v[112:115], v246, s[20:23], s41 offen offset:2048 sc1
v_exp_f32 v24, v24
v_mfma_f32_16x16x32_bf16 v[176:179], a[224:227], v[40:43], v[176:179]
ds_read_b64_tr_b16 a[200:201], v9 offset:8192
ds_read_b64_tr_b16 a[202:203], v9 offset:12288
v_mfma_f32_16x16x32_bf16 v[176:179], a[228:231], v[44:47], v[176:179]
s_waitcnt lgkmcnt(6)
buffer_store_dwordx4 v[120:123], v247, s[20:23], s41 offen offset:3072 sc1
v_exp_f32 v25, v25
v_max_u32 v3, v3, v55
v_mfma_f32_16x16x32_bf16 v[180:183], a[232:235], v[44:47], v[180:183]
ds_read_b64_tr_b16 a[204:205], v9 offset:0
v_cvt_pk_bf16_f32 v36, v24, v25
v_mfma_f32_16x16x32_bf16 v[180:183], a[236:239], v[40:43], v[180:183]
v_exp_f32 v26, v26
v_mfma_f32_16x16x32_bf16 v[184:187], a[240:243], v[40:43], v[184:187]
ds_read_b64_tr_b16 a[206:207], v9 offset:4096
ds_read_b64_tr_b16 a[208:209], v10 offset:0
v_mfma_f32_16x16x32_bf16 v[184:187], a[244:247], v[44:47], v[184:187]
v_exp_f32 v27, v27
v_mfma_f32_16x16x32_bf16 v[188:191], a[248:251], v[44:47], v[188:191]
ds_read_b64_tr_b16 a[210:211], v10 offset:4096
v_cvt_pk_bf16_f32 v37, v26, v27
v_mfma_f32_16x16x32_bf16 v[188:191], a[252:255], v[40:43], v[188:191]
v_exp_f32 v28, v28
v_mfma_f32_16x16x32_bf16 v[16:19], a[128:131], a[48:51], -4.0
ds_read_b64_tr_b16 a[212:213], v10 offset:8192
ds_read_b64_tr_b16 a[214:215], v10 offset:12288
v_mfma_f32_16x16x32_bf16 v[16:19], a[132:135], a[52:55], v[16:19]
v_exp_f32 v29, v29
v_mfma_f32_16x16x32_bf16 v[16:19], a[136:139], a[56:59], v[16:19]
ds_read_b64_tr_b16 a[216:217], v11 offset:8192
ds_read_b64_tr_b16 a[218:219], v11 offset:12288
v_mfma_f32_16x16x32_bf16 v[16:19], a[140:143], a[60:63], v[16:19]
v_exp_f32 v30, v30
v_mfma_f32_16x16x32_bf16 v[20:23], a[144:147], a[60:63], -4.0
ds_read_b64_tr_b16 a[220:221], v11 offset:0
v_cvt_pk_bf16_f32 v38, v28, v29
v_mfma_f32_16x16x32_bf16 v[20:23], a[148:151], a[56:59], v[20:23]
v_exp_f32 v31, v31
v_mfma_f32_16x16x32_bf16 v[20:23], a[152:155], a[52:55], v[20:23]
ds_read_b64_tr_b16 a[222:223], v11 offset:4096
v_cvt_pk_bf16_f32 v39, v30, v31
v_mfma_f32_16x16x32_bf16 v[20:23], a[156:159], a[48:51], v[20:23]
v_exp_f32 v16, v16
v_mfma_f32_16x16x32_bf16 v[24:27], a[160:163], a[48:51], -4.0
ds_read_b64_tr_b16 a[224:225], v8 offset:1024
ds_read_b64_tr_b16 a[226:227], v8 offset:5120
v_mfma_f32_16x16x32_bf16 v[24:27], a[164:167], a[52:55], v[24:27]
v_exp_f32 v17, v17
v_mfma_f32_16x16x32_bf16 v[24:27], a[168:171], a[56:59], v[24:27]
ds_read_b64_tr_b16 a[228:229], v8 offset:9216
v_cvt_pk_bf16_f32 v40, v16, v17
v_mfma_f32_16x16x32_bf16 v[24:27], a[172:175], a[60:63], v[24:27]
v_exp_f32 v18, v18
v_mfma_f32_16x16x32_bf16 v[28:31], a[176:179], a[60:63], -4.0
ds_read_b64_tr_b16 a[230:231], v8 offset:13312
ds_read_b64_tr_b16 a[232:233], v9 offset:9216
v_mfma_f32_16x16x32_bf16 v[28:31], a[180:183], a[56:59], v[28:31]
v_exp_f32 v19, v19
v_mfma_f32_16x16x32_bf16 v[28:31], a[184:187], a[52:55], v[28:31]
ds_read_b64_tr_b16 a[234:235], v9 offset:13312
v_cvt_pk_bf16_f32 v41, v18, v19
v_mfma_f32_16x16x32_bf16 v[28:31], a[188:191], a[48:51], v[28:31]
v_exp_f32 v20, v20
v_smfmac_f32_16x16x64_bf16 v[56:59], v[12:15], v[32:39], v1
s_waitcnt lgkmcnt(15)
ds_read_b64_tr_b16 a[236:237], v9 offset:1024
v_mfma_f32_16x16x32_bf16 v[128:131], a[192:195], v[32:35], v[128:131]
ds_read_b64_tr_b16 a[238:239], v9 offset:5120
ds_read_b64_tr_b16 a[240:241], v10 offset:1024
v_mfma_f32_16x16x32_bf16 v[128:131], a[196:199], v[36:39], v[128:131]
v_exp_f32 v21, v21
v_mfma_f32_16x16x32_bf16 v[132:135], a[200:203], v[36:39], v[132:135]
s_waitcnt lgkmcnt(15)
ds_read_b64_tr_b16 a[242:243], v10 offset:5120
v_cvt_pk_bf16_f32 v42, v20, v21
v_mfma_f32_16x16x32_bf16 v[132:135], a[204:207], v[32:35], v[132:135]
v_exp_f32 v22, v22
v_mfma_f32_16x16x32_bf16 v[136:139], a[208:211], v[32:35], v[136:139]
s_waitcnt lgkmcnt(14)
v_exp_f32 v29, v29
v_mfma_f32_16x16x32_bf16 v[136:139], a[212:215], v[36:39], v[136:139]
s_waitcnt lgkmcnt(10)
ds_read_b64_tr_b16 a[244:245], v10 offset:9216
ds_read_b64_tr_b16 a[246:247], v10 offset:13312
v_exp_f32 v23, v23
v_mfma_f32_16x16x32_bf16 v[140:143], a[216:219], v[36:39], v[140:143]
ds_read_b64_tr_b16 a[248:249], v11 offset:9216
ds_read_b64_tr_b16 a[250:251], v11 offset:13312
v_cvt_pk_bf16_f32 v43, v22, v23
v_mfma_f32_16x16x32_bf16 v[140:143], a[220:223], v[32:35], v[140:143]
s_waitcnt lgkmcnt(10)
ds_read_b64_tr_b16 a[252:253], v11 offset:1024
ds_read_b64_tr_b16 a[254:255], v11 offset:5120
v_exp_f32 v24, v24
v_mfma_f32_16x16x32_bf16 v[144:147], a[224:227], v[32:35], v[144:147]
v_exp_f32 v30, v30
v_mfma_f32_16x16x32_bf16 v[144:147], a[228:231], v[36:39], v[144:147]
s_waitcnt lgkmcnt(8)
v_exp_f32 v25, v25
v_mfma_f32_16x16x32_bf16 v[148:151], a[232:235], v[36:39], v[148:151]
v_cvt_pk_bf16_f32 v44, v24, v25
v_add_f32 v59, v56, v57
v_mfma_f32_16x16x32_bf16 v[148:151], a[236:239], v[32:35], v[148:151]
s_waitcnt lgkmcnt(4)
v_exp_f32 v26, v26
v_mfma_f32_16x16x32_bf16 v[152:155], a[240:243], v[32:35], v[152:155]
v_exp_f32 v31, v31
v_mfma_f32_16x16x32_bf16 v[152:155], a[244:247], v[36:39], v[152:155]
s_waitcnt lgkmcnt(0)
v_exp_f32 v27, v27
v_mfma_f32_16x16x32_bf16 v[156:159], a[248:251], v[36:39], v[156:159]
v_cvt_pk_bf16_f32 v45, v26, v27
v_cvt_pk_bf16_f32 v47, v30, v31
v_rcp_f32 v58, v59
v_mfma_f32_16x16x32_bf16 v[156:159], a[252:255], v[32:35], v[156:159]
v_exp_f32 v28, v28
s_nop 0
v_cvt_pk_bf16_f32 v46, v28, v29
v_subrev_u32 v59, 0x2f800000, v59
v_max_u32 v3, v3, v59
v_smfmac_f32_16x16x64_bf16 v[60:63], v[12:15], v[40:47], v1
v_mfma_f32_16x16x32_bf16 v[160:163], a[192:195], v[40:43], v[160:163]
v_mfma_f32_16x16x32_bf16 v[160:163], a[196:199], v[44:47], v[160:163]
v_mfma_f32_16x16x32_bf16 v[164:167], a[200:203], v[44:47], v[164:167]
v_pk_mul_f32 v[128:129], v[128:129], v[58:59] op_sel_hi:[1,0]
v_pk_mul_f32 v[130:131], v[130:131], v[58:59] op_sel_hi:[1,0]
v_pk_mul_f32 v[132:133], v[132:133], v[58:59] op_sel_hi:[1,0]
v_pk_mul_f32 v[134:135], v[134:135], v[58:59] op_sel_hi:[1,0]
v_pk_mul_f32 v[136:137], v[136:137], v[58:59] op_sel_hi:[1,0]
v_pk_mul_f32 v[138:139], v[138:139], v[58:59] op_sel_hi:[1,0]
v_pk_mul_f32 v[140:141], v[140:141], v[58:59] op_sel_hi:[1,0]
v_pk_mul_f32 v[142:143], v[142:143], v[58:59] op_sel_hi:[1,0]
v_pk_mul_f32 v[144:145], v[144:145], v[58:59] op_sel_hi:[1,0]
v_pk_mul_f32 v[146:147], v[146:147], v[58:59] op_sel_hi:[1,0]
v_pk_mul_f32 v[148:149], v[148:149], v[58:59] op_sel_hi:[1,0]
v_pk_mul_f32 v[150:151], v[150:151], v[58:59] op_sel_hi:[1,0]
v_pk_mul_f32 v[152:153], v[152:153], v[58:59] op_sel_hi:[1,0]
v_pk_mul_f32 v[154:155], v[154:155], v[58:59] op_sel_hi:[1,0]
v_pk_mul_f32 v[156:157], v[156:157], v[58:59] op_sel_hi:[1,0]
v_pk_mul_f32 v[158:159], v[158:159], v[58:59] op_sel_hi:[1,0]
v_cvt_pk_bf16_f32 v128, v128, v129
v_cvt_pk_bf16_f32 v129, v130, v131
v_cvt_pk_bf16_f32 v132, v132, v133
v_cvt_pk_bf16_f32 v133, v134, v135
v_mfma_f32_16x16x32_bf16 v[164:167], a[204:207], v[40:43], v[164:167]
ds_write_b64 v224, v[128:129] offset:32768
ds_write_b64 v225, v[132:133] offset:32768
v_cvt_pk_bf16_f32 v136, v136, v137
v_cvt_pk_bf16_f32 v137, v138, v139
v_cvt_pk_bf16_f32 v140, v140, v141
v_cvt_pk_bf16_f32 v141, v142, v143
v_mfma_f32_16x16x32_bf16 v[168:171], a[208:211], v[40:43], v[168:171]
ds_write_b64 v226, v[136:137] offset:32768
ds_write_b64 v227, v[140:141] offset:32768
v_cvt_pk_bf16_f32 v144, v144, v145
v_cvt_pk_bf16_f32 v145, v146, v147
v_mfma_f32_16x16x32_bf16 v[168:171], a[212:215], v[44:47], v[168:171]
ds_write_b64 v228, v[144:145] offset:32768
v_cvt_pk_bf16_f32 v148, v148, v149
v_cvt_pk_bf16_f32 v149, v150, v151
v_cvt_pk_bf16_f32 v152, v152, v153
v_cvt_pk_bf16_f32 v153, v154, v155
v_mfma_f32_16x16x32_bf16 v[172:175], a[216:219], v[44:47], v[172:175]
ds_write_b64 v229, v[148:149] offset:32768
ds_write_b64 v230, v[152:153] offset:32768
v_cvt_pk_bf16_f32 v156, v156, v157
v_cvt_pk_bf16_f32 v157, v158, v159
v_add_f32 v63, v60, v61
v_rcp_f32 v62, v63
v_mfma_f32_16x16x32_bf16 v[172:175], a[220:223], v[40:43], v[172:175]
ds_write_b64 v231, v[156:157] offset:32768
v_mfma_f32_16x16x32_bf16 v[176:179], a[224:227], v[40:43], v[176:179]
ds_read_b128 v[128:131], v248 offset:32768
ds_read_b128 v[136:139], v248 offset:33792
ds_read_b128 v[144:147], v248 offset:34816
ds_read_b128 v[152:155], v248 offset:35840
v_mfma_f32_16x16x32_bf16 v[176:179], a[228:231], v[44:47], v[176:179]
v_mul_f32 v160, v62, v160
v_mul_f32 v161, v62, v161
v_mfma_f32_16x16x32_bf16 v[180:183], a[232:235], v[44:47], v[180:183]
v_mul_f32 v162, v62, v162
v_mul_f32 v163, v62, v163
v_mfma_f32_16x16x32_bf16 v[180:183], a[236:239], v[40:43], v[180:183]
v_cvt_pk_bf16_f32 v160, v160, v161
v_cvt_pk_bf16_f32 v161, v162, v163
v_mfma_f32_16x16x32_bf16 v[184:187], a[240:243], v[40:43], v[184:187]
ds_write_b64 v224, v[160:161] offset:49152
v_mfma_f32_16x16x32_bf16 v[184:187], a[244:247], v[44:47], v[184:187]
s_waitcnt lgkmcnt(4)
buffer_store_dwordx4 v[128:131], v244, s[20:23], s42 offen offset:0 sc1
v_mfma_f32_16x16x32_bf16 v[188:191], a[248:251], v[44:47], v[188:191]
v_mul_f32 v164, v62, v164
v_mul_f32 v165, v62, v165
v_mul_f32 v166, v62, v166
v_mul_f32 v167, v62, v167
v_cvt_pk_bf16_f32 v164, v164, v165
v_cvt_pk_bf16_f32 v165, v166, v167
v_mfma_f32_16x16x32_bf16 v[188:191], a[252:255], v[40:43], v[188:191]
s_waitcnt lgkmcnt(1)
buffer_store_dwordx4 v[136:139], v245, s[20:23], s42 offen offset:1024 sc1
buffer_store_dwordx4 v[144:147], v246, s[20:23], s42 offen offset:2048 sc1
buffer_store_dwordx4 v[152:155], v247, s[20:23], s42 offen offset:3072 sc1
ds_write_b64 v225, v[164:165] offset:49152
v_subrev_u32 v63, 0x2f800000, v63
v_max_u32 v3, v3, v63
v_pk_mul_f32 v[168:169], v[168:169], v[62:63] op_sel_hi:[1,0]
v_pk_mul_f32 v[170:171], v[170:171], v[62:63] op_sel_hi:[1,0]
v_pk_mul_f32 v[172:173], v[172:173], v[62:63] op_sel_hi:[1,0]
v_pk_mul_f32 v[174:175], v[174:175], v[62:63] op_sel_hi:[1,0]
v_pk_mul_f32 v[176:177], v[176:177], v[62:63] op_sel_hi:[1,0]
v_pk_mul_f32 v[178:179], v[178:179], v[62:63] op_sel_hi:[1,0]
v_cvt_pk_bf16_f32 v168, v168, v169
v_cvt_pk_bf16_f32 v169, v170, v171
v_cvt_pk_bf16_f32 v172, v172, v173
v_cvt_pk_bf16_f32 v173, v174, v175
v_cvt_pk_bf16_f32 v176, v176, v177
v_cvt_pk_bf16_f32 v177, v178, v179
ds_write_b64 v226, v[168:169] offset:49152
ds_write_b64 v227, v[172:173] offset:49152
ds_write_b64 v228, v[176:177] offset:49152
v_pk_mul_f32 v[180:181], v[180:181], v[62:63] op_sel_hi:[1,0]
v_pk_mul_f32 v[182:183], v[182:183], v[62:63] op_sel_hi:[1,0]
v_pk_mul_f32 v[184:185], v[184:185], v[62:63] op_sel_hi:[1,0]
v_pk_mul_f32 v[186:187], v[186:187], v[62:63] op_sel_hi:[1,0]
v_pk_mul_f32 v[188:189], v[188:189], v[62:63] op_sel_hi:[1,0]
v_pk_mul_f32 v[190:191], v[190:191], v[62:63] op_sel_hi:[1,0]
v_cvt_pk_bf16_f32 v180, v180, v181
v_cvt_pk_bf16_f32 v181, v182, v183
v_cvt_pk_bf16_f32 v184, v184, v185
v_cvt_pk_bf16_f32 v185, v186, v187
v_cvt_pk_bf16_f32 v188, v188, v189
v_cvt_pk_bf16_f32 v189, v190, v191
ds_write_b64 v229, v[180:181] offset:49152
ds_write_b64 v230, v[184:185] offset:49152
ds_write_b64 v231, v[188:189] offset:49152
ds_read_b128 v[160:163], v248 offset:49152
ds_read_b128 v[168:171], v248 offset:50176
ds_read_b128 v[176:179], v248 offset:51200
ds_read_b128 v[184:187], v248 offset:52224
s_waitcnt lgkmcnt(3)
buffer_store_dwordx4 v[160:163], v244, s[20:23], s43 offen offset:0 sc1
s_waitcnt lgkmcnt(2)
buffer_store_dwordx4 v[168:171], v245, s[20:23], s43 offen offset:1024 sc1
s_waitcnt lgkmcnt(1)
buffer_store_dwordx4 v[176:179], v246, s[20:23], s43 offen offset:2048 sc1
s_waitcnt lgkmcnt(0)
buffer_store_dwordx4 v[184:187], v247, s[20:23], s43 offen offset:3072 sc1
v_cmp_lt_u32 vcc, 0x1c000000, v3
s_nop 4
s_cbranch_vccnz L_fb
s_endpgm
L_fb:
s_waitcnt vmcnt(0) lgkmcnt(0)
s_barrier
s_lshl_b32 s57, s25, 13
v_subrev_u32 v2, s46, v2
v_add_u32 v8, s57, v8
v_add_u32 v9, s57, v9
v_add_u32 v10, s57, v10
v_add_u32 v11, s57, v11
v_mbcnt_lo_u32_b32 v236, -1, 0
v_mbcnt_hi_u32_b32 v236, -1, v236
v_xor_b32 v234, 16, v236
v_lshlrev_b32 v234, 2, v234
v_xor_b32 v235, 32, v236
v_lshlrev_b32 v235, 2, v235
v_add_u32 v1, 0x1000, v0
v_mov_b32 v250, 0x3e0293ee
v_mov_b32 v12, 0x3f803f80
v_mov_b32 v13, 0x3f803f80
v_mov_b32 v14, 0x3f803f80
v_mov_b32 v15, 0x3f803f80
s_mov_b32 s55, 0
L_fb_q:
buffer_load_dwordx4 a[0:3], v0, s[8:11], s55 offen offset:0
buffer_load_dwordx4 a[4:7], v0, s[8:11], s55 offen offset:64
buffer_load_dwordx4 a[8:11], v0, s[8:11], s55 offen offset:128
buffer_load_dwordx4 a[12:15], v0, s[8:11], s55 offen offset:192
v_mov_b32 v232, 0xff800000
s_mov_b32 s56, 0
L_fb_max:
buffer_load_dwordx4 a[128:131], v0, s[12:15], s56 offen offset:0
buffer_load_dwordx4 a[132:135], v0, s[12:15], s56 offen offset:64
buffer_load_dwordx4 a[136:139], v0, s[12:15], s56 offen offset:128
buffer_load_dwordx4 a[140:143], v0, s[12:15], s56 offen offset:192
buffer_load_dwordx4 a[144:147], v1, s[12:15], s56 offen offset:0
buffer_load_dwordx4 a[148:151], v1, s[12:15], s56 offen offset:64
buffer_load_dwordx4 a[152:155], v1, s[12:15], s56 offen offset:128
buffer_load_dwordx4 a[156:159], v1, s[12:15], s56 offen offset:192
s_waitcnt vmcnt(0)
v_mfma_f32_16x16x32_bf16 v[16:19], a[128:131], a[0:3], 0
v_mfma_f32_16x16x32_bf16 v[16:19], a[132:135], a[4:7], v[16:19]
v_mfma_f32_16x16x32_bf16 v[16:19], a[136:139], a[8:11], v[16:19]
v_mfma_f32_16x16x32_bf16 v[16:19], a[140:143], a[12:15], v[16:19]
v_mfma_f32_16x16x32_bf16 v[20:23], a[144:147], a[0:3], 0
v_mfma_f32_16x16x32_bf16 v[20:23], a[148:151], a[4:7], v[20:23]
v_mfma_f32_16x16x32_bf16 v[20:23], a[152:155], a[8:11], v[20:23]
v_mfma_f32_16x16x32_bf16 v[20:23], a[156:159], a[12:15], v[20:23]
s_nop 7
s_nop 1
v_max3_f32 v232, v16, v17, v232
v_max3_f32 v232, v18, v19, v232
v_max3_f32 v232, v20, v21, v232
v_max3_f32 v232, v22, v23, v232
s_add_u32 s56, s56, 8192
s_cmp_lt_u32 s56, 131072
s_cbranch_scc1 L_fb_max
ds_bpermute_b32 v233, v234, v232
s_waitcnt lgkmcnt(0)
v_max_f32 v232, v232, v233
ds_bpermute_b32 v233, v235, v232
s_waitcnt lgkmcnt(0)
v_max_f32 v232, v232, v233
v_mul_f32 v232, v250, v232
v_mov_b32 v64, 0
v_mov_b32 v65, 0
v_mov_b32 v66, 0
v_mov_b32 v67, 0
v_mov_b32 v68, 0
v_mov_b32 v69, 0
v_mov_b32 v70, 0
v_mov_b32 v71, 0
v_mov_b32 v72, 0
v_mov_b32 v73, 0
v_mov_b32 v74, 0
v_mov_b32 v75, 0
v_mov_b32 v76, 0
v_mov_b32 v77, 0
v_mov_b32 v78, 0
v_mov_b32 v79, 0
v_mov_b32 v80, 0
v_mov_b32 v81, 0
v_mov_b32 v82, 0
v_mov_b32 v83, 0
v_mov_b32 v84, 0
v_mov_b32 v85, 0
v_mov_b32 v86, 0
v_mov_b32 v87, 0
v_mov_b32 v88, 0
v_mov_b32 v89, 0
v_mov_b32 v90, 0
v_mov_b32 v91, 0
v_mov_b32 v92, 0
v_mov_b32 v93, 0
v_mov_b32 v94, 0
v_mov_b32 v95, 0
v_mov_b32 v48, 0
v_mov_b32 v49, 0
v_mov_b32 v50, 0
v_mov_b32 v51, 0
s_mov_b32 s56, 0
L_fb_pv:
buffer_load_dwordx4 a[128:131], v0, s[12:15], s56 offen offset:0
buffer_load_dwordx4 a[132:135], v0, s[12:15], s56 offen offset:64
buffer_load_dwordx4 a[136:139], v0, s[12:15], s56 offen offset:128
buffer_load_dwordx4 a[140:143], v0, s[12:15], s56 offen offset:192
buffer_load_dwordx4 a[144:147], v1, s[12:15], s56 offen offset:0
buffer_load_dwordx4 a[148:151], v1, s[12:15], s56 offen offset:64
buffer_load_dwordx4 a[152:155], v1, s[12:15], s56 offen offset:128
buffer_load_dwordx4 a[156:159], v1, s[12:15], s56 offen offset:192
s_add_u32 m0, s57, 0
s_add_u32 s58, s56, 0
buffer_load_dwordx4 v2, s[16:19], s58 offen offset:0 lds
buffer_load_dwordx4 v2, s[16:19], s58 offen offset:2048 lds
s_add_u32 m0, s57, 1024
s_add_u32 s58, s56, 128
buffer_load_dwordx4 v2, s[16:19], s58 offen offset:0 lds
buffer_load_dwordx4 v2, s[16:19], s58 offen offset:2048 lds
s_add_u32 m0, s57, 4096
s_add_u32 s58, s56, 4096
buffer_load_dwordx4 v2, s[16:19], s58 offen offset:0 lds
buffer_load_dwordx4 v2, s[16:19], s58 offen offset:2048 lds
s_add_u32 m0, s57, 5120
s_add_u32 s58, s56, 4224
buffer_load_dwordx4 v2, s[16:19], s58 offen offset:0 lds
buffer_load_dwordx4 v2, s[16:19], s58 offen offset:2048 lds
s_waitcnt vmcnt(0)
ds_read_b64_tr_b16 a[192:193], v8 offset:0
ds_read_b64_tr_b16 a[194:195], v8 offset:4096
ds_read_b64_tr_b16 a[196:197], v9 offset:0
ds_read_b64_tr_b16 a[198:199], v9 offset:4096
ds_read_b64_tr_b16 a[200:201], v10 offset:0
ds_read_b64_tr_b16 a[202:203], v10 offset:4096
ds_read_b64_tr_b16 a[204:205], v11 offset:0
ds_read_b64_tr_b16 a[206:207], v11 offset:4096
ds_read_b64_tr_b16 a[208:209], v8 offset:1024
ds_read_b64_tr_b16 a[210:211], v8 offset:5120
ds_read_b64_tr_b16 a[212:213], v9 offset:1024
ds_read_b64_tr_b16 a[214:215], v9 offset:5120
ds_read_b64_tr_b16 a[216:217], v10 offset:1024
ds_read_b64_tr_b16 a[218:219], v10 offset:5120
ds_read_b64_tr_b16 a[220:221], v11 offset:1024
ds_read_b64_tr_b16 a[222:223], v11 offset:5120
v_mfma_f32_16x16x32_bf16 v[16:19], a[128:131], a[0:3], 0
v_mfma_f32_16x16x32_bf16 v[16:19], a[132:135], a[4:7], v[16:19]
v_mfma_f32_16x16x32_bf16 v[16:19], a[136:139], a[8:11], v[16:19]
v_mfma_f32_16x16x32_bf16 v[16:19], a[140:143], a[12:15], v[16:19]
v_mfma_f32_16x16x32_bf16 v[20:23], a[144:147], a[0:3], 0
v_mfma_f32_16x16x32_bf16 v[20:23], a[148:151], a[4:7], v[20:23]
v_mfma_f32_16x16x32_bf16 v[20:23], a[152:155], a[8:11], v[20:23]
v_mfma_f32_16x16x32_bf16 v[20:23], a[156:159], a[12:15], v[20:23]
s_nop 7
s_nop 1
v_fma_f32 v16, v16, v250, -v232
v_fma_f32 v17, v17, v250, -v232
v_fma_f32 v18, v18, v250, -v232
v_fma_f32 v19, v19, v250, -v232
v_fma_f32 v20, v20, v250, -v232
v_fma_f32 v21, v21, v250, -v232
v_fma_f32 v22, v22, v250, -v232
v_fma_f32 v23, v23, v250, -v232
v_exp_f32 v16, v16
v_exp_f32 v17, v17
v_exp_f32 v18, v18
v_exp_f32 v19, v19
v_exp_f32 v20, v20
v_exp_f32 v21, v21
v_exp_f32 v22, v22
v_exp_f32 v23, v23
s_nop 0
v_cvt_pk_bf16_f32 v32, v16, v17
v_cvt_pk_bf16_f32 v33, v18, v19
v_cvt_pk_bf16_f32 v34, v20, v21
v_cvt_pk_bf16_f32 v35, v22, v23
s_waitcnt lgkmcnt(0)
s_nop 1
v_mfma_f32_16x16x32_bf16 v[64:67], a[192:195], v[32:35], v[64:67]
v_mfma_f32_16x16x32_bf16 v[68:71], a[196:199], v[32:35], v[68:71]
v_mfma_f32_16x16x32_bf16 v[72:75], a[200:203], v[32:35], v[72:75]
v_mfma_f32_16x16x32_bf16 v[76:79], a[204:207], v[32:35], v[76:79]
v_mfma_f32_16x16x32_bf16 v[80:83], a[208:211], v[32:35], v[80:83]
v_mfma_f32_16x16x32_bf16 v[84:87], a[212:215], v[32:35], v[84:87]
v_mfma_f32_16x16x32_bf16 v[88:91], a[216:219], v[32:35], v[88:91]
v_mfma_f32_16x16x32_bf16 v[92:95], a[220:223], v[32:35], v[92:95]
v_mfma_f32_16x16x32_bf16 v[48:51], v[12:15], v[32:35], v[48:51]
s_nop 7
s_add_u32 s56, s56, 8192
s_cmp_lt_u32 s56, 131072
s_cbranch_scc1 L_fb_pv
s_nop 7
v_rcp_f32 v49, v48
s_nop 0
v_mul_f32 v64, v49, v64
v_mul_f32 v65, v49, v65
v_mul_f32 v66, v49, v66
v_mul_f32 v67, v49, v67
v_mul_f32 v68, v49, v68
v_mul_f32 v69, v49, v69
v_mul_f32 v70, v49, v70
v_mul_f32 v71, v49, v71
v_mul_f32 v72, v49, v72
v_mul_f32 v73, v49, v73
v_mul_f32 v74, v49, v74
v_mul_f32 v75, v49, v75
v_mul_f32 v76, v49, v76
v_mul_f32 v77, v49, v77
v_mul_f32 v78, v49, v78
v_mul_f32 v79, v49, v79
v_mul_f32 v80, v49, v80
v_mul_f32 v81, v49, v81
v_mul_f32 v82, v49, v82
v_mul_f32 v83, v49, v83
v_mul_f32 v84, v49, v84
v_mul_f32 v85, v49, v85
v_mul_f32 v86, v49, v86
v_mul_f32 v87, v49, v87
v_mul_f32 v88, v49, v88
v_mul_f32 v89, v49, v89
v_mul_f32 v90, v49, v90
v_mul_f32 v91, v49, v91
v_mul_f32 v92, v49, v92
v_mul_f32 v93, v49, v93
v_mul_f32 v94, v49, v94
v_mul_f32 v95, v49, v95
v_cvt_pk_bf16_f32 v64, v64, v65
v_cvt_pk_bf16_f32 v65, v66, v67
v_cvt_pk_bf16_f32 v66, v68, v69
v_cvt_pk_bf16_f32 v67, v70, v71
s_nop 1
v_permlane16_swap_b32 v64, v66
v_permlane16_swap_b32 v65, v67
buffer_store_dwordx4 v[64:67], v0, s[20:23], s55 offen offset:0
v_cvt_pk_bf16_f32 v72, v72, v73
v_cvt_pk_bf16_f32 v73, v74, v75
v_cvt_pk_bf16_f32 v74, v76, v77
v_cvt_pk_bf16_f32 v75, v78, v79
s_nop 1
v_permlane16_swap_b32 v72, v74
v_permlane16_swap_b32 v73, v75
buffer_store_dwordx4 v[72:75], v0, s[20:23], s55 offen offset:64
v_cvt_pk_bf16_f32 v80, v80, v81
v_cvt_pk_bf16_f32 v81, v82, v83
v_cvt_pk_bf16_f32 v82, v84, v85
v_cvt_pk_bf16_f32 v83, v86, v87
s_nop 1
v_permlane16_swap_b32 v80, v82
v_permlane16_swap_b32 v81, v83
buffer_store_dwordx4 v[80:83], v0, s[20:23], s55 offen offset:128
v_cvt_pk_bf16_f32 v88, v88, v89
v_cvt_pk_bf16_f32 v89, v90, v91
v_cvt_pk_bf16_f32 v90, v92, v93
v_cvt_pk_bf16_f32 v91, v94, v95
s_nop 1
v_permlane16_swap_b32 v88, v90
v_permlane16_swap_b32 v89, v91
buffer_store_dwordx4 v[88:91], v0, s[20:23], s55 offen offset:192
s_waitcnt vmcnt(0)
s_add_u32 s55, s55, 4096
s_cmp_lt_u32 s55, 49152
s_cbranch_scc1 L_fb_q
L_end:
s_endpgm
.section .rodata,"a"
.p2align 6
.amdhsa_kernel standalone__gqa_softmax__near_ridge_kernel
  .amdhsa_next_free_vgpr 512
  .amdhsa_next_free_sgpr 96
  .amdhsa_accum_offset 256
  .amdhsa_group_segment_fixed_size 0
  .amdhsa_kernarg_size 48
  .amdhsa_user_sgpr_count 2
  .amdhsa_user_sgpr_kernarg_segment_ptr 1
  .amdhsa_system_sgpr_workgroup_id_x 1
.end_amdhsa_kernel
```
